```python
import torch

def _softmax(x, axis=-1):
    return torch.softmax(x, dim=axis)
def _gelu(x):
    return torch.nn.functional.gelu(x, approximate="tanh")
def _silu(x):
    return torch.nn.functional.silu(x)
def _sigmoid(x):
    return torch.sigmoid(x)
def _layernorm(x, axis=-1, eps=1e-5):
    m = x.mean(dim=axis, keepdim=True)
    v = x.var(dim=axis, keepdim=True, unbiased=False)
    return (x - m) / torch.sqrt(v + eps)
def _scatter_add(tgt, idx, src, axis=0):
    return tgt.clone().index_add_(axis, idx, src)
def _segment_sum(src, seg, n):
    out = torch.zeros((n,) + src.shape[1:], dtype=src.dtype)
    return out.index_add_(0, seg, src)
def _pad(x, pw):
    flat = tuple(v for pair in reversed(pw) for v in pair)
    return torch.nn.functional.pad(x, flat)

kernel_name = 'interleave_layers__spectral_fnet__swiglu_ffn__prompt'

def setup_inputs():

    _w = (lambda a: (lambda t: t.to(torch.bfloat16) if t.is_floating_point() else t)(torch.as_tensor(a)))
    def _A_setup():
        B, S, D = 1, 2048, 640
        ns = torch.arange(S)[:, None] * torch.arange(S)[None, :]
        nd = torch.arange(D)[:, None] * torch.arange(D)[None, :]
        Ws_re = torch.cos(-2.0 * torch.pi * ns / S).to(float)
        Ws_im = torch.sin(-2.0 * torch.pi * ns / S).to(float)
        Wd_re = torch.cos(-2.0 * torch.pi * nd / D).to(float)
        Wd_im = torch.sin(-2.0 * torch.pi * nd / D).to(float)
        return {
            "x": _w((lambda *s: torch.randn(*s, dtype=torch.bfloat16) * 0.05)(B, S, D)),
            "dft_seq_re": _w(Ws_re),
            "dft_seq_im": _w(Ws_im),
            "dft_hid_re": _w(Wd_re),
            "dft_hid_im": _w(Wd_im),
        }
    _A_in = _A_setup()

    def _B_setup():
        B, S, D, F = 1, 2048, 640, 1728
        return {
            "x": _w((lambda *s: torch.randn(*s, dtype=torch.bfloat16) * 0.05)(B, S, D)),
            "w_gate": _w((lambda *s: torch.randn(*s, dtype=torch.bfloat16) * 0.4)(D, F)),
            "w_up": _w((lambda *s: torch.randn(*s, dtype=torch.bfloat16) * 0.4)(D, F)),
            "w_down": _w((lambda *s: torch.randn(*s, dtype=torch.bfloat16) * 0.4)(F, D)),
        }
    _B_in = _B_setup()

    return {
        "A_x": _A_in["x"],
        "A_dft_seq_re": _A_in["dft_seq_re"],
        "A_dft_seq_im": _A_in["dft_seq_im"],
        "A_dft_hid_re": _A_in["dft_hid_re"],
        "A_dft_hid_im": _A_in["dft_hid_im"],
        "B_x": _B_in["x"],
        "B_w_gate": _B_in["w_gate"],
        "B_w_up": _B_in["w_up"],
        "B_w_down": _B_in["w_down"],
    }

def reference(A_x, A_dft_seq_re, A_dft_seq_im, A_dft_hid_re, A_dft_hid_im, B_x, B_w_gate, B_w_up, B_w_down):
    def _A_ref(x, dft_seq_re, dft_seq_im, dft_hid_re, dft_hid_im):
        a = torch.einsum("bsd,ed->bse", x, dft_hid_re)
        b = torch.einsum("bsd,ed->bse", x, dft_hid_im)
        y = torch.einsum("ts,bse->bte", dft_seq_re, a) - torch.einsum("ts,bse->bte", dft_seq_im, b)
        return y

    def _B_ref(x, w_gate, w_up, w_down):
        g = _silu(x @ w_gate)
        u = x @ w_up
        return (g * u) @ w_down

    x = A_x
    x = x + _A_ref(_layernorm(x, axis=-1), A_dft_seq_re, A_dft_seq_im, A_dft_hid_re, A_dft_hid_im)
    x = x + _B_ref(_layernorm(x, axis=-1), B_w_gate, B_w_up, B_w_down)
    x = x + _A_ref(_layernorm(x, axis=-1), A_dft_seq_re, A_dft_seq_im, A_dft_hid_re, A_dft_hid_im)
    x = x + _B_ref(_layernorm(x, axis=-1), B_w_gate, B_w_up, B_w_down)
    return x
```

```asm
; @launch grid=(256,1,1) block=(256,1,1) lds=163840
.amdgcn_target "amdgcn-amd-amdhsa--gfx950"
.text
.globl interleave_layers__spectral_fnet__swiglu_ffn__prompt_kernel
.p2align 8
.type interleave_layers__spectral_fnet__swiglu_ffn__prompt_kernel,@function
interleave_layers__spectral_fnet__swiglu_ffn__prompt_kernel:
    s_cmp_ge_u32 s2, 256
    s_cbranch_scc1 END
    s_getpc_b64 s[94:95]
PC0:
    s_load_dwordx2 s[4:5], s[0:1], 88
    s_load_dwordx2 s[16:17], s[0:1], 48
    s_load_dwordx2 s[20:21], s[0:1], 56
    s_load_dwordx2 s[24:25], s[0:1], 64
    s_load_dwordx2 s[8:9], s[0:1], 0
    s_load_dwordx2 s[12:13], s[0:1], 72
    s_load_dwordx2 s[32:33], s[0:1], 80
    s_lshr_b32 s50, s2, 3
    s_lshl_b32 s50, s50, 11
    v_lshrrev_b32 v12, 4, v0
    v_lshl_add_u32 v12, v12, 7, s50
    v_min_u32 v12, CODE_END-PC0-4, v12
    global_load_dword v13, v12, s[94:95]
    v_lshrrev_b32 v3, 6, v0
    v_and_b32 v0, 63, v0
    v_readfirstlane_b32 s36, v3
    s_mov_b32 s6, 268435456
    s_mov_b32 s7, 0x00020000
    s_mov_b32 s18, 2211840
    s_mov_b32 s19, 0x00020000
    s_mov_b32 s22, 2211840
    s_mov_b32 s23, 0x00020000
    s_mov_b32 s26, 2211840
    s_mov_b32 s27, 0x00020000
    s_mov_b32 s10, 2621440
    s_mov_b32 s11, 0x00020000
    s_mov_b32 s14, 2621440
    s_mov_b32 s15, 0x00020000
    s_mov_b32 s34, 256
    s_mov_b32 s35, 0x00020000
    v_lshlrev_b32 v1, 4, v0
    v_and_b32 v2, 15, v0
    v_lshrrev_b32 v3, 4, v0
    s_and_b32 s37, s2, 7
    s_lshr_b32 s38, s2, 6
    s_bfe_u32 s39, s2, 0x30003
    s_lshl_b32 s40, s37, 2
    s_add_u32 s40, s40, s38
    s_lshr_b32 s41, s40, 1
    s_sub_u32 s50, 32, s41
    s_cmp_eq_u32 s40, 1
    s_cselect_b32 s50, 16, s50
    s_bitcmp1_b32 s40, 0
    s_cselect_b32 s41, s50, s41
    s_lshl_b32 s50, s39, 3
    s_lshl_b32 s51, s36, 1
    s_add_u32 s50, s50, s51
    s_lshr_b32 s51, s50, 5
    s_lshl_b32 s51, s51, 5
    s_and_b32 s50, s50, 31
    s_lshl_b32 s50, s50, 6
    s_add_u32 s50, s50, s51
    s_add_u32 s50, s50, s41
    s_mul_i32 s60, s50, 1280
    v_cmp_lt_u32 vcc, 9, v0
    v_mov_b32 v21, 80640
    s_lshr_b32 s50, s36, 1
    s_lshl_b32 s50, s50, 5
    v_cndmask_b32 v20, 0, v21, vcc
    v_lshl_add_u32 v20, v0, 7, v20
    s_and_b32 s51, s36, 1
    s_lshl_b32 s51, s51, 10
    s_add_u32 s50, s50, s51
    s_add_u32 s50, s50, s41
    s_mul_i32 s50, s50, 1280
    v_lshrrev_b32 v50, 3, v0
    v_and_b32 v51, 7, v0
    v_xor_b32 v51, v51, v50
    v_mul_u32_u24 v48, 81920, v50
    v_lshl_add_u32 v48, v51, 4, v48
    v_add_u32 v48, s50, v48
    v_add_u32 v49, 655360, v48
    s_mul_i32 s74, s36, 20480
    s_waitcnt lgkmcnt(0)
    s_xor_b32 s81, s36, 0
    s_lshl_b32 s81, s81, 8
    s_add_u32 s81, s81, s2
    s_cmp_ge_u32 s81, 64
    s_cbranch_scc1 SKIP1
    v_mov_b32 v16, 0
    v_mov_b32 v17, 0
    v_mov_b32 v18, 0
    v_mov_b32 v19, 0
    s_mul_i32 s50, s2, 4096
    buffer_store_dwordx4 v[16:19], v1, s[4:7], s50 offen offset:0 sc1
    buffer_store_dwordx4 v[16:19], v1, s[4:7], s50 offen offset:1024 sc1
    buffer_store_dwordx4 v[16:19], v1, s[4:7], s50 offen offset:2048 sc1
    buffer_store_dwordx4 v[16:19], v1, s[4:7], s50 offen offset:3072 sc1
SKIP1:
    s_mov_b32 exec_lo, 0xfffff
    s_mov_b32 exec_hi, 0x0
    buffer_load_dword v15, v20, s[8:11], s60 offen
    s_mov_b64 exec, -1
    s_add_u32 m0, s74, 0
    s_nop 0
    buffer_load_dwordx4 v48, s[8:11], 0 offen offset:0 lds
    s_add_u32 m0, s74, 1024
    s_nop 0
    buffer_load_dwordx4 v49, s[8:11], 0 offen offset:0 lds
    s_add_u32 m0, s74, 1408
    s_nop 0
    buffer_load_dwordx4 v48, s[8:11], 0 offen offset:640 lds
    s_add_u32 m0, s74, 2432
    s_nop 0
    buffer_load_dwordx4 v49, s[8:11], 0 offen offset:640 lds
    s_add_u32 m0, s74, 3968
    s_nop 0
    buffer_load_dwordx4 v48, s[8:11], 0 offen offset:128 lds
    s_add_u32 m0, s74, 4992
    s_nop 0
    buffer_load_dwordx4 v49, s[8:11], 0 offen offset:128 lds
    s_mov_b32 s90, 1
    s_mov_b32 s66, -1
    s_mov_b32 s67, 0
    v_and_b32 v51, 7, v2
    v_xor_b32 v51, v51, v3
    v_lshlrev_b32 v51, 4, v51
    v_lshl_add_u32 v50, v2, 7, v51
    v_add_u32 v50, s74, v50
    v_xor_b32 v51, 64, v50
    s_mul_i32 s52, s39, 40
    s_lshr_b32 s53, s36, 1
    s_lshl_b32 s53, s53, 4
    s_and_b32 s54, s36, 1
    s_lshl_b32 s55, s54, 1
    s_add_u32 s53, s53, s55
    s_add_u32 s53, s53, s52
    v_and_b32 v20, 1, v0
    v_and_b32 v21, 12, v0
    v_add3_u32 v22, v20, v21, s53
    s_lshl_b32 s56, s36, 10
    s_add_u32 s56, s56, 105472
    v_add_u32 v25, s56, v1
    v_mov_b32 v35, 0
    v_and_b32 v26, 2, v0
    v_cvt_f32_u32 v23, v22
    v_cvt_f32_u32 v26, v26
    v_mul_f32 v26, 0x3e000000, v26
    v_cmp_eq_u32 vcc, 0, v22
    v_mov_b32 v27, 0x3e800000
    v_mul_f32 v23, 0x3acccccd, v23
    v_cndmask_b32 v26, v26, v27, vcc
    v_lshlrev_b32 v27, 3, v3
    v_cvt_f32_u32 v27, v27
    v_fma_f32 v24, v23, v27, v26
    v_fmamk_f32 v89, v23, 0x3f800000, v24
    v_fmamk_f32 v90, v23, 0x40000000, v24
    v_fmamk_f32 v91, v23, 0x40400000, v24
    v_fmamk_f32 v92, v23, 0x40800000, v24
    v_fmamk_f32 v93, v23, 0x40a00000, v24
    v_fmamk_f32 v94, v23, 0x40c00000, v24
    v_fmamk_f32 v95, v23, 0x40e00000, v24
    v_cos_f32 v88, v24
    v_cos_f32 v89, v89
    v_cos_f32 v90, v90
    v_cos_f32 v91, v91
    v_cos_f32 v92, v92
    v_cos_f32 v93, v93
    v_cos_f32 v94, v94
    v_cos_f32 v95, v95
    v_fmamk_f32 v24, v23, 0x42000000, v24
    v_mul_f32 v34, 0x42000000, v23
    v_fmamk_f32 v97, v23, 0x3f800000, v24
    v_fmamk_f32 v98, v23, 0x40000000, v24
    v_fmamk_f32 v99, v23, 0x40400000, v24
    v_fmamk_f32 v100, v23, 0x40800000, v24
    v_fmamk_f32 v101, v23, 0x40a00000, v24
    v_fmamk_f32 v102, v23, 0x40c00000, v24
    v_fmamk_f32 v103, v23, 0x40e00000, v24
    v_cos_f32 v96, v24
    v_cos_f32 v97, v97
    v_cos_f32 v98, v98
    v_cos_f32 v99, v99
    v_cos_f32 v100, v100
    v_cos_f32 v101, v101
    v_cos_f32 v102, v102
    v_cos_f32 v103, v103
    v_cos_f32 v34, v34
    v_cvt_pk_bf16_f32 v104, v88, v89
    v_cvt_pk_bf16_f32 v105, v90, v91
    v_cvt_pk_bf16_f32 v106, v92, v93
    v_cvt_pk_bf16_f32 v107, v94, v95
    ds_write_b128 v25, v[104:107] offset:0
    v_cvt_pk_bf16_f32 v108, v96, v97
    v_cvt_pk_bf16_f32 v109, v98, v99
    v_cvt_pk_bf16_f32 v110, v100, v101
    v_cvt_pk_bf16_f32 v111, v102, v103
    ds_write_b128 v25, v[108:111] offset:5120
    v_add_f32 v34, v34, v34
    v_pk_fma_f32 v[88:89], v[96:97], v[34:35], v[88:89] op_sel_hi:[1,0,1] neg_lo:[0,0,1] neg_hi:[0,0,1]
    v_pk_fma_f32 v[90:91], v[98:99], v[34:35], v[90:91] op_sel_hi:[1,0,1] neg_lo:[0,0,1] neg_hi:[0,0,1]
    v_pk_fma_f32 v[92:93], v[100:101], v[34:35], v[92:93] op_sel_hi:[1,0,1] neg_lo:[0,0,1] neg_hi:[0,0,1]
    v_pk_fma_f32 v[94:95], v[102:103], v[34:35], v[94:95] op_sel_hi:[1,0,1] neg_lo:[0,0,1] neg_hi:[0,0,1]
    v_cvt_pk_bf16_f32 v104, v88, v89
    v_cvt_pk_bf16_f32 v105, v90, v91
    v_cvt_pk_bf16_f32 v106, v92, v93
    v_cvt_pk_bf16_f32 v107, v94, v95
    ds_write_b128 v25, v[104:107] offset:10240
    v_pk_fma_f32 v[96:97], v[88:89], v[34:35], v[96:97] op_sel_hi:[1,0,1] neg_lo:[0,0,1] neg_hi:[0,0,1]
    v_pk_fma_f32 v[98:99], v[90:91], v[34:35], v[98:99] op_sel_hi:[1,0,1] neg_lo:[0,0,1] neg_hi:[0,0,1]
    v_pk_fma_f32 v[100:101], v[92:93], v[34:35], v[100:101] op_sel_hi:[1,0,1] neg_lo:[0,0,1] neg_hi:[0,0,1]
    v_pk_fma_f32 v[102:103], v[94:95], v[34:35], v[102:103] op_sel_hi:[1,0,1] neg_lo:[0,0,1] neg_hi:[0,0,1]
    v_cvt_pk_bf16_f32 v108, v96, v97
    v_cvt_pk_bf16_f32 v109, v98, v99
    v_cvt_pk_bf16_f32 v110, v100, v101
    v_cvt_pk_bf16_f32 v111, v102, v103
    ds_write_b128 v25, v[108:111] offset:15360
    v_pk_fma_f32 v[88:89], v[96:97], v[34:35], v[88:89] op_sel_hi:[1,0,1] neg_lo:[0,0,1] neg_hi:[0,0,1]
    v_pk_fma_f32 v[90:91], v[98:99], v[34:35], v[90:91] op_sel_hi:[1,0,1] neg_lo:[0,0,1] neg_hi:[0,0,1]
    v_pk_fma_f32 v[92:93], v[100:101], v[34:35], v[92:93] op_sel_hi:[1,0,1] neg_lo:[0,0,1] neg_hi:[0,0,1]
    v_pk_fma_f32 v[94:95], v[102:103], v[34:35], v[94:95] op_sel_hi:[1,0,1] neg_lo:[0,0,1] neg_hi:[0,0,1]
    v_cvt_pk_bf16_f32 v104, v88, v89
    v_cvt_pk_bf16_f32 v105, v90, v91
    v_cvt_pk_bf16_f32 v106, v92, v93
    v_cvt_pk_bf16_f32 v107, v94, v95
    ds_write_b128 v25, v[104:107] offset:20480
    v_pk_fma_f32 v[96:97], v[88:89], v[34:35], v[96:97] op_sel_hi:[1,0,1] neg_lo:[0,0,1] neg_hi:[0,0,1]
    v_pk_fma_f32 v[98:99], v[90:91], v[34:35], v[98:99] op_sel_hi:[1,0,1] neg_lo:[0,0,1] neg_hi:[0,0,1]
    v_pk_fma_f32 v[100:101], v[92:93], v[34:35], v[100:101] op_sel_hi:[1,0,1] neg_lo:[0,0,1] neg_hi:[0,0,1]
    v_pk_fma_f32 v[102:103], v[94:95], v[34:35], v[102:103] op_sel_hi:[1,0,1] neg_lo:[0,0,1] neg_hi:[0,0,1]
    v_cvt_pk_bf16_f32 v108, v96, v97
    v_cvt_pk_bf16_f32 v109, v98, v99
    v_cvt_pk_bf16_f32 v110, v100, v101
    v_cvt_pk_bf16_f32 v111, v102, v103
    ds_write_b128 v25, v[108:111] offset:25600
    v_pk_fma_f32 v[88:89], v[96:97], v[34:35], v[88:89] op_sel_hi:[1,0,1] neg_lo:[0,0,1] neg_hi:[0,0,1]
    v_pk_fma_f32 v[90:91], v[98:99], v[34:35], v[90:91] op_sel_hi:[1,0,1] neg_lo:[0,0,1] neg_hi:[0,0,1]
    v_pk_fma_f32 v[92:93], v[100:101], v[34:35], v[92:93] op_sel_hi:[1,0,1] neg_lo:[0,0,1] neg_hi:[0,0,1]
    v_pk_fma_f32 v[94:95], v[102:103], v[34:35], v[94:95] op_sel_hi:[1,0,1] neg_lo:[0,0,1] neg_hi:[0,0,1]
    v_cvt_pk_bf16_f32 v104, v88, v89
    v_cvt_pk_bf16_f32 v105, v90, v91
    v_cvt_pk_bf16_f32 v106, v92, v93
    v_cvt_pk_bf16_f32 v107, v94, v95
    ds_write_b128 v25, v[104:107] offset:30720
    v_pk_fma_f32 v[96:97], v[88:89], v[34:35], v[96:97] op_sel_hi:[1,0,1] neg_lo:[0,0,1] neg_hi:[0,0,1]
    v_pk_fma_f32 v[98:99], v[90:91], v[34:35], v[98:99] op_sel_hi:[1,0,1] neg_lo:[0,0,1] neg_hi:[0,0,1]
    v_pk_fma_f32 v[100:101], v[92:93], v[34:35], v[100:101] op_sel_hi:[1,0,1] neg_lo:[0,0,1] neg_hi:[0,0,1]
    v_pk_fma_f32 v[102:103], v[94:95], v[34:35], v[102:103] op_sel_hi:[1,0,1] neg_lo:[0,0,1] neg_hi:[0,0,1]
    v_cvt_pk_bf16_f32 v108, v96, v97
    v_cvt_pk_bf16_f32 v109, v98, v99
    v_cvt_pk_bf16_f32 v110, v100, v101
    v_cvt_pk_bf16_f32 v111, v102, v103
    ds_write_b128 v25, v[108:111] offset:35840
    v_pk_fma_f32 v[88:89], v[96:97], v[34:35], v[88:89] op_sel_hi:[1,0,1] neg_lo:[0,0,1] neg_hi:[0,0,1]
    v_pk_fma_f32 v[90:91], v[98:99], v[34:35], v[90:91] op_sel_hi:[1,0,1] neg_lo:[0,0,1] neg_hi:[0,0,1]
    v_pk_fma_f32 v[92:93], v[100:101], v[34:35], v[92:93] op_sel_hi:[1,0,1] neg_lo:[0,0,1] neg_hi:[0,0,1]
    v_pk_fma_f32 v[94:95], v[102:103], v[34:35], v[94:95] op_sel_hi:[1,0,1] neg_lo:[0,0,1] neg_hi:[0,0,1]
    v_cvt_pk_bf16_f32 v104, v88, v89
    v_cvt_pk_bf16_f32 v105, v90, v91
    v_cvt_pk_bf16_f32 v106, v92, v93
    v_cvt_pk_bf16_f32 v107, v94, v95
    ds_write_b128 v25, v[104:107] offset:40960
    v_pk_fma_f32 v[96:97], v[88:89], v[34:35], v[96:97] op_sel_hi:[1,0,1] neg_lo:[0,0,1] neg_hi:[0,0,1]
    v_pk_fma_f32 v[98:99], v[90:91], v[34:35], v[98:99] op_sel_hi:[1,0,1] neg_lo:[0,0,1] neg_hi:[0,0,1]
    v_pk_fma_f32 v[100:101], v[92:93], v[34:35], v[100:101] op_sel_hi:[1,0,1] neg_lo:[0,0,1] neg_hi:[0,0,1]
    v_pk_fma_f32 v[102:103], v[94:95], v[34:35], v[102:103] op_sel_hi:[1,0,1] neg_lo:[0,0,1] neg_hi:[0,0,1]
    v_cvt_pk_bf16_f32 v108, v96, v97
    v_cvt_pk_bf16_f32 v109, v98, v99
    v_cvt_pk_bf16_f32 v110, v100, v101
    v_cvt_pk_bf16_f32 v111, v102, v103
    ds_write_b128 v25, v[108:111] offset:46080
    s_cmp_ge_u32 s81, 64
    s_cbranch_scc1 SKIP2
    s_and_b32 s50, s2, 3
    s_lshl_b32 s50, s50, 6
    s_add_u32 s50, s32, s50
    s_addc_u32 s51, s33, 0
    s_waitcnt vmcnt(7)
    s_atomic_add s90, s[50:51], 0
SKIP2:
    s_add_u32 m0, s74, 5376
    s_nop 0
    buffer_load_dwordx4 v48, s[8:11], 0 offen offset:768 lds
    s_and_b32 s42, s37, 3
    s_lshl_b32 s42, s42, 3
    s_add_u32 s42, s42, s39
    s_and_b32 s46, s40, 7
    s_lshl_b32 s46, s46, 2
    s_add_u32 s46, s46, s36
    s_lshr_b32 s47, s40, 3
    s_mul_i32 s72, s47, 28
    s_add_u32 s48, s72, s46
    s_mul_i32 s72, s48, 20480
    s_cmp_lt_u32 s46, 28
    s_cselect_b32 s72, s72, 0x10000000
    s_mul_i32 s73, s36, 2560
    s_add_u32 s73, s73, 81920
    s_add_u32 m0, s74, 6400
    s_nop 0
    buffer_load_dwordx4 v49, s[8:11], 0 offen offset:768 lds
    s_mul_i32 s76, s39, 80
    s_mul_i32 s77, s39, 160
    s_sub_u32 s77, 1120, s77
    s_add_u32 s72, s72, s76
    v_mov_b32 v47, s77
    s_cmp_eq_u32 s42, 31
    s_cselect_b32 s18, 0, s18
    s_cselect_b32 s22, 0, s22
    v_add_u32 v44, 0, v0
    v_mul_u32_u24 v45, 6554, v44
    v_lshrrev_b32 v45, 16, v45
    v_mul_u32_u24 v46, 10, v45
    v_sub_u32 v46, v44, v46
    v_cmp_lt_u32 vcc, 4, v46
    s_add_u32 m0, s74, 7936
    s_nop 0
    buffer_load_dwordx4 v48, s[8:11], 0 offen offset:256 lds
    v_mul_u32_u24 v239, 1280, v45
    v_lshl_add_u32 v239, v46, 4, v239
    v_cndmask_b32 v44, 0, v47, vcc
    v_add_u32 v239, v239, v44
    v_add_u32 v44, 64, v0
    v_mul_u32_u24 v45, 6554, v44
    v_lshrrev_b32 v45, 16, v45
    v_mul_u32_u24 v46, 10, v45
    v_sub_u32 v46, v44, v46
    v_cmp_lt_u32 vcc, 4, v46
    v_mul_u32_u24 v240, 1280, v45
    v_lshl_add_u32 v240, v46, 4, v240
    s_add_u32 m0, s74, 8960
    s_nop 0
    buffer_load_dwordx4 v49, s[8:11], 0 offen offset:256 lds
    v_cndmask_b32 v44, 0, v47, vcc
    v_add_u32 v240, v240, v44
    v_add_u32 v44, 128, v0
    v_mul_u32_u24 v45, 6554, v44
    v_lshrrev_b32 v45, 16, v45
    v_mul_u32_u24 v46, 10, v45
    v_sub_u32 v46, v44, v46
    v_cmp_lt_u32 vcc, 4, v46
    v_mul_u32_u24 v241, 1280, v45
    v_lshl_add_u32 v241, v46, 4, v241
    v_cndmask_b32 v44, 0, v47, vcc
    v_add_u32 v241, v241, v44
    s_add_u32 m0, s74, 9344
    s_nop 0
    buffer_load_dwordx4 v48, s[8:11], 0 offen offset:896 lds
    s_and_b32 s75, s37, 3
    s_mul_i32 s75, s75, 896
    s_bfe_u32 s78, s2, 0x40003
    s_lshl_b32 s78, s78, 2
    s_add_u32 s78, s78, s36
    s_mul_i32 s78, s78, 6912
    s_add_u32 s75, s75, s78
    s_mov_b32 s30, 2211840
    s_mov_b32 s31, 0x00020000
    s_cmp_lt_u32 s38, 2
    s_cselect_b64 s[28:29], s[16:17], s[20:21]
    v_min_u32 v44, 13, v0
    v_mul_u32_u24 v45, 9363, v44
    v_lshrrev_b32 v45, 16, v45
    s_add_u32 m0, s74, 10368
    s_nop 0
    buffer_load_dwordx4 v49, s[8:11], 0 offen offset:896 lds
    v_mul_u32_u24 v45, 2560, v45
    v_lshl_add_u32 v243, v44, 7, v45
    s_add_u32 s53, s52, 32
    v_lshrrev_b32 v21, 1, v21
    v_add3_u32 v22, v20, v21, s53
    s_mul_i32 s55, s36, 3
    s_min_u32 s55, s55, 8
    s_mul_i32 s56, s55, 5120
    s_add_u32 s56, s56, 109568
    s_cmp_lt_u32 s36, 2
    s_cselect_b32 s57, s56, 146432
    s_lshl_b32 s55, s55, 5
    v_add_u32 v25, s56, v1
    s_add_u32 m0, s74, 11904
    s_nop 0
    buffer_load_dwordx4 v48, s[8:11], 0 offen offset:384 lds
    v_and_b32 v26, 2, v0
    v_cvt_f32_u32 v23, v22
    v_cvt_f32_u32 v26, v26
    v_mul_f32 v26, 0x3e000000, v26
    v_mul_f32 v23, 0x3acccccd, v23
    v_lshlrev_b32 v27, 3, v3
    v_cvt_f32_u32 v27, v27
    v_fma_f32 v24, v23, v27, v26
    v_cvt_f32_u32 v26, s55
    v_fma_f32 v24, v26, v23, v24
    v_fract_f32 v24, v24
    v_fmamk_f32 v89, v23, 0x3f800000, v24
    s_add_u32 m0, s74, 12928
    s_nop 0
    buffer_load_dwordx4 v49, s[8:11], 0 offen offset:384 lds
    v_fmamk_f32 v90, v23, 0x40000000, v24
    v_fmamk_f32 v91, v23, 0x40400000, v24
    v_fmamk_f32 v92, v23, 0x40800000, v24
    v_fmamk_f32 v93, v23, 0x40a00000, v24
    v_fmamk_f32 v94, v23, 0x40c00000, v24
    v_fmamk_f32 v95, v23, 0x40e00000, v24
    v_cos_f32 v88, v24
    v_cos_f32 v89, v89
    v_cos_f32 v90, v90
    v_cos_f32 v91, v91
    v_cos_f32 v92, v92
    v_cos_f32 v93, v93
    s_add_u32 m0, s74, 13312
    s_nop 0
    buffer_load_dwordx4 v48, s[8:11], 0 offen offset:1024 lds
    v_cos_f32 v94, v94
    v_cos_f32 v95, v95
    v_fmamk_f32 v24, v23, 0x42000000, v24
    v_mul_f32 v34, 0x42000000, v23
    v_fmamk_f32 v97, v23, 0x3f800000, v24
    v_fmamk_f32 v98, v23, 0x40000000, v24
    v_fmamk_f32 v99, v23, 0x40400000, v24
    v_fmamk_f32 v100, v23, 0x40800000, v24
    v_fmamk_f32 v101, v23, 0x40a00000, v24
    v_fmamk_f32 v102, v23, 0x40c00000, v24
    v_fmamk_f32 v103, v23, 0x40e00000, v24
    v_cos_f32 v96, v24
    s_add_u32 m0, s74, 14336
    s_nop 0
    buffer_load_dwordx4 v49, s[8:11], 0 offen offset:1024 lds
    v_cos_f32 v97, v97
    v_cos_f32 v98, v98
    v_cos_f32 v99, v99
    v_cos_f32 v100, v100
    v_cos_f32 v101, v101
    v_cos_f32 v102, v102
    v_cos_f32 v103, v103
    v_cos_f32 v34, v34
    v_cvt_pk_bf16_f32 v104, v88, v89
    v_cvt_pk_bf16_f32 v105, v90, v91
    v_cvt_pk_bf16_f32 v106, v92, v93
    v_cvt_pk_bf16_f32 v107, v94, v95
    ds_write_b128 v25, v[104:107] offset:0
    s_add_u32 m0, s74, 15872
    s_nop 0
    buffer_load_dwordx4 v48, s[8:11], 0 offen offset:512 lds
    v_cvt_pk_bf16_f32 v108, v96, v97
    v_cvt_pk_bf16_f32 v109, v98, v99
    v_cvt_pk_bf16_f32 v110, v100, v101
    v_cvt_pk_bf16_f32 v111, v102, v103
    ds_write_b128 v25, v[108:111] offset:5120
    v_add_f32 v34, v34, v34
    v_pk_fma_f32 v[88:89], v[96:97], v[34:35], v[88:89] op_sel_hi:[1,0,1] neg_lo:[0,0,1] neg_hi:[0,0,1]
    v_pk_fma_f32 v[90:91], v[98:99], v[34:35], v[90:91] op_sel_hi:[1,0,1] neg_lo:[0,0,1] neg_hi:[0,0,1]
    v_pk_fma_f32 v[92:93], v[100:101], v[34:35], v[92:93] op_sel_hi:[1,0,1] neg_lo:[0,0,1] neg_hi:[0,0,1]
    v_pk_fma_f32 v[94:95], v[102:103], v[34:35], v[94:95] op_sel_hi:[1,0,1] neg_lo:[0,0,1] neg_hi:[0,0,1]
    v_add_u32 v25, s57, v1
    v_cvt_pk_bf16_f32 v104, v88, v89
    s_add_u32 m0, s74, 16896
    s_nop 0
    buffer_load_dwordx4 v49, s[8:11], 0 offen offset:512 lds
    v_cvt_pk_bf16_f32 v105, v90, v91
    v_cvt_pk_bf16_f32 v106, v92, v93
    v_cvt_pk_bf16_f32 v107, v94, v95
    ds_write_b128 v25, v[104:107] offset:10240
    s_mul_i32 s53, s39, 40
    s_add_u32 s53, s53, 40
    v_and_b32 v20, 1, v0
    v_sub_u32 v22, 1, v20
    v_mul_u32_u24 v22, s53, v22
    v_and_b32 v26, 2, v0
    v_cvt_f32_u32 v23, v22
    v_cvt_f32_u32 v26, v26
    s_add_u32 m0, s74, 17280
    s_nop 0
    buffer_load_dwordx4 v48, s[8:11], 0 offen offset:1152 lds
    v_mul_f32 v26, 0x3e000000, v26
    v_mul_f32 v23, 0x3acccccd, v23
    v_lshlrev_b32 v27, 3, v3
    v_cvt_f32_u32 v27, v27
    v_fma_f32 v24, v23, v27, v26
    v_fmamk_f32 v27, v23, 0x3f800000, v24
    v_fmamk_f32 v28, v23, 0x40000000, v24
    v_fmamk_f32 v29, v23, 0x40400000, v24
    v_fmamk_f32 v30, v23, 0x40800000, v24
    v_fmamk_f32 v31, v23, 0x40a00000, v24
    v_fmamk_f32 v32, v23, 0x40c00000, v24
    v_fmamk_f32 v33, v23, 0x40e00000, v24
    s_add_u32 m0, s74, 18304
    s_nop 0
    buffer_load_dwordx4 v49, s[8:11], 0 offen offset:1152 lds
    v_cos_f32 v26, v24
    v_cos_f32 v27, v27
    v_cos_f32 v28, v28
    v_cos_f32 v29, v29
    v_cos_f32 v30, v30
    v_cos_f32 v31, v31
    v_cos_f32 v32, v32
    v_cos_f32 v33, v33
    v_cvt_pk_bf16_f32 v68, v26, v27
    v_cvt_pk_bf16_f32 v69, v28, v29
    v_cvt_pk_bf16_f32 v70, v30, v31
    v_cvt_pk_bf16_f32 v71, v32, v33
    s_add_u32 s49, s75, 0
    buffer_load_dword v15, v243, s[28:31], s49 offen
    s_add_u32 s49, s75, 442368
    buffer_load_dword v15, v243, s[28:31], s49 offen
    s_add_u32 m0, s73, 0
    s_nop 0
    buffer_load_dwordx4 v239, s[24:27], s72 offen lds
    s_add_u32 m0, s73, 1024
    s_nop 0
    buffer_load_dwordx4 v240, s[24:27], s72 offen lds
    s_add_u32 m0, s73, 2048
    s_mov_b32 exec_hi, 0
    buffer_load_dwordx4 v241, s[24:27], s72 offen lds
    s_mov_b32 exec_hi, -1
    s_lshl_b32 s50, s36, 3
    v_lshrrev_b32 v20, 1, v2
    v_add_u32 v20, s50, v20
    v_lshrrev_b32 v21, 1, v20
    v_cmp_eq_u32 vcc, 1, v20
    v_sub_u32 v22, 32, v21
    v_and_b32 v23, 2, v0
    v_cndmask_b32 v22, v22, 16, vcc
    v_cmp_ne_u32 vcc, 0, v23
    v_and_b32 v20, 1, v0
    v_lshl_add_u32 v23, v3, 8, s41
    v_cndmask_b32 v21, v21, v22, vcc
    v_lshl_add_u32 v21, v20, 5, v21
    v_mul_u32_u24 v22, v21, v23
    v_and_b32 v22, 2047, v22
    v_bfe_i32 v20, v21, 0, 1
    v_and_b32 v20, 0x80008000, v20
    v_cvt_f32_u32 v21, v21
    v_cvt_f32_u32 v22, v22
    v_mul_f32 v21, 0x3c800000, v21
    v_mul_f32 v22, 0x3a000000, v22
    v_fmamk_f32 v23, v21, 0x0, v22
    v_fmamk_f32 v24, v21, 0x40000000, v22
    v_cos_f32 v25, v23
    v_cos_f32 v26, v24
    v_sin_f32 v27, v23
    v_sin_f32 v28, v24
    v_cvt_pk_bf16_f32 v52, v25, v26
    v_cvt_pk_bf16_f32 v60, v27, v28
    v_xor_b32 v54, v20, v52
    v_xor_b32 v62, v20, v60
    v_fmamk_f32 v23, v21, 0x40800000, v22
    v_fmamk_f32 v24, v21, 0x40c00000, v22
    v_cos_f32 v25, v23
    v_cos_f32 v26, v24
    v_sin_f32 v27, v23
    v_sin_f32 v28, v24
    v_cvt_pk_bf16_f32 v53, v25, v26
    v_cvt_pk_bf16_f32 v61, v27, v28
    v_xor_b32 v55, v20, v53
    v_xor_b32 v63, v20, v61
    v_fmamk_f32 v23, v21, 0x3f800000, v22
    v_fmamk_f32 v24, v21, 0x40400000, v22
    v_cos_f32 v25, v23
    v_cos_f32 v26, v24
    v_sin_f32 v27, v23
    v_sin_f32 v28, v24
    v_cvt_pk_bf16_f32 v56, v25, v26
    v_cvt_pk_bf16_f32 v64, v27, v28
    v_xor_b32 v58, v20, v56
    v_xor_b32 v66, v20, v64
    v_fmamk_f32 v23, v21, 0x40a00000, v22
    v_fmamk_f32 v24, v21, 0x40e00000, v22
    v_cos_f32 v25, v23
    v_cos_f32 v26, v24
    v_sin_f32 v27, v23
    v_sin_f32 v28, v24
    v_cvt_pk_bf16_f32 v57, v25, v26
    v_cvt_pk_bf16_f32 v65, v27, v28
    v_xor_b32 v59, v20, v57
    v_xor_b32 v67, v20, v65
    s_mul_i32 s50, s39, 5
    s_sub_u32 s51, 35, s50
    s_add_u32 s52, s50, 4
    s_add_u32 s53, s51, 4
    v_lshl_add_u32 v44, v2, 7, s74
    s_waitcnt vmcnt(26)
    v_add_u32 v13, s50, v3
    v_add_u32 v14, s51, v3
    v_mov_b32 v28, s52
    v_mov_b32 v45, s53
    v_cndmask_b32 v28, v45, v28, s[66:67]
    v_xor_b32 v45, v13, v2
    v_lshrrev_b32 v13, 3, v13
    v_and_b32 v45, 7, v45
    v_lshl_add_u32 v13, v13, 12, v44
    v_lshl_add_u32 v13, v45, 4, v13
    v_xor_b32 v45, v14, v2
    v_lshrrev_b32 v14, 3, v14
    v_and_b32 v45, 7, v45
    v_lshl_add_u32 v14, v14, 12, v44
    v_lshl_add_u32 v14, v45, 4, v14
    v_xor_b32 v45, v28, v2
    v_lshrrev_b32 v28, 3, v28
    v_and_b32 v45, 7, v45
    v_lshl_add_u32 v28, v28, 12, v44
    v_lshl_add_u32 v28, v45, 4, v28
    v_lshrrev_b32 v45, 1, v3
    v_lshl_add_u32 v28, v45, 11, v28
    v_and_b32 v45, 1, v3
    v_lshl_add_u32 v28, v45, 3, v28
    v_add_u32 v8, 105472, v1
    s_waitcnt vmcnt(21)
    ds_read_b128 v[132:135], v50 offset:0
    ds_read_b128 v[140:143], v51 offset:0
    ds_read_b128 v[136:139], v50 offset:2048
    ds_read_b128 v[144:147], v51 offset:2048
    s_waitcnt lgkmcnt(4)
    s_barrier
    ds_read_b128 v[72:75], v8 offset:0
    ds_read_b128 v[76:79], v8 offset:1024
    ds_read_b128 v[80:83], v8 offset:2048
    ds_read_b128 v[84:87], v8 offset:3072
    ds_read_b128 v[16:19], v8 offset:4096
    ds_read_b128 v[20:23], v8 offset:5120
    s_waitcnt lgkmcnt(9)
    v_mfma_f32_16x16x32_bf16 v[228:231], v[132:135], v[132:135], 0
    s_waitcnt vmcnt(17)
    ds_read_b128 v[148:151], v50 offset:4096
    v_add_u32 v32, 0, v0
    s_waitcnt lgkmcnt(8)
    v_mfma_f32_16x16x32_bf16 v[228:231], v[136:139], v[136:139], v[228:231]
    ds_read_b128 v[156:159], v51 offset:4096
    v_mul_u32_u24 v33, 9363, v32
    v_mfma_f32_16x16x32_bf16 v[228:231], v[140:143], v[140:143], v[228:231]
    ds_read_b128 v[152:155], v50 offset:6144
    v_lshrrev_b32 v33, 16, v33
    s_waitcnt lgkmcnt(9)
    v_mfma_f32_16x16x32_bf16 v[228:231], v[144:147], v[144:147], v[228:231]
    ds_read_b128 v[160:163], v51 offset:6144
    v_mul_u32_u24 v33, 3344, v33
    v_mfma_f32_16x16x32_bf16 v[128:131], v[132:135], v[68:71], 0
    v_lshl_add_u32 v232, v32, 4, v33
    v_add_u32 v32, 64, v0
    v_mfma_f32_16x16x32_bf16 v[128:131], v[136:139], v[68:71], v[128:131]
    s_mul_i32 s78, s36, 221184
    v_mul_u32_u24 v33, 9363, v32
    v_lshrrev_b32 v33, 16, v33
    v_mfma_f32_16x16x32_bf16 v[128:131], v[140:143], v[68:71], v[128:131]
    s_mul_i32 s79, s42, 112
    v_mul_u32_u24 v33, 3344, v33
    v_lshl_add_u32 v233, v32, 4, v33
    v_mfma_f32_16x16x32_bf16 v[128:131], v[144:147], v[68:71], v[128:131]
    s_waitcnt lgkmcnt(9)
    v_add_u32 v32, 128, v0
    v_mul_u32_u24 v33, 9363, v32
    v_mfma_f32_16x16x32_bf16 v[88:91], v[132:135], v[72:75], 0
    ds_read_b128 v[24:27], v8 offset:6144
    v_lshrrev_b32 v33, 16, v33
    v_mfma_f32_16x16x32_bf16 v[108:111], v[136:139], v[72:75], 0
    s_waitcnt lgkmcnt(9)
    v_mul_u32_u24 v33, 3344, v33
    v_lshl_add_u32 v234, v32, 4, v33
    v_mfma_f32_16x16x32_bf16 v[92:95], v[132:135], v[76:79], 0
    ds_read_b128 v[72:75], v8 offset:7168
    v_add_u32 v32, 192, v0
    v_mfma_f32_16x16x32_bf16 v[112:115], v[136:139], v[76:79], 0
    s_waitcnt lgkmcnt(9)
    v_mul_u32_u24 v33, 9363, v32
    v_lshrrev_b32 v33, 16, v33
    v_mfma_f32_16x16x32_bf16 v[96:99], v[132:135], v[80:83], 0
    ds_read_b128 v[76:79], v8 offset:8192
    v_mul_u32_u24 v33, 3344, v33
    v_mfma_f32_16x16x32_bf16 v[116:119], v[136:139], v[80:83], 0
    s_waitcnt lgkmcnt(9)
    v_lshl_add_u32 v235, v32, 4, v33
    v_add_u32 v32, 256, v0
    v_mfma_f32_16x16x32_bf16 v[100:103], v[132:135], v[84:87], 0
    ds_read_b128 v[80:83], v8 offset:9216
    v_mul_u32_u24 v33, 9363, v32
    v_mfma_f32_16x16x32_bf16 v[120:123], v[136:139], v[84:87], 0
    s_waitcnt lgkmcnt(9)
    v_lshrrev_b32 v33, 16, v33
    v_mul_u32_u24 v33, 3344, v33
    v_mfma_f32_16x16x32_bf16 v[104:107], v[132:135], v[16:19], 0
    ds_read_b128 v[84:87], v8 offset:10240
    v_lshl_add_u32 v236, v32, 4, v33
    v_mfma_f32_16x16x32_bf16 v[124:127], v[136:139], v[16:19], 0
    s_add_u32 s78, s78, s79
    v_add_u32 v32, 320, v0
    v_mul_u32_u24 v33, 9363, v32
    s_waitcnt lgkmcnt(8)
    v_mfma_f32_16x16x32_bf16 v[228:231], v[148:151], v[148:151], v[228:231]
    s_waitcnt vmcnt(13)
    ds_read_b128 v[164:167], v50 offset:8192
    v_lshrrev_b32 v33, 16, v33
    s_waitcnt lgkmcnt(7)
    v_mfma_f32_16x16x32_bf16 v[228:231], v[152:155], v[152:155], v[228:231]
    ds_read_b128 v[172:175], v51 offset:8192
    v_mul_u32_u24 v33, 3344, v33
    v_mfma_f32_16x16x32_bf16 v[228:231], v[156:159], v[156:159], v[228:231]
    ds_read_b128 v[168:171], v50 offset:10240
    v_lshl_add_u32 v237, v32, 4, v33
    s_waitcnt lgkmcnt(8)
    v_mfma_f32_16x16x32_bf16 v[228:231], v[160:163], v[160:163], v[228:231]
    ds_read_b128 v[176:179], v51 offset:10240
    v_add_u32 v32, 384, v0
    v_mfma_f32_16x16x32_bf16 v[128:131], v[148:151], v[68:71], v[128:131]
    s_mul_i32 s79, s36, 14336
    v_mul_u32_u24 v33, 9363, v32
    v_lshrrev_b32 v33, 16, v33
    v_mfma_f32_16x16x32_bf16 v[128:131], v[152:155], v[68:71], v[128:131]
    s_lshl_b32 s50, s40, 2
    v_mul_u32_u24 v33, 3344, v33
    v_lshl_add_u32 v238, v32, 4, v33
    v_mfma_f32_16x16x32_bf16 v[128:131], v[156:159], v[68:71], v[128:131]
    s_add_u32 s50, s50, s36
    s_min_u32 s50, s50, 99
    s_lshl_b32 s50, s50, 9
    v_mfma_f32_16x16x32_bf16 v[128:131], v[160:163], v[68:71], v[128:131]
    v_add_u32 v38, s50, v8
    s_mul_i32 s51, s39, 51200
    v_mfma_f32_16x16x32_bf16 v[88:91], v[140:143], v[20:23], v[88:91]
    ds_read_b128 v[16:19], v8 offset:11264
    s_add_u32 s50, s50, s51
    v_mfma_f32_16x16x32_bf16 v[108:111], v[144:147], v[20:23], v[108:111]
    s_waitcnt lgkmcnt(9)
    s_add_u32 s71, s50, 38207488
    v_mov_b32 v39, 0x10000000
    v_mfma_f32_16x16x32_bf16 v[92:95], v[140:143], v[24:27], v[92:95]
    ds_read_b128 v[20:23], v8 offset:12288
    v_cndmask_b32 v39, v39, v1, s[66:67]
    v_mfma_f32_16x16x32_bf16 v[112:115], v[144:147], v[24:27], v[112:115]
    s_waitcnt lgkmcnt(9)
    ds_read_b128 v[40:43], v38
    v_bfe_u32 v32, v0, 2, 2
    v_mfma_f32_16x16x32_bf16 v[96:99], v[140:143], v[72:75], v[96:99]
    ds_read_b128 v[24:27], v8 offset:13312
    v_and_b32 v33, 1, v3
    v_mfma_f32_16x16x32_bf16 v[116:119], v[144:147], v[72:75], v[116:119]
    s_waitcnt lgkmcnt(10)
    s_add_u32 s49, s75, 884736
    buffer_load_dword v15, v243, s[28:31], s49 offen
    v_mfma_f32_16x16x32_bf16 v[100:103], v[140:143], v[76:79], v[100:103]
    ds_read_b128 v[72:75], v8 offset:14336
    v_lshl_add_u32 v32, v33, 3, v32
    v_mfma_f32_16x16x32_bf16 v[120:123], v[144:147], v[76:79], v[120:123]
    s_waitcnt lgkmcnt(10)
    s_waitcnt lgkmcnt(2)
    buffer_store_dwordx4 v[40:43], v39, s[4:7], s71 offen sc1
    v_mfma_f32_16x16x32_bf16 v[104:107], v[140:143], v[80:83], v[104:107]
    ds_read_b128 v[76:79], v8 offset:15360
    v_mul_u32_u24 v32, 160, v32
    v_mfma_f32_16x16x32_bf16 v[124:127], v[144:147], v[80:83], v[124:127]
    s_lshr_b32 s76, s48, 1
    v_add_u32 v32, s73, v32
    v_and_b32 v34, 3, v0
    v_mfma_f32_16x16x32_bf16 v[228:231], v[164:167], v[164:167], v[228:231]
    s_waitcnt vmcnt(11)
    ds_read_b128 v[180:183], v50 offset:12288
    v_lshrrev_b32 v35, 1, v3
    v_mfma_f32_16x16x32_bf16 v[228:231], v[168:171], v[168:171], v[228:231]
    ds_read_b128 v[188:191], v51 offset:12288
    v_lshl_add_u32 v212, v34, 4, v32
    v_mfma_f32_16x16x32_bf16 v[228:231], v[172:175], v[172:175], v[228:231]
    ds_read_b128 v[184:187], v50 offset:14336
    v_lshl_add_u32 v212, v35, 3, v212
    v_mfma_f32_16x16x32_bf16 v[228:231], v[176:179], v[176:179], v[228:231]
    ds_read_b128 v[192:195], v51 offset:14336
    v_and_b32 v36, 1, v0
    v_mfma_f32_16x16x32_bf16 v[128:131], v[164:167], v[68:71], v[128:131]
    s_mul_i32 s76, s76, 5120
    v_lshl_add_u32 v213, v36, 3, v32
    v_bfe_u32 v36, v0, 1, 1
    v_mfma_f32_16x16x32_bf16 v[128:131], v[168:171], v[68:71], v[128:131]
    s_and_b32 s77, s48, 1
    v_mul_u32_u24 v36, 80, v36
    v_add_u32 v213, v213, v36
    v_mfma_f32_16x16x32_bf16 v[128:131], v[172:175], v[68:71], v[128:131]
    s_lshl_b32 s77, s77, 9
    v_lshlrev_b32 v215, 4, v2
    v_lshl_add_u32 v215, v33, 8, v215
    v_mfma_f32_16x16x32_bf16 v[128:131], v[176:179], v[68:71], v[128:131]
    v_lshl_add_u32 v214, v35, 10, v215
    v_lshl_add_u32 v215, v35, 28, v215
    v_mfma_f32_16x16x32_bf16 v[88:91], v[148:151], v[84:87], v[88:91]
    ds_read_b128 v[80:83], v8 offset:16384
    s_add_u32 s76, s76, s77
    v_mfma_f32_16x16x32_bf16 v[108:111], v[152:155], v[84:87], v[108:111]
    s_mul_i32 s77, s39, 286720
    s_add_u32 s76, s76, s77
    v_mfma_f32_16x16x32_bf16 v[92:95], v[148:151], v[16:19], v[92:95]
    ds_read_b128 v[84:87], v8 offset:17408
    s_add_u32 s76, s76, 6684672
    v_mfma_f32_16x16x32_bf16 v[112:115], v[152:155], v[16:19], v[112:115]
    s_cmp_lt_u32 s46, 28
    s_cselect_b32 s76, s76, 0x10000000
    s_add_u32 s77, s76, 4096
    v_mfma_f32_16x16x32_bf16 v[96:99], v[148:151], v[20:23], v[96:99]
    ds_read_b128 v[16:19], v8 offset:18432
    v_and_b32 v29, 1, v0
    v_mfma_f32_16x16x32_bf16 v[116:119], v[152:155], v[20:23], v[116:119]
    s_waitcnt lgkmcnt(9)
    v_cvt_f32_u32 v29, v29
    v_fma_f32 v29, v29, -2.0, 1.0
    v_mfma_f32_16x16x32_bf16 v[100:103], v[148:151], v[24:27], v[100:103]
    ds_read_b128 v[20:23], v8 offset:19456
    s_and_b32 s50, s36, 1
    v_mfma_f32_16x16x32_bf16 v[120:123], v[152:155], v[24:27], v[120:123]
    s_waitcnt lgkmcnt(9)
    s_add_u32 s49, s75, 1327104
    buffer_load_dword v15, v243, s[28:31], s49 offen
    v_mfma_f32_16x16x32_bf16 v[104:107], v[148:151], v[72:75], v[104:107]
    ds_read_b128 v[24:27], v8 offset:20480
    s_lshl_b32 s50, s50, 3
    v_mfma_f32_16x16x32_bf16 v[124:127], v[152:155], v[72:75], v[124:127]
    s_lshr_b32 s51, s36, 1
    s_lshl_b32 s51, s51, 10
    s_add_u32 s50, s50, s51
    s_waitcnt lgkmcnt(8)
    v_mfma_f32_16x16x32_bf16 v[228:231], v[180:183], v[180:183], v[228:231]
    s_waitcnt vmcnt(8)
    ds_read_b128 v[196:199], v50 offset:16384
    v_add_u32 v10, 93184, v1
    s_waitcnt lgkmcnt(7)
    v_mfma_f32_16x16x32_bf16 v[228:231], v[184:187], v[184:187], v[228:231]
    ds_read_b128 v[204:207], v51 offset:16384
    v_add_u32 v9, s50, v10
    v_mfma_f32_16x16x32_bf16 v[228:231], v[188:191], v[188:191], v[228:231]
    ds_read_b128 v[200:203], v50 offset:18432
    s_lshl_b32 s50, s40, 3
    s_waitcnt lgkmcnt(8)
    v_mfma_f32_16x16x32_bf16 v[228:231], v[192:195], v[192:195], v[228:231]
    ds_read_b128 v[208:211], v51 offset:18432
    s_add_u32 s50, s50, s39
    v_mfma_f32_16x16x32_bf16 v[128:131], v[180:183], v[68:71], v[128:131]
    ds_read_b128 v[248:251], v13
    s_mul_i32 s50, s50, 12288
    v_mfma_f32_16x16x32_bf16 v[128:131], v[184:187], v[68:71], v[128:131]
    ds_read_b128 v[252:255], v14 offset:2048
    s_lshl_b32 s51, s36, 10
    v_mfma_f32_16x16x32_bf16 v[128:131], v[188:191], v[68:71], v[128:131]
    ds_read_b64 v[6:7], v28
    s_add_u32 s50, s50, s51
    v_mfma_f32_16x16x32_bf16 v[128:131], v[192:195], v[68:71], v[128:131]
    s_add_u32 s70, s50, 8978432
    s_add_u32 s60, s70, 4096
    v_mfma_f32_16x16x32_bf16 v[88:91], v[156:159], v[76:79], v[88:91]
    ds_read_b128 v[72:75], v8 offset:21504
    s_add_u32 s61, s70, 8192
    v_mfma_f32_16x16x32_bf16 v[108:111], v[160:163], v[76:79], v[108:111]
    s_waitcnt lgkmcnt(12)
    v_lshlrev_b32 v12, 6, v2
    v_lshl_add_u32 v12, v3, 4, v12
    v_mfma_f32_16x16x32_bf16 v[92:95], v[156:159], v[80:83], v[92:95]
    ds_read_b128 v[76:79], v8 offset:22528
    v_lshlrev_b32 v31, 2, v3
    v_mfma_f32_16x16x32_bf16 v[112:115], v[160:163], v[80:83], v[112:115]
    s_waitcnt lgkmcnt(12)
    v_sub_u32 v31, v2, v31
    v_mov_b32 v30, 0
    v_mfma_f32_16x16x32_bf16 v[96:99], v[156:159], v[84:87], v[96:99]
    ds_read_b128 v[80:83], v8 offset:23552
    v_cmp_eq_u32 s[52:53], 0, v31
    v_mfma_f32_16x16x32_bf16 v[116:119], v[160:163], v[84:87], v[116:119]
    s_waitcnt lgkmcnt(12)
    v_cmp_eq_u32 s[54:55], 1, v31
    v_cmp_eq_u32 s[56:57], 2, v31
    v_mfma_f32_16x16x32_bf16 v[100:103], v[156:159], v[16:19], v[100:103]
    s_waitcnt lgkmcnt(3)
    s_barrier
    ds_read_b128 v[84:87], v8 offset:24576
    v_mfma_f32_16x16x32_bf16 v[120:123], v[160:163], v[16:19], v[120:123]
    v_cmp_eq_u32 s[58:59], 3, v31
    v_mov_b32 v31, 1.0
    v_mfma_f32_16x16x32_bf16 v[104:107], v[156:159], v[20:23], v[104:107]
    ds_read_b128 v[16:19], v8 offset:25600
    v_mfma_f32_16x16x32_bf16 v[124:127], v[160:163], v[20:23], v[124:127]
    s_add_u32 s49, s75, 1769472
    buffer_load_dword v15, v243, s[28:31], s49 offen
    v_mfma_f32_16x16x32_bf16 v[228:231], v[196:199], v[196:199], v[228:231]
    v_mfma_f32_16x16x32_bf16 v[228:231], v[200:203], v[200:203], v[228:231]
    v_mfma_f32_16x16x32_bf16 v[228:231], v[204:207], v[204:207], v[228:231]
    v_mfma_f32_16x16x32_bf16 v[228:231], v[208:211], v[208:211], v[228:231]
    s_add_u32 m0, s79, 0
    v_mfma_f32_16x16x32_bf16 v[128:131], v[196:199], v[68:71], v[128:131]
    buffer_load_dwordx4 v232, s[16:19], s78 offen lds
    v_mfma_f32_16x16x32_bf16 v[128:131], v[200:203], v[68:71], v[128:131]
    v_mfma_f32_16x16x32_bf16 v[128:131], v[204:207], v[68:71], v[128:131]
    s_nop 1
    v_mfma_f32_16x16x32_bf16 v[128:131], v[208:211], v[68:71], v[128:131]
    v_cndmask_b32 v30, v30, v228, s[52:53]
    v_cndmask_b32 v30, v30, v229, s[54:55]
    v_mfma_f32_16x16x32_bf16 v[88:91], v[164:167], v[24:27], v[88:91]
    ds_read_b128 v[20:23], v8 offset:26624
    v_cndmask_b32 v30, v30, v230, s[56:57]
    v_mfma_f32_16x16x32_bf16 v[108:111], v[168:171], v[24:27], v[108:111]
    s_waitcnt lgkmcnt(5)
    v_cndmask_b32 v30, v30, v231, s[58:59]
    v_mfma_f32_16x16x32_bf16 v[92:95], v[164:167], v[72:75], v[92:95]
    ds_read_b128 v[24:27], v8 offset:27648
    v_mfma_f32_16x16x32_bf16 v[112:115], v[168:171], v[72:75], v[112:115]
    s_waitcnt vmcnt(5)
    s_waitcnt lgkmcnt(5)
    v_mfma_f32_16x16x4_f32 v[44:47], v30, v31, 0
    v_mfma_f32_16x16x32_bf16 v[96:99], v[164:167], v[76:79], v[96:99]
    ds_read_b128 v[72:75], v8 offset:28672
    v_mov_b32_dpp v40, v128 quad_perm:[1,1,1,1] row_mask:0xf bank_mask:0xf
    v_mfma_f32_16x16x32_bf16 v[116:119], v[168:171], v[76:79], v[116:119]
    s_waitcnt lgkmcnt(5)
    ds_read_b64_tr_b16 v[216:217], v212 offset:0
    ds_read_b64_tr_b16 v[218:219], v212 offset:640
    v_mfma_f32_16x16x32_bf16 v[100:103], v[164:167], v[80:83], v[100:103]
    ds_read_b128 v[76:79], v8 offset:29696
    v_mov_b32_dpp v41, v129 quad_perm:[1,1,1,1] row_mask:0xf bank_mask:0xf
    v_mfma_f32_16x16x32_bf16 v[120:123], v[168:171], v[80:83], v[120:123]
    s_waitcnt lgkmcnt(7)
    ds_read_b64_tr_b16 v[220:221], v212 offset:80
    ds_read_b64_tr_b16 v[222:223], v212 offset:720
    v_mfma_f32_16x16x32_bf16 v[104:107], v[164:167], v[84:87], v[104:107]
    ds_read_b128 v[80:83], v8 offset:30720
    v_mov_b32_dpp v42, v130 quad_perm:[1,1,1,1] row_mask:0xf bank_mask:0xf
    v_mfma_f32_16x16x32_bf16 v[124:127], v[168:171], v[84:87], v[124:127]
    s_waitcnt lgkmcnt(9)
    ds_read_b64_tr_b16 v[224:225], v213 offset:64
    ds_read_b64_tr_b16 v[226:227], v213 offset:704
    v_mfma_f32_16x16x32_bf16 v[88:91], v[172:175], v[16:19], v[88:91]
    s_add_u32 m0, s79, 1024
    ds_read_b128 v[84:87], v8 offset:31744
    v_mov_b32_dpp v43, v131 quad_perm:[1,1,1,1] row_mask:0xf bank_mask:0xf
    v_mfma_f32_16x16x32_bf16 v[108:111], v[176:179], v[16:19], v[108:111]
    s_waitcnt lgkmcnt(11)
    buffer_load_dwordx4 v233, s[16:19], s78 offen lds
    v_mfma_f32_16x16x32_bf16 v[92:95], v[172:175], v[20:23], v[92:95]
    s_add_u32 m0, s79, 2048
    ds_read_b128 v[16:19], v8 offset:32768
    v_mul_f32 v40, 0x3acccccd, v40
    v_mfma_f32_16x16x32_bf16 v[112:115], v[176:179], v[20:23], v[112:115]
    s_waitcnt lgkmcnt(11)
    buffer_load_dwordx4 v234, s[16:19], s78 offen lds
    v_mfma_f32_16x16x32_bf16 v[96:99], v[172:175], v[24:27], v[96:99]
    ds_read_b128 v[20:23], v8 offset:33792
    v_mul_f32 v41, 0x3acccccd, v41
    v_mfma_f32_16x16x32_bf16 v[116:119], v[176:179], v[24:27], v[116:119]
    s_waitcnt lgkmcnt(11)
    s_waitcnt lgkmcnt(9)
    buffer_store_dwordx4 v[216:219], v214, s[4:7], s76 offen offset:0 sc1
    v_mfma_f32_16x16x32_bf16 v[100:103], v[172:175], v[72:75], v[100:103]
    ds_read_b128 v[24:27], v8 offset:34816
    v_mul_f32 v42, 0x3acccccd, v42
    v_mfma_f32_16x16x32_bf16 v[120:123], v[176:179], v[72:75], v[120:123]
    s_waitcnt lgkmcnt(9)
    v_mul_f32 v43, 0x3acccccd, v43
    v_mul_f32 v44, 0x3acccccd, v44
    v_mfma_f32_16x16x32_bf16 v[104:107], v[172:175], v[76:79], v[104:107]
    ds_read_b128 v[72:75], v8 offset:39936
    v_mul_f32 v45, 0x3acccccd, v45
    v_mfma_f32_16x16x32_bf16 v[124:127], v[176:179], v[76:79], v[124:127]
    s_waitcnt lgkmcnt(7)
    v_mul_f32 v46, 0x3acccccd, v46
    v_mul_f32 v47, 0x3acccccd, v47
    v_mfma_f32_16x16x32_bf16 v[88:91], v[180:183], v[80:83], v[88:91]
    s_add_u32 m0, s79, 3072
    ds_read_b128 v[76:79], v8 offset:45056
    v_fma_f32 v44, -v40, v40, v44
    v_mfma_f32_16x16x32_bf16 v[108:111], v[184:187], v[80:83], v[108:111]
    s_waitcnt lgkmcnt(5)
    buffer_load_dwordx4 v235, s[16:19], s78 offen lds
    v_mfma_f32_16x16x32_bf16 v[92:95], v[180:183], v[84:87], v[92:95]
    ds_read_b128 v[80:83], v8 offset:50176
    v_fma_f32 v45, -v41, v41, v45
    v_mfma_f32_16x16x32_bf16 v[112:115], v[184:187], v[84:87], v[112:115]
    s_waitcnt lgkmcnt(5)
    buffer_store_dwordx4 v[220:223], v214, s[4:7], s76 offen offset:2048 sc1
    v_mfma_f32_16x16x32_bf16 v[96:99], v[180:183], v[16:19], v[96:99]
    ds_read_b128 v[84:87], v8 offset:35840
    v_fma_f32 v46, -v42, v42, v46
    v_mfma_f32_16x16x32_bf16 v[116:119], v[184:187], v[16:19], v[116:119]
    s_waitcnt lgkmcnt(5)
    v_fma_f32 v47, -v43, v43, v47
    v_max_f32 v44, 0, v44
    v_mfma_f32_16x16x32_bf16 v[100:103], v[180:183], v[20:23], v[100:103]
    ds_read_b128 v[16:19], v8 offset:40960
    v_max_f32 v45, 0, v45
    v_mfma_f32_16x16x32_bf16 v[120:123], v[184:187], v[20:23], v[120:123]
    s_waitcnt lgkmcnt(5)
    v_max_f32 v46, 0, v46
    v_max_f32 v47, 0, v47
    v_mfma_f32_16x16x32_bf16 v[104:107], v[180:183], v[24:27], v[104:107]
    s_add_u32 m0, s79, 4096
    ds_read_b128 v[20:23], v8 offset:46080
    v_add_f32 v44, 0x3727c5ac, v44
    v_mfma_f32_16x16x32_bf16 v[124:127], v[184:187], v[24:27], v[124:127]
    s_waitcnt lgkmcnt(5)
    buffer_load_dwordx4 v236, s[16:19], s78 offen lds
    v_mfma_f32_16x16x32_bf16 v[104:107], v[188:191], v[72:75], v[104:107]
    ds_read_b128 v[24:27], v8 offset:36864
    v_add_f32 v45, 0x3727c5ac, v45
    v_mfma_f32_16x16x32_bf16 v[124:127], v[192:195], v[72:75], v[124:127]
    s_waitcnt lgkmcnt(5)
    buffer_store_dwordx4 v[224:227], v215, s[4:7], s77 offen offset:0 sc1
    v_mfma_f32_16x16x32_bf16 v[104:107], v[196:199], v[76:79], v[104:107]
    ds_read_b128 v[72:75], v8 offset:41984
    v_add_f32 v46, 0x3727c5ac, v46
    v_mfma_f32_16x16x32_bf16 v[124:127], v[200:203], v[76:79], v[124:127]
    s_waitcnt lgkmcnt(5)
    v_rsq_f32 v44, v44
    v_mfma_f32_16x16x32_bf16 v[104:107], v[204:207], v[80:83], v[104:107]
    ds_read_b128 v[76:79], v8 offset:47104
    v_add_f32 v47, 0x3727c5ac, v47
    v_mfma_f32_16x16x32_bf16 v[124:127], v[208:211], v[80:83], v[124:127]
    s_waitcnt lgkmcnt(5)
    v_rsq_f32 v45, v45
    v_mfma_f32_16x16x32_bf16 v[88:91], v[188:191], v[84:87], v[88:91]
    s_add_u32 m0, s79, 5120
    ds_read_b128 v[80:83], v8 offset:37888
    v_mul_f32 v128, v128, v44
    v_mfma_f32_16x16x32_bf16 v[108:111], v[192:195], v[84:87], v[108:111]
    s_waitcnt lgkmcnt(5)
    buffer_load_dwordx4 v237, s[16:19], s78 offen lds
    v_mfma_f32_16x16x32_bf16 v[88:91], v[196:199], v[16:19], v[88:91]
    ds_read_b128 v[84:87], v8 offset:43008
    v_mul_f32 v129, v129, v45
    v_mfma_f32_16x16x32_bf16 v[108:111], v[200:203], v[16:19], v[108:111]
    s_waitcnt lgkmcnt(5)
    v_rsq_f32 v46, v46
    v_mfma_f32_16x16x32_bf16 v[88:91], v[204:207], v[20:23], v[88:91]
    ds_read_b128 v[16:19], v8 offset:48128
    v_mul_f32 v130, v130, v46
    v_mfma_f32_16x16x32_bf16 v[108:111], v[208:211], v[20:23], v[108:111]
    s_waitcnt lgkmcnt(5)
    v_rsq_f32 v47, v47
    v_mfma_f32_16x16x32_bf16 v[92:95], v[188:191], v[24:27], v[92:95]
    ds_read_b128 v[20:23], v8 offset:38912
    v_mul_f32 v131, v131, v47
    v_mfma_f32_16x16x32_bf16 v[112:115], v[192:195], v[24:27], v[112:115]
    s_waitcnt lgkmcnt(5)
    v_cvt_pk_bf16_f32 v128, v128, v129
    v_cvt_pk_bf16_f32 v129, v130, v131
    v_mfma_f32_16x16x32_bf16 v[92:95], v[196:199], v[72:75], v[92:95]
    s_add_u32 m0, s79, 6144
    ds_read_b128 v[24:27], v8 offset:44032
    v_fmac_f32 v104, v29, v124
    v_mfma_f32_16x16x32_bf16 v[112:115], v[200:203], v[72:75], v[112:115]
    s_waitcnt lgkmcnt(5)
    buffer_load_dwordx4 v238, s[16:19], s78 offen lds
    v_mfma_f32_16x16x32_bf16 v[92:95], v[204:207], v[76:79], v[92:95]
    ds_read_b128 v[72:75], v8 offset:49152
    v_fmac_f32 v105, v29, v125
    v_mfma_f32_16x16x32_bf16 v[112:115], v[208:211], v[76:79], v[112:115]
    s_waitcnt lgkmcnt(5)
    ds_write_b64 v9, v[128:129] offset:10240
    v_mfma_f32_16x16x32_bf16 v[96:99], v[188:191], v[80:83], v[96:99]
    v_fmac_f32 v106, v29, v126
    v_fmac_f32 v107, v29, v127
    v_mfma_f32_16x16x32_bf16 v[116:119], v[192:195], v[80:83], v[116:119]
    s_waitcnt lgkmcnt(5)
    v_mul_f32 v104, v104, v44
    v_mul_f32 v105, v105, v45
    v_mfma_f32_16x16x32_bf16 v[96:99], v[196:199], v[84:87], v[96:99]
    v_mul_f32 v106, v106, v46
    v_mul_f32 v107, v107, v47
    v_mfma_f32_16x16x32_bf16 v[116:119], v[200:203], v[84:87], v[116:119]
    s_add_u32 m0, s79, 7168
    s_waitcnt lgkmcnt(4)
    v_cvt_pk_bf16_f32 v104, v104, v105
    v_cvt_pk_bf16_f32 v105, v106, v107
    v_mfma_f32_16x16x32_bf16 v[96:99], v[204:207], v[16:19], v[96:99]
    buffer_load_dwordx4 v232, s[20:23], s78 offen lds
    v_mfma_f32_16x16x32_bf16 v[116:119], v[208:211], v[16:19], v[116:119]
    s_waitcnt lgkmcnt(3)
    ds_write_b64 v9, v[104:105] offset:8192
    v_mfma_f32_16x16x32_bf16 v[100:103], v[188:191], v[20:23], v[100:103]
    v_fmac_f32 v88, v29, v108
    v_fmac_f32 v89, v29, v109
    v_mfma_f32_16x16x32_bf16 v[120:123], v[192:195], v[20:23], v[120:123]
    s_waitcnt lgkmcnt(3)
    v_fmac_f32 v90, v29, v110
    v_fmac_f32 v91, v29, v111
    v_mfma_f32_16x16x32_bf16 v[100:103], v[196:199], v[24:27], v[100:103]
    v_mul_f32 v88, v88, v44
    v_mul_f32 v89, v89, v45
    v_mfma_f32_16x16x32_bf16 v[120:123], v[200:203], v[24:27], v[120:123]
    s_waitcnt lgkmcnt(2)
    s_waitcnt lgkmcnt(0)
    s_barrier
    ds_read_b128 v[164:167], v10 offset:8192
    v_mfma_f32_16x16x32_bf16 v[100:103], v[204:207], v[72:75], v[100:103]
    ds_read_b128 v[168:171], v10 offset:9216
    v_mul_f32 v90, v90, v46
    v_mfma_f32_16x16x32_bf16 v[120:123], v[208:211], v[72:75], v[120:123]
    ds_read_b128 v[172:175], v10 offset:10240
    v_mul_f32 v91, v91, v47
    ds_read_b128 v[176:179], v10 offset:11264
    s_waitcnt lgkmcnt(3)
    v_mfma_f32_16x16x32_bf16 v[180:183], v[164:167], v[52:55], 0
    v_cvt_pk_bf16_f32 v88, v88, v89
    v_cvt_pk_bf16_f32 v89, v90, v91
    v_mfma_f32_16x16x32_bf16 v[184:187], v[164:167], v[60:63], 0
    s_add_u32 m0, s79, 8192
    ds_write_b64 v9, v[88:89] offset:0
    s_waitcnt lgkmcnt(3)
    v_mfma_f32_16x16x32_bf16 v[180:183], v[168:171], v[56:59], v[180:183]
    buffer_load_dwordx4 v233, s[20:23], s78 offen lds
    v_mfma_f32_16x16x32_bf16 v[184:187], v[168:171], v[64:67], v[184:187]
    v_fmac_f32 v92, v29, v112
    v_fmac_f32 v93, v29, v113
    s_waitcnt lgkmcnt(2)
    v_mfma_f32_16x16x32_bf16 v[188:191], v[172:175], v[52:55], 0
    v_fmac_f32 v94, v29, v114
    v_fmac_f32 v95, v29, v115
    v_mfma_f32_16x16x32_bf16 v[192:195], v[172:175], v[60:63], 0
    s_add_u32 m0, s79, 9216
    v_mul_f32 v92, v92, v44
    v_mul_f32 v93, v93, v45
    s_waitcnt lgkmcnt(1)
    v_mfma_f32_16x16x32_bf16 v[188:191], v[176:179], v[56:59], v[188:191]
    buffer_load_dwordx4 v234, s[20:23], s78 offen lds
    v_mfma_f32_16x16x32_bf16 v[192:195], v[176:179], v[64:67], v[192:195]
    v_mul_f32 v94, v94, v46
    v_mul_f32 v95, v95, v47
    v_cvt_pk_bf16_f32 v92, v92, v93
    v_cvt_pk_bf16_f32 v93, v94, v95
    ds_write_b64 v9, v[92:93] offset:2048
    s_waitcnt lgkmcnt(0)
    s_barrier
    ds_read_b128 v[132:135], v10 offset:0
    ds_read_b128 v[136:139], v10 offset:1024
    ds_read_b128 v[140:143], v10 offset:2048
    ds_read_b128 v[144:147], v10 offset:3072
    s_waitcnt lgkmcnt(3)
    v_mfma_f32_16x16x32_bf16 v[196:199], v[132:135], v[52:55], 0
    v_fmac_f32 v96, v29, v116
    v_fmac_f32 v97, v29, v117
    v_mfma_f32_16x16x32_bf16 v[200:203], v[132:135], v[60:63], 0
    v_fmac_f32 v98, v29, v118
    v_fmac_f32 v99, v29, v119
    s_waitcnt lgkmcnt(2)
    v_mfma_f32_16x16x32_bf16 v[196:199], v[136:139], v[56:59], v[196:199]
    v_mul_f32 v96, v96, v44
    v_mul_f32 v97, v97, v45
    v_mfma_f32_16x16x32_bf16 v[200:203], v[136:139], v[64:67], v[200:203]
    v_mul_f32 v98, v98, v46
    v_mul_f32 v99, v99, v47
    s_waitcnt lgkmcnt(1)
    v_mfma_f32_16x16x32_bf16 v[204:207], v[140:143], v[52:55], 0
    v_cvt_pk_bf16_f32 v96, v96, v97
    v_cvt_pk_bf16_f32 v97, v98, v99
    v_mfma_f32_16x16x32_bf16 v[208:211], v[140:143], v[60:63], 0
    ds_write_b64 v9, v[96:97] offset:4096
    s_waitcnt lgkmcnt(1)
    v_mfma_f32_16x16x32_bf16 v[204:207], v[144:147], v[56:59], v[204:207]
    v_fmac_f32 v100, v29, v120
    v_fmac_f32 v101, v29, v121
    v_mfma_f32_16x16x32_bf16 v[208:211], v[144:147], v[64:67], v[208:211]
    v_fmac_f32 v102, v29, v122
    v_fmac_f32 v103, v29, v123
    v_mul_f32 v100, v100, v44
    v_mul_f32 v101, v101, v45
    v_mul_f32 v102, v102, v46
    v_mul_f32 v103, v103, v47
    v_cvt_pk_bf16_f32 v100, v100, v101
    v_cvt_pk_bf16_f32 v101, v102, v103
    ds_write_b64 v9, v[100:101] offset:6144
    v_pk_add_f32 v[180:181], v[180:181], v[186:187]
    v_pk_add_f32 v[182:183], v[182:183], v[184:185] neg_lo:[0,1] neg_hi:[0,1]
    v_cvt_pk_bf16_f32 v24, v180, v182
    v_cvt_pk_bf16_f32 v25, v181, v183
    v_pk_add_f32 v[188:189], v[188:189], v[194:195]
    v_pk_add_f32 v[190:191], v[190:191], v[192:193] neg_lo:[0,1] neg_hi:[0,1]
    v_cvt_pk_bf16_f32 v26, v188, v190
    v_cvt_pk_bf16_f32 v27, v189, v191
    buffer_store_dwordx4 v[24:27], v12, s[4:7], s61 offen sc1
    s_waitcnt lgkmcnt(0)
    s_barrier
    ds_read_b128 v[148:151], v10 offset:4096
    ds_read_b128 v[152:155], v10 offset:5120
    ds_read_b128 v[156:159], v10 offset:6144
    ds_read_b128 v[160:163], v10 offset:7168
    v_pk_add_f32 v[196:197], v[196:197], v[202:203]
    v_pk_add_f32 v[198:199], v[198:199], v[200:201] neg_lo:[0,1] neg_hi:[0,1]
    v_cvt_pk_bf16_f32 v16, v196, v198
    v_cvt_pk_bf16_f32 v17, v197, v199
    v_pk_add_f32 v[204:205], v[204:205], v[210:211]
    v_pk_add_f32 v[206:207], v[206:207], v[208:209] neg_lo:[0,1] neg_hi:[0,1]
    v_cvt_pk_bf16_f32 v18, v204, v206
    v_cvt_pk_bf16_f32 v19, v205, v207
    buffer_store_dwordx4 v[16:19], v12, s[4:7], s70 offen sc1
    s_waitcnt lgkmcnt(3)
    v_mfma_f32_16x16x32_bf16 v[88:91], v[148:151], v[52:55], 0
    v_mfma_f32_16x16x32_bf16 v[92:95], v[148:151], v[60:63], 0
    s_waitcnt lgkmcnt(2)
    v_mfma_f32_16x16x32_bf16 v[88:91], v[152:155], v[56:59], v[88:91]
    v_mfma_f32_16x16x32_bf16 v[92:95], v[152:155], v[64:67], v[92:95]
    s_waitcnt lgkmcnt(1)
    v_mfma_f32_16x16x32_bf16 v[108:111], v[156:159], v[52:55], 0
    s_nop 1
    v_mfma_f32_16x16x32_bf16 v[112:115], v[156:159], v[60:63], 0
    s_waitcnt lgkmcnt(0)
    v_mfma_f32_16x16x32_bf16 v[108:111], v[160:163], v[56:59], v[108:111]
    s_nop 0
    v_add_f32 v88, v88, v94
    v_sub_f32 v90, v90, v92
    v_mfma_f32_16x16x32_bf16 v[112:115], v[160:163], v[64:67], v[112:115]
    v_add_f32 v89, v89, v95
    v_sub_f32 v91, v91, v93
    v_cvt_pk_bf16_f32 v20, v88, v90
    v_cvt_pk_bf16_f32 v21, v89, v91
    s_nop 3
    v_pk_add_f32 v[108:109], v[108:109], v[114:115]
    v_pk_add_f32 v[110:111], v[110:111], v[112:113] neg_lo:[0,1] neg_hi:[0,1]
    v_cvt_pk_bf16_f32 v22, v108, v110
    v_cvt_pk_bf16_f32 v23, v109, v111
    buffer_store_dwordx4 v[20:23], v12, s[4:7], s60 offen sc1
    v_and_b32 v14, 3, v0
    v_lshlrev_b32 v14, 6, v14
    s_add_u32 s80, s78, 884736
    s_cmp_lg_u32 s36, 0
    s_cbranch_scc1 SKIP3
    buffer_load_dword v38, v14, s[32:35], 0 offen sc1
SKIP3:
    s_barrier
    s_add_u32 m0, s79, 10240
    s_nop 0
    buffer_load_dwordx4 v235, s[20:23], s78 offen lds
    v_bfe_u32 v32, v0, 2, 2
    v_lshl_add_u32 v32, v3, 3, v32
    v_mul_u32_u24 v32, 112, v32
    s_mul_i32 s50, s36, 14336
    v_add_u32 v32, s50, v32
    v_and_b32 v33, 3, v0
    v_and_b32 v34, 1, v0
    v_bfe_u32 v35, v0, 1, 1
    v_lshl_add_u32 v239, v33, 4, v32
    v_lshl_add_u32 v240, v34, 4, v32
    v_lshl_add_u32 v240, v35, 3, v240
    v_mul_u32_u24 v35, 7168, v35
    v_lshl_add_u32 v241, v34, 3, v32
    v_add_u32 v241, v241, v35
    v_add_u32 v242, s50, v1
    v_mov_b32 v244, 0x3f803f80
    v_mov_b32 v245, 0x3f803f80
    v_mov_b32 v246, 0x3f803f80
    v_mov_b32 v247, 0x3f803f80
    s_and_b32 s43, s37, 4
    s_add_u32 m0, s79, 11264
    s_nop 0
    buffer_load_dwordx4 v236, s[20:23], s78 offen lds
    s_add_u32 s43, s43, s38
    s_lshl_b32 s44, s43, 2
    s_add_u32 s44, s44, s36
    s_lshl_b32 s45, s2, 2
    s_add_u32 s45, s45, s36
    s_lshl_b32 s45, s45, 7
    s_add_u32 s92, s4, s45
    s_addc_u32 s93, s5, 0
    s_lshl_b32 s50, s40, 2
    s_add_u32 s50, s50, s36
    s_mul_i32 s64, s50, 20480
    s_lshl_b32 s65, s50, 10
    s_lshl_b32 s50, s36, 10
    s_lshl_b32 s51, s39, 12
    s_add_u32 s50, s50, s51
    s_lshr_b32 s51, s40, 3
    s_lshl_b32 s51, s51, 7
    s_add_u32 s82, s50, s51
    s_and_b32 s50, s37, 4
    s_and_b32 s51, s37, 3
    s_lshl_b32 s51, s51, 6
    s_add_u32 m0, s79, 12288
    s_nop 0
    buffer_load_dwordx4 v237, s[20:23], s78 offen lds
    s_add_u32 s50, s50, s51
    s_add_u32 s50, s50, s36
    s_lshl_b32 s50, s50, 2
    s_add_u32 s50, s50, s38
    s_lshl_b32 s84, s50, 7
    s_lshl_b32 s50, s36, 6
    s_add_u32 s50, s50, s43
    s_lshl_b32 s50, s50, 2
    s_and_b32 s51, s37, 3
    s_add_u32 s50, s50, s51
    s_lshl_b32 s86, s50, 7
    s_lshl_b32 s50, s38, 6
    s_add_u32 s50, s50, s37
    s_lshl_b32 s50, s50, 2
    s_add_u32 s50, s50, s36
    s_lshl_b32 s88, s50, 7
    s_mul_i32 s50, s39, 1280
    s_add_u32 s51, s50, 1024
    s_sub_u32 s52, 20224, s50
    v_mov_b32 v12, s51
    s_add_u32 m0, s79, 13312
    s_nop 0
    buffer_load_dwordx4 v238, s[20:23], s78 offen lds
    v_mov_b32 v13, s52
    v_cndmask_b32 v4, v13, v12, s[66:67]
    v_and_b32 v12, 1, v3
    v_lshl_add_u32 v4, v12, 3, v4
    v_lshl_add_u32 v4, v2, 4, v4
    v_lshlrev_b32 v5, 2, v0
    s_add_u32 s82, s4, s82
    s_addc_u32 s83, s5, 0
    s_add_u32 s84, s4, s84
    s_addc_u32 s85, s5, 0
    s_add_u32 s86, s4, s86
    s_addc_u32 s87, s5, 0
    s_add_u32 s88, s4, s88
    s_addc_u32 s89, s5, 0
    v_and_b32 v28, 3, v0
    v_bfe_u32 v29, v0, 2, 1
    v_lshlrev_b32 v28, 15, v28
    v_lshl_add_u32 v28, v29, 9, v28
    v_lshrrev_b32 v29, 3, v0
    v_lshl_add_u32 v28, v29, 28, v28
    v_mov_b32 v29, 1
    s_sub_u32 s69, s82, s4
    s_add_u32 s69, s69, 0
    s_and_b32 s50, s36, 1
    s_lshl_b32 s50, s50, 4
    v_add_u32 v104, s50, v2
    s_lshr_b32 s54, s36, 1
    s_or_b32 s51, s54, s41
    s_cmp_eq_u32 s51, 0
    s_cselect_b32 s51, 32, 31
    v_sub_u32 v105, s51, v104
    v_cvt_f32_u32 v104, v104
    v_cvt_f32_u32 v105, v105
    v_cvt_f32_u32 v106, v3
    v_mul_f32 v104, 0x3d000000, v104
    v_mul_f32 v105, 0x3d000000, v105
    v_add_f32 v106, v106, v106
    v_cmp_eq_u32 vcc, 0, v3
    v_mul_f32 v107, v104, v106
    v_mul_f32 v108, v105, v106
    v_fmamk_f32 v109, v104, 0x0, v107
    v_fmamk_f32 v110, v104, 0x3f800000, v107
    v_fmamk_f32 v111, v104, 0x41000000, v107
    v_fmamk_f32 v112, v104, 0x41100000, v107
    v_mul_f32 v121, 0x41800000, v104
    v_cos_f32 v113, v109
    v_sin_f32 v117, v109
    v_cos_f32 v114, v110
    v_sin_f32 v118, v110
    v_cos_f32 v115, v111
    v_sin_f32 v119, v111
    v_cos_f32 v116, v112
    v_sin_f32 v120, v112
    v_cos_f32 v121, v121
    v_cvt_pk_bf16_f32 v40, v113, v117
    v_cvt_pk_bf16_f32 v42, v114, v118
    v_cvt_pk_bf16_f32 v44, v115, v119
    v_cvt_pk_bf16_f32 v46, v116, v120
    v_cndmask_b32 v113, v113, v121, vcc
    v_cvt_pk_bf16_f32 v41, v113, -v117
    v_cvt_pk_bf16_f32 v43, v114, -v118
    v_cvt_pk_bf16_f32 v45, v115, -v119
    v_cvt_pk_bf16_f32 v47, v116, -v120
    v_fmamk_f32 v109, v105, 0x0, v108
    v_fmamk_f32 v110, v105, 0x3f800000, v108
    v_fmamk_f32 v111, v105, 0x41000000, v108
    v_fmamk_f32 v112, v105, 0x41100000, v108
    v_mul_f32 v121, 0x41800000, v105
    v_cos_f32 v113, v109
    v_sin_f32 v117, v109
    v_cos_f32 v114, v110
    v_sin_f32 v118, v110
    v_cos_f32 v115, v111
    v_sin_f32 v119, v111
    s_cmp_lg_u32 s36, 0
    s_cbranch_scc1 SKIP4
    s_mov_b32 s68, 0
    s_waitcnt vmcnt(4)
INI5:
    v_cmp_gt_u32 s[96:97], 16, v38
    s_cmp_eq_u64 s[96:97], 0
    s_cbranch_scc1 INIX6
    buffer_load_dword v38, v14, s[32:35], 0 offen sc1
    s_add_u32 s68, s68, 1
    s_waitcnt vmcnt(0)
    s_cmp_lt_u32 s68, 400000
    s_cbranch_scc1 INI5
INIX6:
SKIP4:
    s_waitcnt vmcnt(4)
    s_barrier
    buffer_atomic_add v29, v28, s[4:7], s69 offen sc1
    s_add_u32 m0, s79, 57344
    s_nop 0
    buffer_load_dwordx4 v232, s[16:19], s80 offen lds
    v_cos_f32 v116, v112
    v_sin_f32 v120, v112
    v_cos_f32 v121, v121
    v_cvt_pk_bf16_f32 v48, v113, v117
    v_cvt_pk_bf16_f32 v50, v114, v118
    v_cvt_pk_bf16_f32 v52, v115, v119
    v_cvt_pk_bf16_f32 v54, v116, v120
    v_cndmask_b32 v113, v113, v121, vcc
    v_cvt_pk_bf16_f32 v49, v113, -v117
    v_cvt_pk_bf16_f32 v51, v114, -v118
    v_cvt_pk_bf16_f32 v53, v115, -v119
    v_cvt_pk_bf16_f32 v55, v116, -v120
    s_add_u32 m0, s79, 58368
    s_nop 0
    buffer_load_dwordx4 v233, s[16:19], s80 offen lds
    v_mul_u32_u24 v104, 98304, v3
    s_mul_i32 s50, s36, 786432
    s_mul_i32 s51, s39, 12288
    s_add_u32 s50, s50, s51
    s_lshr_b32 s51, s40, 1
    s_lshl_b32 s51, s51, 8
    s_add_u32 s50, s50, s51
    s_add_u32 s70, s50, 8978432
    s_mul_i32 s71, s36, 6144
    v_xor_b32 v105, 0, v2
    v_lshl_add_u32 v100, v105, 4, v104
    s_add_u32 m0, s79, 59392
    s_nop 0
    buffer_load_dwordx4 v234, s[16:19], s80 offen lds
    v_xor_b32 v105, 4, v2
    v_lshl_add_u32 v101, v105, 4, v104
    v_xor_b32 v105, 1, v2
    v_lshl_add_u32 v102, v105, 4, v104
    v_xor_b32 v105, 5, v2
    v_lshl_add_u32 v103, v105, 4, v104
    s_and_b32 s50, s40, 1
    s_xor_b32 s51, s50, 1
    s_cmp_lt_u32 s40, 2
    s_cselect_b32 s51, s50, s51
    s_xor_b32 s52, s54, 1
    s_cmp_eq_u32 s40, 0
    s_cselect_b32 s52, s54, s52
    s_add_u32 m0, s79, 60416
    s_nop 0
    buffer_load_dwordx4 v235, s[16:19], s80 offen lds
    s_lshl_b32 s50, s50, 7
    s_lshl_b32 s55, s54, 6
    s_add_u32 s50, s50, s55
    s_lshl_b32 s51, s51, 7
    s_lshl_b32 s52, s52, 6
    s_add_u32 s51, s51, s52
    v_lshrrev_b32 v104, 1, v3
    v_mul_u32_u24 v104, 6144, v104
    v_and_b32 v105, 1, v3
    v_lshl_add_u32 v104, v105, 10, v104
    v_add_u32 v104, 132096, v104
    s_add_u32 m0, s79, 61440
    s_nop 0
    buffer_load_dwordx4 v236, s[16:19], s80 offen lds
    v_lshlrev_b32 v105, 6, v105
    v_xor_b32 v106, s50, v105
    v_xor_b32 v107, s51, v105
    v_add_u32 v106, v106, v104
    v_add_u32 v107, v107, v104
    v_and_b32 v108, 12, v2
    v_add_u32 v108, v108, v2
    v_mov_b32 v109, v108
    v_lshrrev_b32 v110, 4, v109
    v_and_b32 v111, 15, v109
    v_lshl_add_u32 v30, v110, 11, v106
    s_add_u32 m0, s79, 62464
    s_nop 0
    buffer_load_dwordx4 v237, s[16:19], s80 offen lds
    v_and_b32 v110, 1, v110
    v_lshlrev_b32 v110, 2, v110
    v_xor_b32 v111, v111, v110
    v_lshl_add_u32 v30, v111, 2, v30
    v_xor_b32 v31, 16, v30
    v_sub_u32 v109, 40, v108
    v_cmp_lt_u32 vcc, 31, v109
    v_and_b32 v110, 6, v109
    v_add_u32 v110, v110, v109
    v_cndmask_b32 v109, v109, v110, vcc
    v_cmp_eq_u32 vcc, 0, v2
    v_nop
    s_add_u32 m0, s79, 63488
    s_nop 0
    buffer_load_dwordx4 v238, s[16:19], s80 offen lds
    v_nop
    v_cndmask_b32 v109, v109, 34, vcc
    v_lshrrev_b32 v110, 4, v109
    v_and_b32 v111, 15, v109
    v_lshl_add_u32 v32, v110, 11, v107
    v_and_b32 v110, 1, v110
    v_lshlrev_b32 v110, 2, v110
    v_xor_b32 v111, v111, v110
    v_lshl_add_u32 v32, v111, 2, v32
    v_sub_u32 v109, 36, v108
    v_cmp_lt_u32 vcc, 31, v109
    s_add_u32 m0, s79, 64512
    s_nop 0
    buffer_load_dwordx4 v232, s[20:23], s80 offen lds
    v_and_b32 v110, 6, v109
    v_add_u32 v110, v110, v109
    v_cndmask_b32 v109, v109, v110, vcc
    v_lshrrev_b32 v110, 4, v109
    v_and_b32 v111, 15, v109
    v_lshl_add_u32 v33, v110, 11, v107
    v_and_b32 v110, 1, v110
    v_lshlrev_b32 v110, 2, v110
    v_xor_b32 v111, v111, v110
    v_lshl_add_u32 v33, v111, 2, v33
    v_cmp_gt_u32 vcc, 8, v2
    s_add_u32 m0, s79, 65536
    s_nop 0
    buffer_load_dwordx4 v233, s[20:23], s80 offen lds
    s_load_dword s91, s[92:93], 0 glc
    v_and_b32 v110, 6, v2
    v_add3_u32 v110, v110, v2, 32
    v_sub_u32 v109, 16, v2
    v_cndmask_b32 v109, v109, v110, vcc
    v_cndmask_b32 v112, v107, v106, vcc
    v_lshrrev_b32 v110, 4, v109
    v_and_b32 v111, 15, v109
    v_lshl_add_u32 v34, v110, 11, v112
    v_and_b32 v110, 1, v110
    v_lshlrev_b32 v110, 2, v110
    s_add_u32 m0, s79, 66560
    s_nop 0
    buffer_load_dwordx4 v234, s[20:23], s80 offen lds
    v_xor_b32 v111, v111, v110
    v_lshl_add_u32 v34, v111, 2, v34
    s_add_u32 s56, s64, 15269888
    s_mul_i32 s59, s39, 1280
    s_add_u32 s57, s56, s59
    s_sub_u32 s58, s56, s59
    s_add_u32 s58, s58, 19200
    s_lshl_b32 s59, s39, 7
    s_add_u32 s59, s59, s65
    s_add_u32 s59, s59, 23134144
    s_mov_b32 s60, 0x3f803f80
    v_mov_b32 v24, 0
    v_mov_b32 v25, 0
    v_subrev_u32 v26, 16, v0
    v_lshrrev_b32 v27, 5, v26
    v_min_u32 v27, 1, v27
    v_lshlrev_b32 v27, 28, v27
    v_add_u32 v26, v27, v5
    s_waitcnt vmcnt(11)
    ds_read_b64_tr_b16 v[152:153], v239 offset:0
    ds_read_b64_tr_b16 v[154:155], v239 offset:448
    ds_read_b64_tr_b16 v[156:157], v239 offset:8
    ds_read_b64_tr_b16 v[158:159], v239 offset:456
    ds_read_b64_tr_b16 v[160:161], v239 offset:7168
    ds_read_b64_tr_b16 v[162:163], v239 offset:7616
    ds_read_b64_tr_b16 v[164:165], v239 offset:7176
    ds_read_b64_tr_b16 v[166:167], v239 offset:7624
    ds_read_b64_tr_b16 v[168:169], v240 offset:64
    ds_read_b64_tr_b16 v[170:171], v240 offset:512
    ds_read_b64_tr_b16 v[172:173], v240 offset:7232
    ds_read_b64_tr_b16 v[174:175], v240 offset:7680
    ds_read_b64_tr_b16 v[176:177], v241 offset:96
    ds_read_b64_tr_b16 v[178:179], v241 offset:544
    ds_read_b64_tr_b16 v[180:181], v239 offset:3584
    ds_read_b64_tr_b16 v[182:183], v239 offset:4032
    ds_read_b64_tr_b16 v[184:185], v239 offset:3592
    ds_read_b64_tr_b16 v[186:187], v239 offset:4040
    ds_read_b64_tr_b16 v[188:189], v239 offset:10752
    ds_read_b64_tr_b16 v[190:191], v239 offset:11200
    ds_read_b64_tr_b16 v[192:193], v239 offset:10760
    ds_read_b64_tr_b16 v[194:195], v239 offset:11208
    ds_read_b64_tr_b16 v[196:197], v240 offset:3648
    ds_read_b64_tr_b16 v[198:199], v240 offset:4096
    ds_read_b64_tr_b16 v[200:201], v240 offset:10816
    ds_read_b64_tr_b16 v[202:203], v240 offset:11264
    ds_read_b64_tr_b16 v[204:205], v241 offset:3680
    ds_read_b64_tr_b16 v[206:207], v241 offset:4128
    s_waitcnt lgkmcnt(0)
    s_cmp_ge_u32 s91, 8
    s_cbranch_scc1 POLLX8
    s_mov_b32 s68, 0
POLL7:
    s_load_dword s91, s[92:93], 0 glc
    s_add_u32 s68, s68, 1
    s_waitcnt lgkmcnt(0)
    s_cmp_ge_u32 s91, 8
    s_cbranch_scc1 POLLX8
    s_cmp_lt_u32 s68, 400000
    s_cbranch_scc1 POLL7
POLLX8:
    s_add_u32 m0, s71, 132096
    s_add_u32 s50, s70, 0
    buffer_load_dwordx4 v100, s[4:7], s50 offen sc1 lds
    s_add_u32 m0, s71, 133120
    s_add_u32 s50, s70, 393216
    buffer_load_dwordx4 v101, s[4:7], s50 offen sc1 lds
    s_add_u32 m0, s71, 134144
    s_add_u32 s50, s70, 4096
    buffer_load_dwordx4 v102, s[4:7], s50 offen sc1 lds
    s_add_u32 m0, s71, 135168
    s_add_u32 s50, s70, 397312
    buffer_load_dwordx4 v103, s[4:7], s50 offen sc1 lds
    s_add_u32 m0, s71, 136192
    s_add_u32 s50, s70, 8192
    buffer_load_dwordx4 v100, s[4:7], s50 offen sc1 lds
    s_add_u32 m0, s71, 137216
    s_add_u32 s50, s70, 401408
    buffer_load_dwordx4 v101, s[4:7], s50 offen sc1 lds
    s_add_u32 m0, s79, 67584
    s_nop 0
    buffer_load_dwordx4 v235, s[20:23], s80 offen lds
    v_mfma_f32_16x16x32_bf16 v[124:127], v[244:247], v[152:155], 0
    ds_write_b128 v242, v[152:155] offset:0
    v_mfma_f32_16x16x32_bf16 v[128:131], v[244:247], v[156:159], 0
    ds_write_b128 v242, v[156:159] offset:1024
    v_mfma_f32_16x16x32_bf16 v[132:135], v[244:247], v[160:163], 0
    ds_write_b128 v242, v[160:163] offset:2048
    v_mfma_f32_16x16x32_bf16 v[136:139], v[244:247], v[164:167], 0
    ds_write_b128 v242, v[164:167] offset:3072
    v_mfma_f32_16x16x32_bf16 v[140:143], v[244:247], v[168:171], 0
    ds_write_b128 v242, v[168:171] offset:4096
    v_mfma_f32_16x16x32_bf16 v[144:147], v[244:247], v[172:175], 0
    ds_write_b128 v242, v[172:175] offset:5120
    v_mfma_f32_16x16x32_bf16 v[148:151], v[244:247], v[176:179], 0
    ds_write_b128 v242, v[176:179] offset:6144
    v_mfma_f32_16x16x32_bf16 v[124:127], v[244:247], v[180:183], v[124:127]
    ds_write_b128 v242, v[180:183] offset:7168
    v_mfma_f32_16x16x32_bf16 v[128:131], v[244:247], v[184:187], v[128:131]
    ds_write_b128 v242, v[184:187] offset:8192
    v_mfma_f32_16x16x32_bf16 v[132:135], v[244:247], v[188:191], v[132:135]
    ds_write_b128 v242, v[188:191] offset:9216
    v_mfma_f32_16x16x32_bf16 v[136:139], v[244:247], v[192:195], v[136:139]
    ds_write_b128 v242, v[192:195] offset:10240
    v_mfma_f32_16x16x32_bf16 v[140:143], v[244:247], v[196:199], v[140:143]
    ds_write_b128 v242, v[196:199] offset:11264
    v_mfma_f32_16x16x32_bf16 v[144:147], v[244:247], v[200:203], v[144:147]
    ds_write_b128 v242, v[200:203] offset:12288
    v_mfma_f32_16x16x32_bf16 v[148:151], v[244:247], v[204:207], v[148:151]
    ds_write_b128 v242, v[204:207] offset:13312
    v_add_u32 v239, 57344, v239
    v_add_u32 v240, 57344, v240
    v_add_u32 v241, 57344, v241
    v_add_u32 v242, 57344, v242
    v_lshlrev_b32 v212, 16, v248
    v_and_b32 v213, 0xffff0000, v248
    v_lshlrev_b32 v214, 16, v249
    v_and_b32 v215, 0xffff0000, v249
    v_lshlrev_b32 v216, 16, v250
    v_and_b32 v217, 0xffff0000, v250
    v_lshlrev_b32 v218, 16, v251
    v_and_b32 v219, 0xffff0000, v251
    v_lshlrev_b32 v220, 16, v252
    v_and_b32 v221, 0xffff0000, v252
    v_lshlrev_b32 v222, 16, v253
    v_and_b32 v223, 0xffff0000, v253
    v_lshlrev_b32 v224, 16, v254
    v_and_b32 v225, 0xffff0000, v254
    v_lshlrev_b32 v226, 16, v255
    v_and_b32 v227, 0xffff0000, v255
    v_lshlrev_b32 v228, 16, v6
    v_and_b32 v229, 0xffff0000, v6
    v_lshlrev_b32 v230, 16, v7
    v_and_b32 v231, 0xffff0000, v7
    s_waitcnt vmcnt(1)
    s_barrier
    ds_read2st64_b32 v[60:61], v30 offset0:0 offset1:1
    ds_read2st64_b32 v[62:63], v30 offset0:2 offset1:3
    ds_read2st64_b32 v[64:65], v30 offset0:48 offset1:49
    ds_read2st64_b32 v[66:67], v30 offset0:50 offset1:51
    ds_read2st64_b32 v[68:69], v31 offset0:0 offset1:1
    ds_read2st64_b32 v[70:71], v31 offset0:2 offset1:3
    ds_read2st64_b32 v[72:73], v31 offset0:48 offset1:49
    ds_read2st64_b32 v[74:75], v31 offset0:50 offset1:51
    ds_read2st64_b32 v[76:77], v32 offset0:0 offset1:1
    ds_read2st64_b32 v[78:79], v32 offset0:2 offset1:3
    ds_read2st64_b32 v[80:81], v32 offset0:48 offset1:49
    ds_read2st64_b32 v[82:83], v32 offset0:50 offset1:51
    ds_read2st64_b32 v[84:85], v33 offset0:0 offset1:1
    ds_read2st64_b32 v[86:87], v33 offset0:2 offset1:3
    ds_read2st64_b32 v[88:89], v33 offset0:48 offset1:49
    ds_read2st64_b32 v[90:91], v33 offset0:50 offset1:51
    ds_read2st64_b32 v[92:93], v34 offset0:0 offset1:1
    ds_read2st64_b32 v[94:95], v34 offset0:2 offset1:3
    ds_read2st64_b32 v[96:97], v34 offset0:48 offset1:49
    ds_read2st64_b32 v[98:99], v34 offset0:50 offset1:51
    s_add_u32 m0, s79, 68608
    s_nop 0
    buffer_load_dwordx4 v236, s[20:23], s80 offen lds
    s_add_u32 m0, s79, 69632
    s_nop 0
    buffer_load_dwordx4 v237, s[20:23], s80 offen lds
    s_add_u32 m0, s79, 70656
    s_nop 0
    buffer_load_dwordx4 v238, s[20:23], s80 offen lds
    s_waitcnt lgkmcnt(15)
    v_mfma_f32_16x16x32_bf16 v[212:215], v[60:63], v[40:43], v[212:215]
    v_mfma_f32_16x16x32_bf16 v[212:215], v[64:67], v[44:47], v[212:215]
    s_waitcnt lgkmcnt(14)
    v_mfma_f32_16x16x32_bf16 v[216:219], v[68:71], v[40:43], v[216:219]
    s_waitcnt lgkmcnt(12)
    v_mfma_f32_16x16x32_bf16 v[216:219], v[72:75], v[44:47], v[216:219]
    s_waitcnt lgkmcnt(10)
    v_mfma_f32_16x16x32_bf16 v[220:223], v[76:79], v[48:51], v[220:223]
    s_nop 1
    v_cvt_pk_bf16_f32 v12, v212, v213
    v_cvt_pk_bf16_f32 v13, v214, v215
    s_waitcnt lgkmcnt(8)
    v_mfma_f32_16x16x32_bf16 v[220:223], v[80:83], v[52:55], v[220:223]
    s_waitcnt lgkmcnt(6)
    v_mfma_f32_16x16x32_bf16 v[224:227], v[84:87], v[48:51], v[224:227]
    v_cvt_pk_bf16_f32 v14, v216, v217
    v_cvt_pk_bf16_f32 v15, v218, v219
    s_waitcnt lgkmcnt(4)
    v_mfma_f32_16x16x32_bf16 v[224:227], v[88:91], v[52:55], v[224:227]
    buffer_store_dwordx4 v[12:15], v1, s[4:7], s57 offen sc1
    s_waitcnt lgkmcnt(2)
    v_mfma_f32_16x16x32_bf16 v[56:59], v[92:95], v[40:43], v[228:231]
    v_cvt_pk_bf16_f32 v16, v220, v221
    v_cvt_pk_bf16_f32 v17, v222, v223
    v_mfma_f32_16x16x32_bf16 v[228:231], v[92:95], v[48:51], v[228:231]
    s_waitcnt lgkmcnt(0)
    v_mfma_f32_16x16x32_bf16 v[56:59], v[96:99], v[44:47], v[56:59]
    v_cvt_pk_bf16_f32 v18, v224, v225
    v_cvt_pk_bf16_f32 v19, v226, v227
    v_mfma_f32_16x16x32_bf16 v[228:231], v[96:99], v[52:55], v[228:231]
    buffer_store_dwordx4 v[16:19], v1, s[4:7], s58 offen sc1
    v_dot2c_f32_bf16 v24, s60, v12
    v_dot2c_f32_bf16 v25, v12, v12
    v_dot2c_f32_bf16 v24, s60, v13
    v_dot2c_f32_bf16 v25, v13, v13
    v_dot2c_f32_bf16 v24, s60, v14
    v_dot2c_f32_bf16 v25, v14, v14
    v_dot2c_f32_bf16 v24, s60, v15
    v_dot2c_f32_bf16 v25, v15, v15
    v_cndmask_b32 v228, v228, v56, s[66:67]
    v_cndmask_b32 v229, v229, v57, s[66:67]
    v_cndmask_b32 v230, v230, v58, s[66:67]
    v_cndmask_b32 v231, v231, v59, s[66:67]
    v_cvt_pk_bf16_f32 v20, v228, v229
    v_cvt_pk_bf16_f32 v21, v230, v231
    buffer_store_dwordx2 v[20:21], v4, s[4:7], s56 offen sc1
    v_dot2c_f32_bf16 v24, s60, v16
    v_dot2c_f32_bf16 v25, v16, v16
    v_dot2c_f32_bf16 v24, s60, v17
    v_dot2c_f32_bf16 v25, v17, v17
    v_dot2c_f32_bf16 v24, s60, v18
    v_dot2c_f32_bf16 v25, v18, v18
    v_dot2c_f32_bf16 v24, s60, v19
    v_dot2c_f32_bf16 v25, v19, v19
    v_dot2c_f32_bf16 v24, s60, v20
    v_dot2c_f32_bf16 v25, v20, v20
    v_dot2c_f32_bf16 v24, s60, v21
    v_dot2c_f32_bf16 v25, v21, v21
    s_nop 2
    v_permlane32_swap_b32 v24, v25
    v_add_f32 v24, v24, v25
    v_mov_b32 v25, v24
    s_nop 1
    v_permlane16_swap_b32 v24, v25
    v_add_f32 v24, v24, v25
    buffer_store_dword v24, v26, s[4:7], s59 offen sc1
    s_barrier
    s_add_u32 s50, s36, 16
    s_mul_i32 s78, s50, 110592
    s_mul_i32 s51, s42, 112
    s_add_u32 s78, s78, s51
    s_mul_i32 s79, s50, 7168
    s_add_u32 m0, s79, 0
    s_nop 0
    buffer_load_dwordx4 v232, s[16:19], s78 offen lds
    s_add_u32 m0, s79, 1024
    s_nop 0
    buffer_load_dwordx4 v233, s[16:19], s78 offen lds
    s_add_u32 m0, s79, 2048
    s_nop 0
    buffer_load_dwordx4 v234, s[16:19], s78 offen lds
    s_add_u32 m0, s79, 3072
    s_mov_b32 exec_hi, 0
    buffer_load_dwordx4 v235, s[16:19], s78 offen lds
    s_mov_b32 exec_hi, -1
    s_add_u32 m0, s79, 3584
    s_nop 0
    buffer_load_dwordx4 v232, s[20:23], s78 offen lds
    s_add_u32 m0, s79, 4608
    s_nop 0
    buffer_load_dwordx4 v233, s[20:23], s78 offen lds
    v_and_b32 v28, 7, v0
    v_lshlrev_b32 v28, 12, v28
    v_lshrrev_b32 v29, 3, v0
    v_lshl_add_u32 v28, v29, 28, v28
    v_mov_b32 v29, 1
    s_sub_u32 s69, s84, s4
    s_add_u32 s69, s69, 131072
    s_waitcnt vmcnt(10)
    ds_read_b64_tr_b16 v[152:153], v239 offset:0
    ds_read_b64_tr_b16 v[154:155], v239 offset:448
    ds_read_b64_tr_b16 v[156:157], v239 offset:8
    ds_read_b64_tr_b16 v[158:159], v239 offset:456
    ds_read_b64_tr_b16 v[160:161], v239 offset:7168
    ds_read_b64_tr_b16 v[162:163], v239 offset:7616
    ds_read_b64_tr_b16 v[164:165], v239 offset:7176
    ds_read_b64_tr_b16 v[166:167], v239 offset:7624
    ds_read_b64_tr_b16 v[168:169], v240 offset:64
    ds_read_b64_tr_b16 v[170:171], v240 offset:512
    ds_read_b64_tr_b16 v[172:173], v240 offset:7232
    ds_read_b64_tr_b16 v[174:175], v240 offset:7680
    ds_read_b64_tr_b16 v[176:177], v241 offset:96
    ds_read_b64_tr_b16 v[178:179], v241 offset:544
    ds_read_b64_tr_b16 v[180:181], v239 offset:3584
    ds_read_b64_tr_b16 v[182:183], v239 offset:4032
    ds_read_b64_tr_b16 v[184:185], v239 offset:3592
    ds_read_b64_tr_b16 v[186:187], v239 offset:4040
    ds_read_b64_tr_b16 v[188:189], v239 offset:10752
    ds_read_b64_tr_b16 v[190:191], v239 offset:11200
    ds_read_b64_tr_b16 v[192:193], v239 offset:10760
    ds_read_b64_tr_b16 v[194:195], v239 offset:11208
    ds_read_b64_tr_b16 v[196:197], v240 offset:3648
    ds_read_b64_tr_b16 v[198:199], v240 offset:4096
    ds_read_b64_tr_b16 v[200:201], v240 offset:10816
    ds_read_b64_tr_b16 v[202:203], v240 offset:11264
    ds_read_b64_tr_b16 v[204:205], v241 offset:3680
    ds_read_b64_tr_b16 v[206:207], v241 offset:4128
    s_waitcnt vmcnt(6)
    s_barrier
    buffer_atomic_add v29, v28, s[4:7], s69 offen sc1
    s_add_u32 m0, s79, 5632
    s_nop 0
    buffer_load_dwordx4 v234, s[20:23], s78 offen lds
    s_add_u32 m0, s79, 6656
    s_mov_b32 exec_hi, 0
    buffer_load_dwordx4 v235, s[20:23], s78 offen lds
    s_mov_b32 exec_hi, -1
    v_add_u32 v9, 64512, v1
    v_add_u32 v10, 129024, v1
    s_mul_i32 s50, s44, 81920
    s_cmp_eq_u32 s42, 31
    s_cselect_b32 s50, 0x10000000, s50
    s_add_u32 s72, s50, 15269888
    s_add_u32 s73, s50, 15290368
    s_add_u32 s74, s50, 15310848
    s_add_u32 s75, s50, 15331328
    s_lshl_b32 s80, s44, 12
    s_add_u32 s80, s80, 23134208
    v_lshrrev_b32 v30, 5, v0
    v_mul_u32_u24 v30, 57344, v30
    v_lshl_add_u32 v30, v2, 4, v30
    v_and_b32 v31, 1, v3
    v_lshl_add_u32 v6, v31, 8, v30
    v_add_u32 v6, 1024, v6
    v_lshl_add_u32 v7, v31, 3, v30
    v_add_u32 v7, 1536, v7
    s_mul_i32 s81, s39, 286720
    s_mul_i32 s50, s36, 71680
    s_add_u32 s81, s81, s50
    s_add_u32 s81, s81, 6684672
    s_mov_b32 s16, 4096
    s_mov_b32 s17, 8192
    s_mov_b32 s18, 12288
    s_mov_b32 s19, 4096
    s_cmp_eq_u32 s36, 3
    s_cselect_b32 s18, 0x10000000, s18
    s_cselect_b32 s19, 0x10000000, s19
    s_mul_i32 s50, s36, 7168
    s_sub_u32 s50, 57344, s50
    v_bfe_u32 v32, v0, 1, 1
    v_mul_u32_u24 v32, 3584, v32
    v_add_u32 v239, s50, v239
    v_add_u32 v240, s50, v240
    v_add_u32 v241, s50, v241
    v_sub_u32 v241, v241, v32
    s_mul_i32 s50, s36, 448
    s_add_u32 s50, s50, 156672
    v_lshl_add_u32 v208, v2, 2, s50
    s_waitcnt lgkmcnt(0)
    buffer_load_dwordx4 a[0:3], v1, s[4:7], s81 offen offset:0 sc1
    v_mfma_f32_16x16x32_bf16 v[124:127], v[244:247], v[152:155], v[124:127]
    ds_write_b128 v242, v[152:155] offset:0
    v_mfma_f32_16x16x32_bf16 v[128:131], v[244:247], v[156:159], v[128:131]
    ds_write_b128 v242, v[156:159] offset:1024
    buffer_load_dwordx4 a[4:7], v1, s[4:7], s81 offen offset:1024 sc1
    v_mfma_f32_16x16x32_bf16 v[132:135], v[244:247], v[160:163], v[132:135]
    ds_write_b128 v242, v[160:163] offset:2048
    v_mfma_f32_16x16x32_bf16 v[136:139], v[244:247], v[164:167], v[136:139]
    buffer_load_dwordx4 a[8:11], v1, s[4:7], s81 offen offset:2048 sc1
    ds_write_b128 v242, v[164:167] offset:3072
    v_mfma_f32_16x16x32_bf16 v[140:143], v[244:247], v[168:171], v[140:143]
    ds_write_b128 v242, v[168:171] offset:4096
    v_mfma_f32_16x16x32_bf16 v[144:147], v[244:247], v[172:175], v[144:147]
    buffer_load_dwordx4 a[12:15], v1, s[4:7], s81 offen offset:3072 sc1
    s_add_u32 s81, s81, 4096
    ds_write_b128 v242, v[172:175] offset:5120
    v_mfma_f32_16x16x32_bf16 v[148:151], v[244:247], v[176:179], v[148:151]
    ds_write_b128 v242, v[176:179] offset:6144
    buffer_load_dwordx4 a[16:19], v1, s[4:7], s81 offen offset:0 sc1
    v_mfma_f32_16x16x32_bf16 v[124:127], v[244:247], v[180:183], v[124:127]
    ds_write_b128 v242, v[180:183] offset:7168
    v_mfma_f32_16x16x32_bf16 v[128:131], v[244:247], v[184:187], v[128:131]
    ds_write_b128 v242, v[184:187] offset:8192
    buffer_load_dwordx4 a[20:23], v1, s[4:7], s81 offen offset:1024 sc1
    v_mfma_f32_16x16x32_bf16 v[132:135], v[244:247], v[188:191], v[132:135]
    ds_write_b128 v242, v[188:191] offset:9216
    v_mfma_f32_16x16x32_bf16 v[136:139], v[244:247], v[192:195], v[136:139]
    buffer_load_dwordx4 a[24:27], v1, s[4:7], s81 offen offset:2048 sc1
    ds_write_b128 v242, v[192:195] offset:10240
    v_mfma_f32_16x16x32_bf16 v[140:143], v[244:247], v[196:199], v[140:143]
    ds_write_b128 v242, v[196:199] offset:11264
    v_mfma_f32_16x16x32_bf16 v[144:147], v[244:247], v[200:203], v[144:147]
    buffer_load_dwordx4 a[28:31], v1, s[4:7], s81 offen offset:3072 sc1
    s_add_u32 s81, s81, 4096
    ds_write_b128 v242, v[200:203] offset:12288
    v_mfma_f32_16x16x32_bf16 v[148:151], v[244:247], v[204:207], v[148:151]
    ds_write_b128 v242, v[204:207] offset:13312
    v_add_u32 v242, s79, v1
    s_waitcnt vmcnt(8)
    ds_read_b64_tr_b16 v[40:41], v239 offset:0
    ds_read_b64_tr_b16 v[42:43], v239 offset:448
    ds_read_b64_tr_b16 v[44:45], v239 offset:8
    ds_read_b64_tr_b16 v[46:47], v239 offset:456
    ds_read_b64_tr_b16 v[48:49], v239 offset:3584
    ds_read_b64_tr_b16 v[50:51], v239 offset:4032
    ds_read_b64_tr_b16 v[52:53], v239 offset:3592
    ds_read_b64_tr_b16 v[54:55], v239 offset:4040
    ds_read_b64_tr_b16 v[56:57], v240 offset:64
    ds_read_b64_tr_b16 v[58:59], v240 offset:512
    ds_read_b64_tr_b16 v[60:61], v240 offset:3648
    ds_read_b64_tr_b16 v[62:63], v240 offset:4096
    ds_read_b64_tr_b16 v[64:65], v241 offset:96
    ds_read_b64_tr_b16 v[66:67], v241 offset:544
    buffer_load_dwordx4 a[32:35], v1, s[4:7], s81 offen offset:0 sc1
    buffer_load_dwordx4 a[36:39], v1, s[4:7], s81 offen offset:1024 sc1
    buffer_load_dwordx4 a[40:43], v1, s[4:7], s81 offen offset:2048 sc1
    buffer_load_dwordx4 a[44:47], v1, s[4:7], s81 offen offset:3072 sc1
    s_add_u32 s81, s81, 4096
    buffer_load_dwordx4 a[48:51], v1, s[4:7], s81 offen offset:0 sc1
    buffer_load_dwordx4 a[52:55], v1, s[4:7], s81 offen offset:1024 sc1
    buffer_load_dwordx4 a[56:59], v1, s[4:7], s81 offen offset:2048 sc1
    buffer_load_dwordx4 a[60:63], v1, s[4:7], s81 offen offset:3072 sc1
    s_add_u32 s81, s81, 4096
    s_waitcnt lgkmcnt(0)
    s_load_dword s91, s[92:93], 131072 glc
    v_mfma_f32_16x16x32_bf16 v[124:127], v[244:247], v[40:43], v[124:127]
    ds_write_b128 v242, v[40:43] offset:0
    v_mfma_f32_16x16x32_bf16 v[128:131], v[244:247], v[44:47], v[128:131]
    ds_write_b128 v242, v[44:47] offset:1024
    v_mfma_f32_16x16x32_bf16 v[132:135], v[244:247], v[48:51], v[132:135]
    ds_write_b128 v242, v[48:51] offset:2048
    v_mfma_f32_16x16x32_bf16 v[136:139], v[244:247], v[52:55], v[136:139]
    ds_write_b128 v242, v[52:55] offset:3072
    v_mfma_f32_16x16x32_bf16 v[140:143], v[244:247], v[56:59], v[140:143]
    ds_write_b128 v242, v[56:59] offset:4096
    v_mfma_f32_16x16x32_bf16 v[144:147], v[244:247], v[60:63], v[144:147]
    ds_write_b128 v242, v[60:63] offset:5120
    v_mfma_f32_16x16x32_bf16 v[148:151], v[244:247], v[64:67], v[148:151]
    ds_write_b128 v242, v[64:67] offset:6144
    s_mul_i32 s50, s44, 229376
    s_mul_i32 s51, s42, 1792
    s_add_u32 s50, s50, s51
    s_cmp_eq_u32 s42, 31
    s_cselect_b32 s50, 0x10000000, s50
    s_add_u32 s76, s50, 23527424
    s_add_u32 s77, s50, 23584768
    s_add_u32 s78, s50, 23642112
    s_add_u32 s79, s50, 23699456
    v_min_u32 v210, 55, v0
    v_lshlrev_b32 v210, 3, v210
    v_add_u32 v209, 156672, v210
    v_add_u32 v210, 163328, v210
    ds_write_b32 v208, v124 offset:0
    ds_write_b32 v208, v128 offset:64
    ds_write_b32 v208, v132 offset:128
    ds_write_b32 v208, v136 offset:192
    ds_write_b32 v208, v140 offset:256
    ds_write_b32 v208, v144 offset:320
    ds_write_b32 v208, v148 offset:384
    s_waitcnt lgkmcnt(0)
    s_cmp_ge_u32 s91, 8
    s_cbranch_scc1 POLLX10
    s_mov_b32 s68, 0
POLL9:
    s_load_dword s91, s[92:93], 131072 glc
    s_add_u32 s68, s68, 1
    s_waitcnt lgkmcnt(0)
    s_cmp_ge_u32 s91, 8
    s_cbranch_scc1 POLLX10
    s_cmp_lt_u32 s68, 400000
    s_cbranch_scc1 POLL9
POLLX10:
    buffer_load_dwordx4 v[152:155], v1, s[4:7], s72 offen offset:0 sc1
    buffer_load_dwordx4 v[156:159], v1, s[4:7], s73 offen offset:0 sc1
    buffer_load_dwordx4 v[160:163], v1, s[4:7], s72 offen offset:1024 sc1
    buffer_load_dwordx4 v[164:167], v1, s[4:7], s73 offen offset:1024 sc1
    buffer_load_dwordx4 v[168:171], v1, s[4:7], s72 offen offset:2048 sc1
    buffer_load_dwordx4 v[172:175], v1, s[4:7], s73 offen offset:2048 sc1
    buffer_load_dwordx4 v[176:179], v1, s[4:7], s72 offen offset:3072 sc1
    buffer_load_dwordx4 v[180:183], v1, s[4:7], s73 offen offset:3072 sc1
    s_add_u32 s72, s72, 4096
    s_add_u32 s73, s73, 4096
    s_waitcnt lgkmcnt(0)
    s_barrier
    ds_read_b128 v[124:127], v1 offset:0
    ds_read_b128 v[128:131], v1 offset:1024
    ds_read_b128 v[132:135], v1 offset:2048
    ds_read_b128 v[136:139], v1 offset:3072
    ds_read_b128 v[140:143], v1 offset:4096
    ds_read_b128 v[144:147], v1 offset:5120
    s_waitcnt vmcnt(7) lgkmcnt(5)
    v_mfma_f32_16x16x32_bf16 v[12:15], v[124:127], v[152:155], 0
    ds_read_b128 v[148:151], v1 offset:6144
    ds_read_b64 v[88:89], v209 offset:0
    s_waitcnt vmcnt(6)
    v_mfma_f32_16x16x32_bf16 v[16:19], v[124:127], v[156:159], 0
    s_waitcnt lgkmcnt(5)
    buffer_load_dword v68, v5, s[4:7], s80 offen offset:0 sc1
    v_mfma_f32_16x16x32_bf16 v[20:23], v[128:131], v[152:155], 0
    ds_read_b128 v[124:127], v1 offset:7168
    ds_read_b64 v[90:91], v209 offset:448
    v_mfma_f32_16x16x32_bf16 v[24:27], v[128:131], v[156:159], 0
    buffer_load_dwordx4 v[184:187], v1, s[4:7], s72 offen offset:0 sc1
    v_mfma_f32_16x16x32_bf16 v[28:31], v[132:135], v[152:155], 0
    ds_read_b128 v[128:131], v1 offset:8192
    ds_read_b64 v[92:93], v209 offset:896
    v_mfma_f32_16x16x32_bf16 v[32:35], v[132:135], v[156:159], 0
    s_waitcnt lgkmcnt(7)
    buffer_load_dword v69, v5, s[4:7], s80 offen offset:256 sc1
    v_mfma_f32_16x16x32_bf16 v[36:39], v[136:139], v[152:155], 0
    ds_read_b128 v[132:135], v1 offset:9216
    ds_read_b64 v[94:95], v209 offset:1344
    v_mfma_f32_16x16x32_bf16 v[40:43], v[136:139], v[156:159], 0
    buffer_load_dwordx4 v[188:191], v1, s[4:7], s73 offen offset:0 sc1
    v_mfma_f32_16x16x32_bf16 v[44:47], v[140:143], v[152:155], 0
    ds_read_b128 v[136:139], v1 offset:10240
    v_lshlrev_b32 v211, 4, v3
    v_mfma_f32_16x16x32_bf16 v[48:51], v[140:143], v[156:159], 0
    s_waitcnt lgkmcnt(8)
    buffer_load_dword v70, v5, s[4:7], s80 offen offset:512 sc1
    v_mfma_f32_16x16x32_bf16 v[52:55], v[144:147], v[152:155], 0
    ds_read_b128 v[140:143], v1 offset:11264
    v_add_u32 v211, 163328, v211
    v_mfma_f32_16x16x32_bf16 v[56:59], v[144:147], v[156:159], 0
    buffer_load_dwordx4 a[64:67], v1, s[4:7], s81 offen offset:0 sc1
    v_mfma_f32_16x16x32_bf16 v[60:63], v[148:151], v[152:155], 0
    s_waitcnt vmcnt(10)
    ds_read_b128 v[144:147], v1 offset:12288
    v_mfma_f32_16x16x32_bf16 v[64:67], v[148:151], v[156:159], 0
    s_waitcnt lgkmcnt(8)
    buffer_load_dword v71, v5, s[4:7], s80 offen offset:768 sc1
    v_mfma_f32_16x16x32_bf16 v[12:15], v[124:127], v[160:163], v[12:15]
    ds_read_b128 v[148:151], v1 offset:13312
    v_mfma_f32_16x16x32_bf16 v[16:19], v[124:127], v[164:167], v[16:19]
    s_waitcnt lgkmcnt(5)
    buffer_load_dword v72, v5, s[4:7], s80 offen offset:1024 sc1
    v_mfma_f32_16x16x32_bf16 v[20:23], v[128:131], v[160:163], v[20:23]
    ds_read_b128 v[124:127], v1 offset:14336
    v_add_f32 v88, v88, v90
    v_mfma_f32_16x16x32_bf16 v[24:27], v[128:131], v[164:167], v[24:27]
    buffer_load_dwordx4 v[152:155], v1, s[4:7], s72 offen offset:1024 sc1
    v_mfma_f32_16x16x32_bf16 v[28:31], v[132:135], v[160:163], v[28:31]
    ds_read_b128 v[128:131], v1 offset:15360
    v_add_f32 v89, v89, v91
    v_mfma_f32_16x16x32_bf16 v[32:35], v[132:135], v[164:167], v[32:35]
    s_waitcnt lgkmcnt(4)
    buffer_load_dword v73, v5, s[4:7], s80 offen offset:1280 sc1
    v_mfma_f32_16x16x32_bf16 v[36:39], v[136:139], v[160:163], v[36:39]
    ds_read_b128 v[132:135], v1 offset:16384
    v_add_f32 v92, v92, v94
    v_mfma_f32_16x16x32_bf16 v[40:43], v[136:139], v[164:167], v[40:43]
    buffer_load_dwordx4 v[156:159], v1, s[4:7], s73 offen offset:1024 sc1
    v_mfma_f32_16x16x32_bf16 v[44:47], v[140:143], v[160:163], v[44:47]
    ds_read_b128 v[136:139], v1 offset:17408
    v_add_f32 v93, v93, v95
    v_mfma_f32_16x16x32_bf16 v[48:51], v[140:143], v[164:167], v[48:51]
    s_waitcnt lgkmcnt(4)
    buffer_load_dword v74, v5, s[4:7], s80 offen offset:1536 sc1
    v_mfma_f32_16x16x32_bf16 v[52:55], v[144:147], v[160:163], v[52:55]
    ds_read_b128 v[140:143], v1 offset:18432
    v_add_f32 v88, v88, v92
    v_mfma_f32_16x16x32_bf16 v[56:59], v[144:147], v[164:167], v[56:59]
    buffer_load_dwordx4 a[68:71], v1, s[4:7], s81 offen offset:1024 sc1
    v_mfma_f32_16x16x32_bf16 v[60:63], v[148:151], v[160:163], v[60:63]
    s_waitcnt vmcnt(15)
    ds_read_b128 v[144:147], v1 offset:19456
    v_add_f32 v89, v89, v93
    v_mfma_f32_16x16x32_bf16 v[64:67], v[148:151], v[164:167], v[64:67]
    s_waitcnt lgkmcnt(5)
    buffer_load_dword v75, v5, s[4:7], s80 offen offset:1792 sc1
    v_mfma_f32_16x16x32_bf16 v[12:15], v[124:127], v[168:171], v[12:15]
    ds_read_b128 v[148:151], v1 offset:20480
    ds_write_b64 v210, v[88:89]
    v_mfma_f32_16x16x32_bf16 v[16:19], v[124:127], v[172:175], v[16:19]
    s_waitcnt lgkmcnt(5)
    buffer_load_dword v76, v5, s[4:7], s80 offen offset:2048 sc1
    v_mfma_f32_16x16x32_bf16 v[20:23], v[128:131], v[168:171], v[20:23]
    ds_read_b128 v[124:127], v1 offset:21504
    v_mfma_f32_16x16x32_bf16 v[24:27], v[128:131], v[172:175], v[24:27]
    buffer_load_dwordx4 v[160:163], v1, s[4:7], s72 offen offset:2048 sc1
    v_mfma_f32_16x16x32_bf16 v[28:31], v[132:135], v[168:171], v[28:31]
    ds_read_b128 v[128:131], v1 offset:22528
    v_mfma_f32_16x16x32_bf16 v[32:35], v[132:135], v[172:175], v[32:35]
    s_waitcnt lgkmcnt(5)
    buffer_load_dword v77, v5, s[4:7], s80 offen offset:2304 sc1
    v_mfma_f32_16x16x32_bf16 v[36:39], v[136:139], v[168:171], v[36:39]
    ds_read_b128 v[132:135], v1 offset:23552
    v_mfma_f32_16x16x32_bf16 v[40:43], v[136:139], v[172:175], v[40:43]
    buffer_load_dwordx4 v[164:167], v1, s[4:7], s73 offen offset:2048 sc1
    v_mfma_f32_16x16x32_bf16 v[44:47], v[140:143], v[168:171], v[44:47]
    ds_read_b128 v[136:139], v1 offset:24576
    v_mfma_f32_16x16x32_bf16 v[48:51], v[140:143], v[172:175], v[48:51]
    s_waitcnt lgkmcnt(5)
    buffer_load_dword v78, v5, s[4:7], s80 offen offset:2560 sc1
    v_mfma_f32_16x16x32_bf16 v[52:55], v[144:147], v[168:171], v[52:55]
    ds_read_b128 v[140:143], v1 offset:25600
    v_mfma_f32_16x16x32_bf16 v[56:59], v[144:147], v[172:175], v[56:59]
    buffer_load_dwordx4 a[72:75], v1, s[4:7], s81 offen offset:2048 sc1
    v_mfma_f32_16x16x32_bf16 v[60:63], v[148:151], v[168:171], v[60:63]
    s_waitcnt vmcnt(20)
    ds_read_b128 v[144:147], v1 offset:26624
    v_mfma_f32_16x16x32_bf16 v[64:67], v[148:151], v[172:175], v[64:67]
    s_waitcnt lgkmcnt(5)
    buffer_load_dword v79, v5, s[4:7], s80 offen offset:2816 sc1
    v_mfma_f32_16x16x32_bf16 v[12:15], v[124:127], v[176:179], v[12:15]
    ds_read_b128 v[148:151], v1 offset:27648
    v_mfma_f32_16x16x32_bf16 v[16:19], v[124:127], v[180:183], v[16:19]
    s_waitcnt lgkmcnt(4)
    buffer_load_dword v80, v5, s[4:7], s80 offen offset:3072 sc1
    v_mfma_f32_16x16x32_bf16 v[20:23], v[128:131], v[176:179], v[20:23]
    ds_read_b128 v[124:127], v1 offset:28672
    v_mfma_f32_16x16x32_bf16 v[24:27], v[128:131], v[180:183], v[24:27]
    buffer_load_dwordx4 v[168:171], v1, s[4:7], s72 offen offset:3072 sc1
    v_mfma_f32_16x16x32_bf16 v[28:31], v[132:135], v[176:179], v[28:31]
    ds_read_b128 v[128:131], v1 offset:29696
    v_mfma_f32_16x16x32_bf16 v[32:35], v[132:135], v[180:183], v[32:35]
    s_waitcnt lgkmcnt(4)
    buffer_load_dword v81, v5, s[4:7], s80 offen offset:3328 sc1
    v_mfma_f32_16x16x32_bf16 v[36:39], v[136:139], v[176:179], v[36:39]
    ds_read_b128 v[132:135], v1 offset:30720
    v_mfma_f32_16x16x32_bf16 v[40:43], v[136:139], v[180:183], v[40:43]
    buffer_load_dwordx4 v[172:175], v1, s[4:7], s73 offen offset:3072 sc1
    v_mfma_f32_16x16x32_bf16 v[44:47], v[140:143], v[176:179], v[44:47]
    s_add_u32 s72, s72, 4096
    ds_read_b128 v[136:139], v1 offset:31744
    v_mfma_f32_16x16x32_bf16 v[48:51], v[140:143], v[180:183], v[48:51]
    s_waitcnt lgkmcnt(4)
    buffer_load_dword v82, v5, s[4:7], s80 offen offset:3584 sc1
    v_mfma_f32_16x16x32_bf16 v[52:55], v[144:147], v[176:179], v[52:55]
    s_add_u32 s73, s73, 4096
    ds_read_b128 v[140:143], v1 offset:32768
    v_mfma_f32_16x16x32_bf16 v[56:59], v[144:147], v[180:183], v[56:59]
    buffer_load_dwordx4 a[76:79], v1, s[4:7], s81 offen offset:3072 sc1
    v_mfma_f32_16x16x32_bf16 v[60:63], v[148:151], v[176:179], v[60:63]
    s_add_u32 s81, s81, 4096
    s_waitcnt vmcnt(23)
    ds_read_b128 v[144:147], v1 offset:33792
    v_mfma_f32_16x16x32_bf16 v[64:67], v[148:151], v[180:183], v[64:67]
    s_waitcnt lgkmcnt(5)
    buffer_load_dword v83, v5, s[4:7], s80 offen offset:3840 sc1
    v_mfma_f32_16x16x32_bf16 v[12:15], v[124:127], v[184:187], v[12:15]
    ds_read_b128 v[148:151], v1 offset:34816
    v_mfma_f32_16x16x32_bf16 v[16:19], v[124:127], v[188:191], v[16:19]
    s_waitcnt lgkmcnt(4)
    s_waitcnt vmcnt(21)
    v_add_f32 v68, v68, v69
    v_add_f32 v70, v70, v71
    v_mfma_f32_16x16x32_bf16 v[20:23], v[128:131], v[184:187], v[20:23]
    ds_read_b128 v[124:127], v1 offset:35840
    v_add_f32 v68, v68, v70
    v_mfma_f32_16x16x32_bf16 v[24:27], v[128:131], v[188:191], v[24:27]
    buffer_load_dwordx4 v[176:179], v1, s[4:7], s72 offen offset:0 sc1
    v_mfma_f32_16x16x32_bf16 v[28:31], v[132:135], v[184:187], v[28:31]
    ds_read_b128 v[128:131], v1 offset:36864
    v_mov_b32 v69, v68
    v_mfma_f32_16x16x32_bf16 v[32:35], v[132:135], v[188:191], v[32:35]
    s_waitcnt lgkmcnt(4)
    v_permlane32_swap_b32 v68, v69
    v_mfma_f32_16x16x32_bf16 v[36:39], v[136:139], v[184:187], v[36:39]
    ds_read_b128 v[132:135], v1 offset:37888
    v_add_f32 v68, v68, v69
    v_mfma_f32_16x16x32_bf16 v[40:43], v[136:139], v[188:191], v[40:43]
    buffer_load_dwordx4 v[180:183], v1, s[4:7], s73 offen offset:0 sc1
    v_mfma_f32_16x16x32_bf16 v[44:47], v[140:143], v[184:187], v[44:47]
    ds_read_b128 v[136:139], v1 offset:38912
    v_mov_b32 v69, v68
    v_mfma_f32_16x16x32_bf16 v[48:51], v[140:143], v[188:191], v[48:51]
    s_waitcnt lgkmcnt(4)
    v_permlane16_swap_b32 v68, v69
    v_mfma_f32_16x16x32_bf16 v[52:55], v[144:147], v[184:187], v[52:55]
    ds_read_b128 v[140:143], v1 offset:39936
    v_mul_f32 v200, 0xbacccccd, v68
    v_mfma_f32_16x16x32_bf16 v[56:59], v[144:147], v[188:191], v[56:59]
    buffer_load_dwordx4 a[80:83], v1, s[4:7], s81 offen offset:0 sc1
    v_mfma_f32_16x16x32_bf16 v[60:63], v[148:151], v[184:187], v[60:63]
    s_waitcnt vmcnt(20)
    ds_read_b128 v[144:147], v1 offset:40960
    v_mul_f32 v69, 0x3acccccd, v69
    v_mfma_f32_16x16x32_bf16 v[64:67], v[148:151], v[188:191], v[64:67]
    s_waitcnt lgkmcnt(5)
    v_fma_f32 v69, -v200, v200, v69
    v_max_f32 v69, 0, v69
    v_mfma_f32_16x16x32_bf16 v[12:15], v[124:127], v[152:155], v[12:15]
    ds_read_b128 v[148:151], v1 offset:41984
    v_add_f32 v196, 0x3727c5ac, v69
    v_mfma_f32_16x16x32_bf16 v[16:19], v[124:127], v[156:159], v[16:19]
    s_waitcnt lgkmcnt(4)
    v_rsq_f32 v192, v196
    v_mfma_f32_16x16x32_bf16 v[20:23], v[128:131], v[152:155], v[20:23]
    ds_read_b128 v[124:127], v1 offset:43008
    v_mul_f32 v192, 0xbfb8aa3b, v192
    v_mfma_f32_16x16x32_bf16 v[24:27], v[128:131], v[156:159], v[24:27]
    buffer_load_dwordx4 v[184:187], v1, s[4:7], s72 offen offset:1024 sc1
    v_mfma_f32_16x16x32_bf16 v[28:31], v[132:135], v[152:155], v[28:31]
    ds_read_b128 v[128:131], v1 offset:44032
    v_mfma_f32_16x16x32_bf16 v[32:35], v[132:135], v[156:159], v[32:35]
    s_waitcnt lgkmcnt(4)
    s_waitcnt vmcnt(18)
    v_add_f32 v72, v72, v73
    v_add_f32 v74, v74, v75
    v_mfma_f32_16x16x32_bf16 v[36:39], v[136:139], v[152:155], v[36:39]
    ds_read_b128 v[132:135], v1 offset:45056
    v_add_f32 v72, v72, v74
    v_mfma_f32_16x16x32_bf16 v[40:43], v[136:139], v[156:159], v[40:43]
    buffer_load_dwordx4 v[188:191], v1, s[4:7], s73 offen offset:1024 sc1
    v_mfma_f32_16x16x32_bf16 v[44:47], v[140:143], v[152:155], v[44:47]
    ds_read_b128 v[136:139], v1 offset:46080
    v_mov_b32 v73, v72
    v_mfma_f32_16x16x32_bf16 v[48:51], v[140:143], v[156:159], v[48:51]
    s_waitcnt lgkmcnt(4)
    v_permlane32_swap_b32 v72, v73
    v_mfma_f32_16x16x32_bf16 v[52:55], v[144:147], v[152:155], v[52:55]
    ds_read_b128 v[140:143], v1 offset:47104
    v_add_f32 v72, v72, v73
    v_mfma_f32_16x16x32_bf16 v[56:59], v[144:147], v[156:159], v[56:59]
    buffer_load_dwordx4 a[84:87], v1, s[4:7], s81 offen offset:1024 sc1
    v_mfma_f32_16x16x32_bf16 v[60:63], v[148:151], v[152:155], v[60:63]
    s_waitcnt vmcnt(16)
    ds_read_b128 v[144:147], v1 offset:48128
    v_mov_b32 v73, v72
    v_mfma_f32_16x16x32_bf16 v[64:67], v[148:151], v[156:159], v[64:67]
    s_waitcnt lgkmcnt(5)
    v_permlane16_swap_b32 v72, v73
    v_mfma_f32_16x16x32_bf16 v[12:15], v[124:127], v[160:163], v[12:15]
    ds_read_b128 v[148:151], v1 offset:49152
    v_mul_f32 v201, 0xbacccccd, v72
    v_mfma_f32_16x16x32_bf16 v[16:19], v[124:127], v[164:167], v[16:19]
    s_waitcnt lgkmcnt(4)
    v_mul_f32 v73, 0x3acccccd, v73
    v_fma_f32 v73, -v201, v201, v73
    v_mfma_f32_16x16x32_bf16 v[20:23], v[128:131], v[160:163], v[20:23]
    ds_read_b128 v[124:127], v1 offset:50176
    v_max_f32 v73, 0, v73
    v_mfma_f32_16x16x32_bf16 v[24:27], v[128:131], v[164:167], v[24:27]
    buffer_load_dwordx4 v[152:155], v1, s[4:7], s72 offen offset:2048 sc1
    v_mfma_f32_16x16x32_bf16 v[28:31], v[132:135], v[160:163], v[28:31]
    ds_read_b128 v[128:131], v1 offset:51200
    v_add_f32 v197, 0x3727c5ac, v73
    v_mfma_f32_16x16x32_bf16 v[32:35], v[132:135], v[164:167], v[32:35]
    s_waitcnt lgkmcnt(4)
    buffer_load_dwordx4 a[88:91], v1, s[4:7], s81 offen offset:2048 sc1
    v_mfma_f32_16x16x32_bf16 v[36:39], v[136:139], v[160:163], v[36:39]
    ds_read_b128 v[132:135], v1 offset:52224
    v_mfma_f32_16x16x32_bf16 v[40:43], v[136:139], v[164:167], v[40:43]
    buffer_load_dwordx4 v[156:159], v1, s[4:7], s73 offen offset:2048 sc1
    v_mfma_f32_16x16x32_bf16 v[44:47], v[140:143], v[160:163], v[44:47]
    ds_read_b128 v[136:139], v1 offset:53248
    v_mfma_f32_16x16x32_bf16 v[48:51], v[140:143], v[164:167], v[48:51]
    s_waitcnt lgkmcnt(4)
    v_rsq_f32 v193, v197
    v_mfma_f32_16x16x32_bf16 v[52:55], v[144:147], v[160:163], v[52:55]
    ds_read_b128 v[140:143], v1 offset:54272
    v_mul_f32 v193, 0xbfb8aa3b, v193
    v_mfma_f32_16x16x32_bf16 v[56:59], v[144:147], v[164:167], v[56:59]
    buffer_load_dwordx4 a[92:95], v1, s[4:7], s81 offen offset:3072 sc1
    v_mfma_f32_16x16x32_bf16 v[60:63], v[148:151], v[160:163], v[60:63]
    s_add_u32 s81, s81, 4096
    s_waitcnt vmcnt(13)
    ds_read_b128 v[144:147], v1 offset:55296
    v_mfma_f32_16x16x32_bf16 v[64:67], v[148:151], v[164:167], v[64:67]
    s_waitcnt lgkmcnt(5)
    v_add_f32 v76, v76, v77
    v_add_f32 v78, v78, v79
    v_mfma_f32_16x16x32_bf16 v[12:15], v[124:127], v[168:171], v[12:15]
    ds_read_b128 v[148:151], v1 offset:56320
    v_add_f32 v76, v76, v78
    v_mfma_f32_16x16x32_bf16 v[16:19], v[124:127], v[172:175], v[16:19]
    s_waitcnt lgkmcnt(4)
    v_mov_b32 v77, v76
    v_mfma_f32_16x16x32_bf16 v[20:23], v[128:131], v[168:171], v[20:23]
    ds_read_b128 v[124:127], v1 offset:57344
    v_mfma_f32_16x16x32_bf16 v[24:27], v[128:131], v[172:175], v[24:27]
    buffer_load_dwordx4 v[160:163], v1, s[4:7], s72 offen offset:3072 sc1
    v_mfma_f32_16x16x32_bf16 v[28:31], v[132:135], v[168:171], v[28:31]
    ds_read_b128 v[128:131], v1 offset:58368
    v_mfma_f32_16x16x32_bf16 v[32:35], v[132:135], v[172:175], v[32:35]
    s_waitcnt lgkmcnt(4)
    v_permlane32_swap_b32 v76, v77
    v_mfma_f32_16x16x32_bf16 v[36:39], v[136:139], v[168:171], v[36:39]
    ds_read_b128 v[132:135], v1 offset:59392
    v_add_f32 v76, v76, v77
    v_mfma_f32_16x16x32_bf16 v[40:43], v[136:139], v[172:175], v[40:43]
    buffer_load_dwordx4 v[164:167], v1, s[4:7], s73 offen offset:3072 sc1
    v_mfma_f32_16x16x32_bf16 v[44:47], v[140:143], v[168:171], v[44:47]
    s_add_u32 s72, s72, 4096
    ds_read_b128 v[136:139], v1 offset:60416
    v_mov_b32 v77, v76
    v_mfma_f32_16x16x32_bf16 v[48:51], v[140:143], v[172:175], v[48:51]
    s_waitcnt lgkmcnt(4)
    v_permlane16_swap_b32 v76, v77
    v_mfma_f32_16x16x32_bf16 v[52:55], v[144:147], v[168:171], v[52:55]
    s_add_u32 s73, s73, 4096
    ds_read_b128 v[140:143], v1 offset:61440
    v_mul_f32 v202, 0xbacccccd, v76
    v_mfma_f32_16x16x32_bf16 v[56:59], v[144:147], v[172:175], v[56:59]
    buffer_load_dwordx4 a[96:99], v1, s[4:7], s81 offen offset:0 sc1
    v_mfma_f32_16x16x32_bf16 v[60:63], v[148:151], v[168:171], v[60:63]
    s_waitcnt vmcnt(11)
    ds_read_b128 v[144:147], v1 offset:62464
    v_mul_f32 v77, 0x3acccccd, v77
    v_mfma_f32_16x16x32_bf16 v[64:67], v[148:151], v[172:175], v[64:67]
    s_waitcnt lgkmcnt(5)
    v_fma_f32 v77, -v202, v202, v77
    v_max_f32 v77, 0, v77
    v_mfma_f32_16x16x32_bf16 v[12:15], v[124:127], v[176:179], v[12:15]
    ds_read_b128 v[148:151], v1 offset:63488
    v_add_f32 v198, 0x3727c5ac, v77
    v_mfma_f32_16x16x32_bf16 v[16:19], v[124:127], v[180:183], v[16:19]
    s_waitcnt lgkmcnt(4)
    v_rsq_f32 v194, v198
    v_mfma_f32_16x16x32_bf16 v[20:23], v[128:131], v[176:179], v[20:23]
    ds_read_b128 v[124:127], v9 offset:0
    v_mul_f32 v194, 0xbfb8aa3b, v194
    v_mfma_f32_16x16x32_bf16 v[24:27], v[128:131], v[180:183], v[24:27]
    buffer_load_dwordx4 v[168:171], v1, s[4:7], s72 offen offset:0 sc1
    v_mfma_f32_16x16x32_bf16 v[28:31], v[132:135], v[176:179], v[28:31]
    ds_read_b128 v[128:131], v9 offset:1024
    v_mfma_f32_16x16x32_bf16 v[32:35], v[132:135], v[180:183], v[32:35]
    s_waitcnt lgkmcnt(4)
    v_add_f32 v80, v80, v81
    v_add_f32 v82, v82, v83
    v_mfma_f32_16x16x32_bf16 v[36:39], v[136:139], v[176:179], v[36:39]
    ds_read_b128 v[132:135], v9 offset:2048
    v_add_f32 v80, v80, v82
    v_mfma_f32_16x16x32_bf16 v[40:43], v[136:139], v[180:183], v[40:43]
    buffer_load_dwordx4 v[172:175], v1, s[4:7], s73 offen offset:0 sc1
    v_mfma_f32_16x16x32_bf16 v[44:47], v[140:143], v[176:179], v[44:47]
    ds_read_b128 v[136:139], v9 offset:3072
    v_mov_b32 v81, v80
    v_mfma_f32_16x16x32_bf16 v[48:51], v[140:143], v[180:183], v[48:51]
    s_waitcnt lgkmcnt(4)
    v_permlane32_swap_b32 v80, v81
    v_mfma_f32_16x16x32_bf16 v[52:55], v[144:147], v[176:179], v[52:55]
    ds_read_b128 v[140:143], v9 offset:4096
    v_add_f32 v80, v80, v81
    v_mfma_f32_16x16x32_bf16 v[56:59], v[144:147], v[180:183], v[56:59]
    buffer_load_dwordx4 a[100:103], v1, s[4:7], s81 offen offset:1024 sc1
    v_mfma_f32_16x16x32_bf16 v[60:63], v[148:151], v[176:179], v[60:63]
    s_waitcnt vmcnt(11)
    ds_read_b128 v[144:147], v9 offset:5120
    v_mov_b32 v81, v80
    v_mfma_f32_16x16x32_bf16 v[64:67], v[148:151], v[180:183], v[64:67]
    s_waitcnt lgkmcnt(5)
    v_permlane16_swap_b32 v80, v81
    v_mfma_f32_16x16x32_bf16 v[12:15], v[124:127], v[184:187], v[12:15]
    ds_read_b128 v[148:151], v9 offset:6144
    v_mul_f32 v203, 0xbacccccd, v80
    v_mfma_f32_16x16x32_bf16 v[16:19], v[124:127], v[188:191], v[16:19]
    s_waitcnt lgkmcnt(4)
    v_mul_f32 v81, 0x3acccccd, v81
    v_fma_f32 v81, -v203, v203, v81
    v_mfma_f32_16x16x32_bf16 v[20:23], v[128:131], v[184:187], v[20:23]
    ds_read_b128 v[124:127], v9 offset:7168
    v_max_f32 v81, 0, v81
    v_mfma_f32_16x16x32_bf16 v[24:27], v[128:131], v[188:191], v[24:27]
    buffer_load_dwordx4 v[176:179], v1, s[4:7], s72 offen offset:1024 sc1
    v_mfma_f32_16x16x32_bf16 v[28:31], v[132:135], v[184:187], v[28:31]
    ds_read_b128 v[128:131], v9 offset:8192
    v_add_f32 v199, 0x3727c5ac, v81
    v_mfma_f32_16x16x32_bf16 v[32:35], v[132:135], v[188:191], v[32:35]
    s_waitcnt lgkmcnt(4)
    buffer_load_dwordx4 a[104:107], v1, s[4:7], s81 offen offset:2048 sc1
    v_mfma_f32_16x16x32_bf16 v[36:39], v[136:139], v[184:187], v[36:39]
    ds_read_b128 v[132:135], v9 offset:9216
    v_mfma_f32_16x16x32_bf16 v[40:43], v[136:139], v[188:191], v[40:43]
    buffer_load_dwordx4 v[180:183], v1, s[4:7], s73 offen offset:1024 sc1
    v_mfma_f32_16x16x32_bf16 v[44:47], v[140:143], v[184:187], v[44:47]
    ds_read_b128 v[136:139], v9 offset:10240
    v_mfma_f32_16x16x32_bf16 v[48:51], v[140:143], v[188:191], v[48:51]
    s_waitcnt lgkmcnt(4)
    v_rsq_f32 v195, v199
    v_mfma_f32_16x16x32_bf16 v[52:55], v[144:147], v[184:187], v[52:55]
    ds_read_b128 v[140:143], v9 offset:11264
    v_mul_f32 v195, 0xbfb8aa3b, v195
    v_mfma_f32_16x16x32_bf16 v[56:59], v[144:147], v[188:191], v[56:59]
    buffer_load_dwordx4 a[108:111], v1, s[4:7], s81 offen offset:3072 sc1
    v_mfma_f32_16x16x32_bf16 v[60:63], v[148:151], v[184:187], v[60:63]
    s_add_u32 s81, s81, 4096
    s_waitcnt vmcnt(11)
    ds_read_b128 v[144:147], v9 offset:12288
    v_mfma_f32_16x16x32_bf16 v[64:67], v[148:151], v[188:191], v[64:67]
    s_waitcnt lgkmcnt(5)
    v_mfma_f32_16x16x32_bf16 v[12:15], v[124:127], v[152:155], v[12:15]
    ds_read_b128 v[148:151], v9 offset:13312
    v_mfma_f32_16x16x32_bf16 v[16:19], v[124:127], v[156:159], v[16:19]
    s_waitcnt lgkmcnt(4)
    v_mfma_f32_16x16x32_bf16 v[20:23], v[128:131], v[152:155], v[20:23]
    ds_read_b128 v[124:127], v9 offset:14336
    v_mfma_f32_16x16x32_bf16 v[24:27], v[128:131], v[156:159], v[24:27]
    buffer_load_dwordx4 v[184:187], v1, s[4:7], s72 offen offset:2048 sc1
    v_mfma_f32_16x16x32_bf16 v[28:31], v[132:135], v[152:155], v[28:31]
    ds_read_b128 v[128:131], v9 offset:15360
    v_mfma_f32_16x16x32_bf16 v[32:35], v[132:135], v[156:159], v[32:35]
    s_waitcnt lgkmcnt(4)
    v_mfma_f32_16x16x32_bf16 v[36:39], v[136:139], v[152:155], v[36:39]
    ds_read_b128 v[132:135], v9 offset:16384
    v_mfma_f32_16x16x32_bf16 v[40:43], v[136:139], v[156:159], v[40:43]
    buffer_load_dwordx4 v[188:191], v1, s[4:7], s73 offen offset:2048 sc1
    v_mfma_f32_16x16x32_bf16 v[44:47], v[140:143], v[152:155], v[44:47]
    ds_read_b128 v[136:139], v9 offset:17408
    v_mfma_f32_16x16x32_bf16 v[48:51], v[140:143], v[156:159], v[48:51]
    s_waitcnt lgkmcnt(4)
    ds_read_b128 v[72:75], v211 offset:0
    v_mfma_f32_16x16x32_bf16 v[52:55], v[144:147], v[152:155], v[52:55]
    ds_read_b128 v[140:143], v9 offset:18432
    v_mfma_f32_16x16x32_bf16 v[56:59], v[144:147], v[156:159], v[56:59]
    buffer_load_dwordx4 a[112:115], v1, s[4:7], s81 offen offset:0 sc1
    v_mfma_f32_16x16x32_bf16 v[60:63], v[148:151], v[152:155], v[60:63]
    s_waitcnt vmcnt(11)
    ds_read_b128 v[144:147], v9 offset:19456
    v_mfma_f32_16x16x32_bf16 v[64:67], v[148:151], v[156:159], v[64:67]
    s_waitcnt lgkmcnt(6)
    v_mfma_f32_16x16x32_bf16 v[12:15], v[124:127], v[160:163], v[12:15]
    ds_read_b128 v[148:151], v9 offset:20480
    v_mfma_f32_16x16x32_bf16 v[16:19], v[124:127], v[164:167], v[16:19]
    s_waitcnt lgkmcnt(5)
    ds_read_b128 v[80:83], v211 offset:64
    v_mfma_f32_16x16x32_bf16 v[20:23], v[128:131], v[160:163], v[20:23]
    s_waitcnt lgkmcnt(4)
    ds_read_b128 v[124:127], v9 offset:21504
    v_mfma_f32_16x16x32_bf16 v[24:27], v[128:131], v[164:167], v[24:27]
    buffer_load_dwordx4 v[152:155], v1, s[4:7], s72 offen offset:3072 sc1
    v_mfma_f32_16x16x32_bf16 v[28:31], v[132:135], v[160:163], v[28:31]
    ds_read_b128 v[128:131], v9 offset:22528
    v_fmac_f32 v12, v200, v72
    v_mfma_f32_16x16x32_bf16 v[32:35], v[132:135], v[164:167], v[32:35]
    s_waitcnt lgkmcnt(5)
    buffer_load_dwordx4 a[116:119], v1, s[4:7], s81 offen offset:1024 sc1
    v_mfma_f32_16x16x32_bf16 v[36:39], v[136:139], v[160:163], v[36:39]
    ds_read_b128 v[132:135], v9 offset:23552
    v_fmac_f32 v13, v200, v73
    v_mfma_f32_16x16x32_bf16 v[40:43], v[136:139], v[164:167], v[40:43]
    buffer_load_dwordx4 v[156:159], v1, s[4:7], s73 offen offset:3072 sc1
    v_mfma_f32_16x16x32_bf16 v[44:47], v[140:143], v[160:163], v[44:47]
    s_add_u32 s72, s72, 4096
    ds_read_b128 v[136:139], v9 offset:24576
    v_fmac_f32 v14, v200, v74
    v_mfma_f32_16x16x32_bf16 v[48:51], v[140:143], v[164:167], v[48:51]
    s_waitcnt lgkmcnt(5)
    v_fmac_f32 v15, v200, v75
    v_fmac_f32 v16, v201, v72
    v_mfma_f32_16x16x32_bf16 v[52:55], v[144:147], v[160:163], v[52:55]
    s_add_u32 s73, s73, 4096
    ds_read_b128 v[140:143], v9 offset:25600
    v_fmac_f32 v17, v201, v73
    v_mfma_f32_16x16x32_bf16 v[56:59], v[144:147], v[164:167], v[56:59]
    buffer_load_dwordx4 a[120:123], v1, s[4:7], s81 offen offset:2048 sc1
    v_mfma_f32_16x16x32_bf16 v[60:63], v[148:151], v[160:163], v[60:63]
    s_waitcnt vmcnt(12)
    ds_read_b128 v[144:147], v9 offset:26624
    v_fmac_f32 v18, v201, v74
    v_mfma_f32_16x16x32_bf16 v[64:67], v[148:151], v[164:167], v[64:67]
    s_waitcnt lgkmcnt(5)
    v_fmac_f32 v19, v201, v75
    v_mfma_f32_16x16x32_bf16 v[12:15], v[124:127], v[168:171], v[12:15]
    ds_read_b128 v[148:151], v9 offset:27648
    v_mul_f32 v68, v202, v72
    v_mfma_f32_16x16x32_bf16 v[16:19], v[124:127], v[172:175], v[16:19]
    s_waitcnt lgkmcnt(4)
    v_mul_f32 v69, v202, v73
    v_mul_f32 v70, v202, v74
    v_mfma_f32_16x16x32_bf16 v[20:23], v[128:131], v[168:171], v[20:23]
    ds_read_b128 v[124:127], v9 offset:28672
    v_mul_f32 v71, v202, v75
    v_mfma_f32_16x16x32_bf16 v[24:27], v[128:131], v[172:175], v[24:27]
    buffer_load_dwordx4 v[160:163], v1, s[4:7], s72 offen offset:0 sc1
    v_mfma_f32_16x16x32_bf16 v[28:31], v[132:135], v[168:171], v[28:31]
    ds_read_b128 v[128:131], v9 offset:29696
    v_mul_f32 v72, v203, v72
    v_mfma_f32_16x16x32_bf16 v[32:35], v[132:135], v[172:175], v[32:35]
    s_waitcnt lgkmcnt(4)
    v_mul_f32 v73, v203, v73
    v_mul_f32 v74, v203, v74
    v_mfma_f32_16x16x32_bf16 v[36:39], v[136:139], v[168:171], v[36:39]
    ds_read_b128 v[132:135], v9 offset:30720
    v_fmac_f32 v20, v200, v80
    v_mfma_f32_16x16x32_bf16 v[40:43], v[136:139], v[172:175], v[40:43]
    buffer_load_dwordx4 v[164:167], v1, s[4:7], s73 offen offset:0 sc1
    v_mfma_f32_16x16x32_bf16 v[44:47], v[140:143], v[168:171], v[44:47]
    ds_read_b128 v[136:139], v9 offset:31744
    v_fmac_f32 v21, v200, v81
    v_mfma_f32_16x16x32_bf16 v[48:51], v[140:143], v[172:175], v[48:51]
    s_waitcnt lgkmcnt(4)
    v_fmac_f32 v22, v200, v82
    v_fmac_f32 v23, v200, v83
    v_mfma_f32_16x16x32_bf16 v[52:55], v[144:147], v[168:171], v[52:55]
    ds_read_b128 v[140:143], v9 offset:32768
    v_fmac_f32 v24, v201, v80
    v_mfma_f32_16x16x32_bf16 v[56:59], v[144:147], v[172:175], v[56:59]
    buffer_load_dwordx4 a[124:127], v1, s[4:7], s81 offen offset:3072 sc1
    v_mfma_f32_16x16x32_bf16 v[60:63], v[148:151], v[168:171], v[60:63]
    s_add_u32 s81, s81, 4096
    s_waitcnt vmcnt(11)
    ds_read_b128 v[144:147], v9 offset:33792
    v_fmac_f32 v25, v201, v81
    v_mfma_f32_16x16x32_bf16 v[64:67], v[148:151], v[172:175], v[64:67]
    s_waitcnt lgkmcnt(5)
    v_fmac_f32 v26, v201, v82
    v_fmac_f32 v27, v201, v83
    v_mfma_f32_16x16x32_bf16 v[12:15], v[124:127], v[176:179], v[12:15]
    ds_read_b128 v[148:151], v9 offset:34816
    v_mul_f32 v75, v203, v75
    v_mfma_f32_16x16x32_bf16 v[16:19], v[124:127], v[180:183], v[16:19]
    s_waitcnt lgkmcnt(4)
    ds_read_b128 v[88:91], v211 offset:128
    v_mul_f32 v76, v202, v80
    v_mfma_f32_16x16x32_bf16 v[20:23], v[128:131], v[176:179], v[20:23]
    ds_read_b128 v[124:127], v9 offset:35840
    v_mul_f32 v77, v202, v81
    v_mfma_f32_16x16x32_bf16 v[24:27], v[128:131], v[180:183], v[24:27]
    buffer_load_dwordx4 v[168:171], v1, s[4:7], s72 offen offset:1024 sc1
    v_mfma_f32_16x16x32_bf16 v[28:31], v[132:135], v[176:179], v[28:31]
    ds_read_b128 v[128:131], v9 offset:36864
    v_mul_f32 v78, v202, v82
    v_mfma_f32_16x16x32_bf16 v[32:35], v[132:135], v[180:183], v[32:35]
    s_waitcnt lgkmcnt(5)
    v_mul_f32 v79, v202, v83
    v_mul_f32 v80, v203, v80
    v_mfma_f32_16x16x32_bf16 v[36:39], v[136:139], v[176:179], v[36:39]
    s_waitcnt lgkmcnt(2)
    ds_read_b128 v[132:135], v9 offset:37888
    v_mul_f32 v81, v203, v81
    v_mfma_f32_16x16x32_bf16 v[40:43], v[136:139], v[180:183], v[40:43]
    buffer_load_dwordx4 v[172:175], v1, s[4:7], s73 offen offset:1024 sc1
    v_mfma_f32_16x16x32_bf16 v[44:47], v[140:143], v[176:179], v[44:47]
    ds_read_b128 v[136:139], v9 offset:38912
    v_fmac_f32 v28, v200, v88
    v_mfma_f32_16x16x32_bf16 v[48:51], v[140:143], v[180:183], v[48:51]
    v_fmac_f32 v29, v200, v89
    v_fmac_f32 v30, v200, v90
    v_mfma_f32_16x16x32_bf16 v[52:55], v[144:147], v[176:179], v[52:55]
    ds_read_b128 v[140:143], v9 offset:39936
    v_fmac_f32 v31, v200, v91
    v_mfma_f32_16x16x32_bf16 v[56:59], v[144:147], v[180:183], v[56:59]
    buffer_load_dwordx4 a[128:131], v1, s[4:7], s81 offen offset:0 sc1
    v_mfma_f32_16x16x32_bf16 v[60:63], v[148:151], v[176:179], v[60:63]
    s_waitcnt vmcnt(11)
    ds_read_b128 v[144:147], v9 offset:40960
    v_fmac_f32 v32, v201, v88
    v_mfma_f32_16x16x32_bf16 v[64:67], v[148:151], v[180:183], v[64:67]
    s_waitcnt lgkmcnt(5)
    v_fmac_f32 v33, v201, v89
    v_fmac_f32 v34, v201, v90
    v_mfma_f32_16x16x32_bf16 v[12:15], v[124:127], v[184:187], v[12:15]
    ds_read_b128 v[148:151], v9 offset:41984
    v_fmac_f32 v35, v201, v91
    v_mfma_f32_16x16x32_bf16 v[16:19], v[124:127], v[188:191], v[16:19]
    s_waitcnt lgkmcnt(4)
    ds_read_b128 v[96:99], v211 offset:192
    v_mul_f32 v82, v203, v82
    v_mfma_f32_16x16x32_bf16 v[20:23], v[128:131], v[184:187], v[20:23]
    ds_read_b128 v[124:127], v9 offset:43008
    v_mul_f32 v83, v203, v83
    v_mfma_f32_16x16x32_bf16 v[24:27], v[128:131], v[188:191], v[24:27]
    buffer_load_dwordx4 v[176:179], v1, s[4:7], s72 offen offset:2048 sc1
    v_mfma_f32_16x16x32_bf16 v[28:31], v[132:135], v[184:187], v[28:31]
    ds_read_b128 v[128:131], v9 offset:44032
    v_mul_f32 v84, v202, v88
    v_mfma_f32_16x16x32_bf16 v[32:35], v[132:135], v[188:191], v[32:35]
    s_waitcnt lgkmcnt(5)
    buffer_load_dwordx4 a[132:135], v1, s[4:7], s81 offen offset:1024 sc1
    v_mfma_f32_16x16x32_bf16 v[36:39], v[136:139], v[184:187], v[36:39]
    ds_read_b128 v[132:135], v9 offset:45056
    v_mul_f32 v85, v202, v89
    v_mfma_f32_16x16x32_bf16 v[40:43], v[136:139], v[188:191], v[40:43]
    buffer_load_dwordx4 v[180:183], v1, s[4:7], s73 offen offset:2048 sc1
    v_mfma_f32_16x16x32_bf16 v[44:47], v[140:143], v[184:187], v[44:47]
    s_waitcnt lgkmcnt(3)
    ds_read_b128 v[136:139], v9 offset:46080
    v_mul_f32 v86, v202, v90
    v_mfma_f32_16x16x32_bf16 v[48:51], v[140:143], v[188:191], v[48:51]
    v_mul_f32 v87, v202, v91
    v_mul_f32 v88, v203, v88
    v_mfma_f32_16x16x32_bf16 v[52:55], v[144:147], v[184:187], v[52:55]
    ds_read_b128 v[140:143], v9 offset:47104
    v_fmac_f32 v36, v200, v96
    v_mfma_f32_16x16x32_bf16 v[56:59], v[144:147], v[188:191], v[56:59]
    buffer_load_dwordx4 a[136:139], v1, s[4:7], s81 offen offset:2048 sc1
    v_mfma_f32_16x16x32_bf16 v[60:63], v[148:151], v[184:187], v[60:63]
    s_waitcnt vmcnt(11)
    ds_read_b128 v[144:147], v9 offset:48128
    v_fmac_f32 v37, v200, v97
    v_mfma_f32_16x16x32_bf16 v[64:67], v[148:151], v[188:191], v[64:67]
    s_waitcnt lgkmcnt(5)
    v_fmac_f32 v38, v200, v98
    v_fmac_f32 v39, v200, v99
    v_mfma_f32_16x16x32_bf16 v[12:15], v[124:127], v[152:155], v[12:15]
    ds_read_b128 v[148:151], v9 offset:49152
    v_fmac_f32 v40, v201, v96
    v_mfma_f32_16x16x32_bf16 v[16:19], v[124:127], v[156:159], v[16:19]
    s_waitcnt lgkmcnt(4)
    v_fmac_f32 v41, v201, v97
    v_fmac_f32 v42, v201, v98
    v_mfma_f32_16x16x32_bf16 v[20:23], v[128:131], v[152:155], v[20:23]
    ds_read_b128 v[124:127], v9 offset:50176
    v_fmac_f32 v43, v201, v99
    v_mfma_f32_16x16x32_bf16 v[24:27], v[128:131], v[156:159], v[24:27]
    buffer_load_dwordx4 v[184:187], v1, s[4:7], s72 offen offset:3072 sc1
    v_mfma_f32_16x16x32_bf16 v[28:31], v[132:135], v[152:155], v[28:31]
    ds_read_b128 v[128:131], v9 offset:51200
    v_mul_f32 v89, v203, v89
    v_mfma_f32_16x16x32_bf16 v[32:35], v[132:135], v[156:159], v[32:35]
    s_waitcnt lgkmcnt(4)
    ds_read_b128 v[104:107], v211 offset:256
    v_mul_f32 v90, v203, v90
    v_mfma_f32_16x16x32_bf16 v[36:39], v[136:139], v[152:155], v[36:39]
    ds_read_b128 v[132:135], v9 offset:52224
    v_mul_f32 v91, v203, v91
    v_mfma_f32_16x16x32_bf16 v[40:43], v[136:139], v[156:159], v[40:43]
    buffer_load_dwordx4 v[188:191], v1, s[4:7], s73 offen offset:3072 sc1
    v_mfma_f32_16x16x32_bf16 v[44:47], v[140:143], v[152:155], v[44:47]
    s_add_u32 s72, s72, 4096
    ds_read_b128 v[136:139], v9 offset:53248
    v_mul_f32 v92, v202, v96
    v_mfma_f32_16x16x32_bf16 v[48:51], v[140:143], v[156:159], v[48:51]
    s_waitcnt lgkmcnt(5)
    v_mul_f32 v93, v202, v97
    v_mul_f32 v94, v202, v98
    v_mfma_f32_16x16x32_bf16 v[52:55], v[144:147], v[152:155], v[52:55]
    s_waitcnt lgkmcnt(2)
    s_add_u32 s73, s73, 4096
    ds_read_b128 v[140:143], v9 offset:54272
    v_mfma_f32_16x16x32_bf16 v[56:59], v[144:147], v[156:159], v[56:59]
    buffer_load_dwordx4 a[140:143], v1, s[4:7], s81 offen offset:3072 sc1
    v_mfma_f32_16x16x32_bf16 v[60:63], v[148:151], v[152:155], v[60:63]
    s_add_u32 s81, s81, 4096
    s_waitcnt vmcnt(11)
    ds_read_b128 v[144:147], v9 offset:55296
    v_fmac_f32 v44, v200, v104
    v_mfma_f32_16x16x32_bf16 v[64:67], v[148:151], v[156:159], v[64:67]
    v_fmac_f32 v45, v200, v105
    v_fmac_f32 v46, v200, v106
    v_mfma_f32_16x16x32_bf16 v[12:15], v[124:127], v[160:163], v[12:15]
    ds_read_b128 v[148:151], v9 offset:56320
    v_fmac_f32 v47, v200, v107
    v_mfma_f32_16x16x32_bf16 v[16:19], v[124:127], v[164:167], v[16:19]
    s_waitcnt lgkmcnt(4)
    v_fmac_f32 v48, v201, v104
    v_fmac_f32 v49, v201, v105
    v_mfma_f32_16x16x32_bf16 v[20:23], v[128:131], v[160:163], v[20:23]
    ds_read_b128 v[124:127], v9 offset:57344
    v_fmac_f32 v50, v201, v106
    v_mfma_f32_16x16x32_bf16 v[24:27], v[128:131], v[164:167], v[24:27]
    buffer_load_dwordx4 v[152:155], v1, s[4:7], s74 offen offset:0 sc1
    v_mfma_f32_16x16x32_bf16 v[28:31], v[132:135], v[160:163], v[28:31]
    ds_read_b128 v[128:131], v9 offset:58368
    v_fmac_f32 v51, v201, v107
    v_mfma_f32_16x16x32_bf16 v[32:35], v[132:135], v[164:167], v[32:35]
    s_waitcnt lgkmcnt(4)
    ds_read_b128 v[112:115], v211 offset:320
    v_mul_f32 v95, v202, v99
    v_mfma_f32_16x16x32_bf16 v[36:39], v[136:139], v[160:163], v[36:39]
    ds_read_b128 v[132:135], v9 offset:59392
    v_mul_f32 v96, v203, v96
    v_mfma_f32_16x16x32_bf16 v[40:43], v[136:139], v[164:167], v[40:43]
    buffer_load_dwordx4 v[156:159], v1, s[4:7], s75 offen offset:0 sc1
    v_mfma_f32_16x16x32_bf16 v[44:47], v[140:143], v[160:163], v[44:47]
    ds_read_b128 v[136:139], v9 offset:60416
    v_mul_f32 v97, v203, v97
    v_mfma_f32_16x16x32_bf16 v[48:51], v[140:143], v[164:167], v[48:51]
    s_waitcnt lgkmcnt(5)
    v_mul_f32 v98, v203, v98
    v_mul_f32 v99, v203, v99
    v_mfma_f32_16x16x32_bf16 v[52:55], v[144:147], v[160:163], v[52:55]
    ds_read_b128 v[140:143], v9 offset:61440
    v_mul_f32 v100, v202, v104
    v_mfma_f32_16x16x32_bf16 v[56:59], v[144:147], v[164:167], v[56:59]
    buffer_load_dwordx4 a[144:147], v1, s[4:7], s81 offen offset:0 sc1
    v_mfma_f32_16x16x32_bf16 v[60:63], v[148:151], v[160:163], v[60:63]
    s_waitcnt lgkmcnt(3)
    s_waitcnt vmcnt(11)
    ds_read_b128 v[144:147], v9 offset:62464
    v_mul_f32 v101, v202, v105
    v_mfma_f32_16x16x32_bf16 v[64:67], v[148:151], v[164:167], v[64:67]
    ds_read_b128 v[120:123], v211 offset:384
    v_mul_f32 v102, v202, v106
    v_mfma_f32_16x16x32_bf16 v[12:15], v[124:127], v[168:171], v[12:15]
    ds_read_b128 v[148:151], v9 offset:63488
    v_fmac_f32 v52, v200, v112
    v_mfma_f32_16x16x32_bf16 v[16:19], v[124:127], v[172:175], v[16:19]
    s_waitcnt lgkmcnt(5)
    v_fmac_f32 v53, v200, v113
    v_fmac_f32 v54, v200, v114
    v_mfma_f32_16x16x32_bf16 v[20:23], v[128:131], v[168:171], v[20:23]
    ds_read_b128 v[124:127], v10 offset:0
    v_fmac_f32 v55, v200, v115
    v_mfma_f32_16x16x32_bf16 v[24:27], v[128:131], v[172:175], v[24:27]
    buffer_load_dwordx4 v[160:163], v1, s[4:7], s74 offen offset:1024 sc1
    v_mfma_f32_16x16x32_bf16 v[28:31], v[132:135], v[168:171], v[28:31]
    ds_read_b128 v[128:131], v10 offset:1024
    v_fmac_f32 v56, v201, v112
    v_mfma_f32_16x16x32_bf16 v[32:35], v[132:135], v[172:175], v[32:35]
    s_waitcnt lgkmcnt(5)
    buffer_load_dwordx4 a[148:151], v1, s[4:7], s81 offen offset:1024 sc1
    v_mfma_f32_16x16x32_bf16 v[36:39], v[136:139], v[168:171], v[36:39]
    ds_read_b128 v[132:135], v10 offset:2048
    v_fmac_f32 v57, v201, v113
    v_mfma_f32_16x16x32_bf16 v[40:43], v[136:139], v[172:175], v[40:43]
    buffer_load_dwordx4 v[164:167], v1, s[4:7], s75 offen offset:1024 sc1
    v_mfma_f32_16x16x32_bf16 v[44:47], v[140:143], v[168:171], v[44:47]
    ds_read_b128 v[136:139], v10 offset:3072
    v_fmac_f32 v58, v201, v114
    v_mfma_f32_16x16x32_bf16 v[48:51], v[140:143], v[172:175], v[48:51]
    s_waitcnt lgkmcnt(4)
    v_fmac_f32 v59, v201, v115
    v_mul_f32 v103, v202, v107
    v_mfma_f32_16x16x32_bf16 v[52:55], v[144:147], v[168:171], v[52:55]
    ds_read_b128 v[140:143], v10 offset:4096
    v_mul_f32 v104, v203, v104
    v_mfma_f32_16x16x32_bf16 v[56:59], v[144:147], v[172:175], v[56:59]
    buffer_load_dwordx4 a[152:155], v1, s[4:7], s81 offen offset:2048 sc1
    v_mfma_f32_16x16x32_bf16 v[60:63], v[148:151], v[168:171], v[60:63]
    s_waitcnt vmcnt(11)
    ds_read_b128 v[144:147], v10 offset:5120
    v_mul_f32 v105, v203, v105
    v_mfma_f32_16x16x32_bf16 v[64:67], v[148:151], v[172:175], v[64:67]
    s_waitcnt lgkmcnt(5)
    v_mul_f32 v106, v203, v106
    v_mul_f32 v107, v203, v107
    v_mfma_f32_16x16x32_bf16 v[12:15], v[124:127], v[176:179], v[12:15]
    ds_read_b128 v[148:151], v10 offset:6144
    v_mul_f32 v108, v202, v112
    v_mfma_f32_16x16x32_bf16 v[16:19], v[124:127], v[180:183], v[16:19]
    s_waitcnt lgkmcnt(4)
    v_mul_f32 v109, v202, v113
    v_mul_f32 v110, v202, v114
    v_mfma_f32_16x16x32_bf16 v[20:23], v[128:131], v[176:179], v[20:23]
    ds_read_b128 v[124:127], v10 offset:7168
    v_fmac_f32 v60, v200, v120
    v_mfma_f32_16x16x32_bf16 v[24:27], v[128:131], v[180:183], v[24:27]
    buffer_load_dwordx4 v[168:171], v1, s[4:7], s74 offen offset:2048 sc1
    v_mfma_f32_16x16x32_bf16 v[28:31], v[132:135], v[176:179], v[28:31]
    ds_read_b128 v[128:131], v10 offset:8192
    v_fmac_f32 v61, v200, v121
    v_mfma_f32_16x16x32_bf16 v[32:35], v[132:135], v[180:183], v[32:35]
    s_waitcnt lgkmcnt(4)
    v_fmac_f32 v62, v200, v122
    v_fmac_f32 v63, v200, v123
    v_mfma_f32_16x16x32_bf16 v[36:39], v[136:139], v[176:179], v[36:39]
    ds_read_b128 v[132:135], v10 offset:9216
    v_fmac_f32 v64, v201, v120
    v_mfma_f32_16x16x32_bf16 v[40:43], v[136:139], v[180:183], v[40:43]
    buffer_load_dwordx4 v[172:175], v1, s[4:7], s75 offen offset:2048 sc1
    v_mfma_f32_16x16x32_bf16 v[44:47], v[140:143], v[176:179], v[44:47]
    ds_read_b128 v[136:139], v10 offset:10240
    v_fmac_f32 v65, v201, v121
    v_mfma_f32_16x16x32_bf16 v[48:51], v[140:143], v[180:183], v[48:51]
    s_waitcnt lgkmcnt(4)
    v_fmac_f32 v66, v201, v122
    v_fmac_f32 v67, v201, v123
    v_mfma_f32_16x16x32_bf16 v[52:55], v[144:147], v[176:179], v[52:55]
    ds_read_b128 v[140:143], v10 offset:11264
    v_mul_f32 v111, v202, v115
    v_mfma_f32_16x16x32_bf16 v[56:59], v[144:147], v[180:183], v[56:59]
    buffer_load_dwordx4 a[156:159], v1, s[4:7], s81 offen offset:3072 sc1
    v_mfma_f32_16x16x32_bf16 v[60:63], v[148:151], v[176:179], v[60:63]
    s_add_u32 s81, s81, 4096
    s_waitcnt vmcnt(11)
    ds_read_b128 v[144:147], v10 offset:12288
    v_mul_f32 v112, v203, v112
    v_mfma_f32_16x16x32_bf16 v[64:67], v[148:151], v[180:183], v[64:67]
    s_waitcnt lgkmcnt(5)
    v_mul_f32 v113, v203, v113
    v_mul_f32 v114, v203, v114
    v_mfma_f32_16x16x32_bf16 v[12:15], v[124:127], v[184:187], v[12:15]
    ds_read_b128 v[148:151], v10 offset:13312
    v_mul_f32 v115, v203, v115
    v_mfma_f32_16x16x32_bf16 v[16:19], v[124:127], v[188:191], v[16:19]
    s_waitcnt lgkmcnt(4)
    v_mul_f32 v116, v202, v120
    v_mul_f32 v117, v202, v121
    v_mfma_f32_16x16x32_bf16 v[20:23], v[128:131], v[184:187], v[20:23]
    ds_read_b128 v[124:127], v1 offset:0
    v_mul_f32 v118, v202, v122
    v_mfma_f32_16x16x32_bf16 v[24:27], v[128:131], v[188:191], v[24:27]
    buffer_load_dwordx4 v[176:179], v1, s[4:7], s74 offen offset:3072 sc1
    v_mfma_f32_16x16x32_bf16 v[28:31], v[132:135], v[184:187], v[28:31]
    ds_read_b128 v[128:131], v1 offset:1024
    v_mul_f32 v119, v202, v123
    v_mfma_f32_16x16x32_bf16 v[32:35], v[132:135], v[188:191], v[32:35]
    s_waitcnt lgkmcnt(4)
    buffer_load_dwordx4 a[160:163], v1, s[4:7], s81 offen offset:0 sc1
    v_mfma_f32_16x16x32_bf16 v[36:39], v[136:139], v[184:187], v[36:39]
    ds_read_b128 v[132:135], v1 offset:2048
    v_mul_f32 v120, v203, v120
    v_mfma_f32_16x16x32_bf16 v[40:43], v[136:139], v[188:191], v[40:43]
    buffer_load_dwordx4 v[180:183], v1, s[4:7], s75 offen offset:3072 sc1
    v_mfma_f32_16x16x32_bf16 v[44:47], v[140:143], v[184:187], v[44:47]
    s_add_u32 s74, s74, 4096
    ds_read_b128 v[136:139], v1 offset:3072
    v_mul_f32 v121, v203, v121
    v_mfma_f32_16x16x32_bf16 v[48:51], v[140:143], v[188:191], v[48:51]
    s_waitcnt lgkmcnt(4)
    v_mul_f32 v122, v203, v122
    v_mul_f32 v123, v203, v123
    v_mfma_f32_16x16x32_bf16 v[52:55], v[144:147], v[184:187], v[52:55]
    s_add_u32 s75, s75, 4096
    ds_read_b128 v[140:143], v1 offset:4096
    v_mfma_f32_16x16x32_bf16 v[56:59], v[144:147], v[188:191], v[56:59]
    buffer_load_dwordx4 a[164:167], v1, s[4:7], s81 offen offset:1024 sc1
    v_mfma_f32_16x16x32_bf16 v[60:63], v[148:151], v[184:187], v[60:63]
    s_waitcnt vmcnt(12)
    ds_read_b128 v[144:147], v1 offset:5120
    v_mfma_f32_16x16x32_bf16 v[64:67], v[148:151], v[188:191], v[64:67]
    s_waitcnt lgkmcnt(5)
    v_mfma_f32_16x16x32_bf16 v[68:71], v[124:127], v[152:155], v[68:71]
    ds_read_b128 v[148:151], v1 offset:6144
    v_mfma_f32_16x16x32_bf16 v[72:75], v[124:127], v[156:159], v[72:75]
    s_waitcnt lgkmcnt(4)
    v_mfma_f32_16x16x32_bf16 v[76:79], v[128:131], v[152:155], v[76:79]
    ds_read_b128 v[124:127], v1 offset:7168
    v_mfma_f32_16x16x32_bf16 v[80:83], v[128:131], v[156:159], v[80:83]
    buffer_load_dwordx4 v[184:187], v1, s[4:7], s74 offen offset:0 sc1
    v_mfma_f32_16x16x32_bf16 v[84:87], v[132:135], v[152:155], v[84:87]
    ds_read_b128 v[128:131], v1 offset:8192
    v_mul_f32 v28, v12, v28
    v_mfma_f32_16x16x32_bf16 v[88:91], v[132:135], v[156:159], v[88:91]
    s_waitcnt lgkmcnt(4)
    v_mul_f32 v29, v13, v29
    v_mul_f32 v30, v14, v30
    v_mfma_f32_16x16x32_bf16 v[92:95], v[136:139], v[152:155], v[92:95]
    ds_read_b128 v[132:135], v1 offset:9216
    v_mul_f32 v31, v15, v31
    v_mfma_f32_16x16x32_bf16 v[96:99], v[136:139], v[156:159], v[96:99]
    buffer_load_dwordx4 v[188:191], v1, s[4:7], s75 offen offset:0 sc1
    v_mfma_f32_16x16x32_bf16 v[100:103], v[140:143], v[152:155], v[100:103]
    ds_read_b128 v[136:139], v1 offset:10240
    v_mul_f32 v12, v12, v192
    v_mfma_f32_16x16x32_bf16 v[104:107], v[140:143], v[156:159], v[104:107]
    s_waitcnt lgkmcnt(4)
    v_exp_f32 v12, v12
    v_mfma_f32_16x16x32_bf16 v[108:111], v[144:147], v[152:155], v[108:111]
    ds_read_b128 v[140:143], v1 offset:11264
    v_mul_f32 v13, v13, v192
    v_mfma_f32_16x16x32_bf16 v[112:115], v[144:147], v[156:159], v[112:115]
    buffer_load_dwordx4 a[168:171], v1, s[4:7], s81 offen offset:2048 sc1
    v_mfma_f32_16x16x32_bf16 v[116:119], v[148:151], v[152:155], v[116:119]
    s_waitcnt vmcnt(11)
    ds_read_b128 v[144:147], v1 offset:12288
    v_mul_f32 v14, v14, v192
    v_mfma_f32_16x16x32_bf16 v[120:123], v[148:151], v[156:159], v[120:123]
    s_waitcnt lgkmcnt(5)
    v_exp_f32 v13, v13
    v_mfma_f32_16x16x32_bf16 v[68:71], v[124:127], v[160:163], v[68:71]
    ds_read_b128 v[148:151], v1 offset:13312
    v_mul_f32 v15, v15, v192
    v_mfma_f32_16x16x32_bf16 v[72:75], v[124:127], v[164:167], v[72:75]
    s_waitcnt lgkmcnt(4)
    v_exp_f32 v14, v14
    v_mfma_f32_16x16x32_bf16 v[76:79], v[128:131], v[160:163], v[76:79]
    ds_read_b128 v[124:127], v1 offset:14336
    v_fma_f32 v12, v12, v196, v196
    v_mfma_f32_16x16x32_bf16 v[80:83], v[128:131], v[164:167], v[80:83]
    buffer_load_dwordx4 v[152:155], v1, s[4:7], s74 offen offset:1024 sc1
    v_mfma_f32_16x16x32_bf16 v[84:87], v[132:135], v[160:163], v[84:87]
    ds_read_b128 v[128:131], v1 offset:15360
    v_fma_f32 v13, v13, v196, v196
    v_mfma_f32_16x16x32_bf16 v[88:91], v[132:135], v[164:167], v[88:91]
    s_waitcnt lgkmcnt(4)
    v_exp_f32 v15, v15
    v_mfma_f32_16x16x32_bf16 v[92:95], v[136:139], v[160:163], v[92:95]
    ds_read_b128 v[132:135], v1 offset:16384
    v_fma_f32 v14, v14, v196, v196
    v_mfma_f32_16x16x32_bf16 v[96:99], v[136:139], v[164:167], v[96:99]
    buffer_load_dwordx4 v[156:159], v1, s[4:7], s75 offen offset:1024 sc1
    v_mfma_f32_16x16x32_bf16 v[100:103], v[140:143], v[160:163], v[100:103]
    ds_read_b128 v[136:139], v1 offset:17408
    v_fma_f32 v15, v15, v196, v196
    v_mfma_f32_16x16x32_bf16 v[104:107], v[140:143], v[164:167], v[104:107]
    s_waitcnt lgkmcnt(4)
    v_rcp_f32 v12, v12
    v_mfma_f32_16x16x32_bf16 v[108:111], v[144:147], v[160:163], v[108:111]
    ds_read_b128 v[140:143], v1 offset:18432
    v_mul_f32 v28, v28, v12
    v_mfma_f32_16x16x32_bf16 v[112:115], v[144:147], v[164:167], v[112:115]
    buffer_load_dwordx4 a[172:175], v1, s[4:7], s81 offen offset:3072 sc1
    v_mfma_f32_16x16x32_bf16 v[116:119], v[148:151], v[160:163], v[116:119]
    s_add_u32 s81, s81, 4096
    s_waitcnt vmcnt(11)
    ds_read_b128 v[144:147], v1 offset:19456
    v_mul_f32 v36, v20, v36
    v_mfma_f32_16x16x32_bf16 v[120:123], v[148:151], v[164:167], v[120:123]
    s_waitcnt lgkmcnt(5)
    v_rcp_f32 v13, v13
    v_mfma_f32_16x16x32_bf16 v[68:71], v[124:127], v[168:171], v[68:71]
    ds_read_b128 v[148:151], v1 offset:20480
    v_mul_f32 v29, v29, v13
    v_mfma_f32_16x16x32_bf16 v[72:75], v[124:127], v[172:175], v[72:75]
    s_waitcnt lgkmcnt(4)
    v_rcp_f32 v14, v14
    v_mfma_f32_16x16x32_bf16 v[76:79], v[128:131], v[168:171], v[76:79]
    ds_read_b128 v[124:127], v1 offset:21504
    v_mul_f32 v30, v30, v14
    v_mfma_f32_16x16x32_bf16 v[80:83], v[128:131], v[172:175], v[80:83]
    buffer_load_dwordx4 v[160:163], v1, s[4:7], s74 offen offset:2048 sc1
    v_mfma_f32_16x16x32_bf16 v[84:87], v[132:135], v[168:171], v[84:87]
    ds_read_b128 v[128:131], v1 offset:22528
    v_cvt_pk_bf16_f32 v12, v28, v29
    v_mfma_f32_16x16x32_bf16 v[88:91], v[132:135], v[172:175], v[88:91]
    s_waitcnt lgkmcnt(4)
    v_rcp_f32 v15, v15
    v_mfma_f32_16x16x32_bf16 v[92:95], v[136:139], v[168:171], v[92:95]
    ds_read_b128 v[132:135], v1 offset:23552
    v_mul_f32 v31, v31, v15
    v_mfma_f32_16x16x32_bf16 v[96:99], v[136:139], v[172:175], v[96:99]
    buffer_load_dwordx4 v[164:167], v1, s[4:7], s75 offen offset:2048 sc1
    v_mfma_f32_16x16x32_bf16 v[100:103], v[140:143], v[168:171], v[100:103]
    ds_read_b128 v[136:139], v1 offset:24576
    v_cvt_pk_bf16_f32 v13, v30, v31
    v_mfma_f32_16x16x32_bf16 v[104:107], v[140:143], v[172:175], v[104:107]
    s_waitcnt lgkmcnt(4)
    v_mul_f32 v37, v21, v37
    v_mul_f32 v38, v22, v38
    v_mfma_f32_16x16x32_bf16 v[108:111], v[144:147], v[168:171], v[108:111]
    ds_read_b128 v[140:143], v1 offset:25600
    v_mul_f32 v39, v23, v39
    v_mfma_f32_16x16x32_bf16 v[112:115], v[144:147], v[172:175], v[112:115]
    buffer_load_dwordx4 a[176:179], v1, s[4:7], s81 offen offset:0 sc1
    v_mfma_f32_16x16x32_bf16 v[116:119], v[148:151], v[168:171], v[116:119]
    s_waitcnt vmcnt(10)
    ds_read_b128 v[144:147], v1 offset:26624
    v_mul_f32 v20, v20, v192
    v_mfma_f32_16x16x32_bf16 v[120:123], v[148:151], v[172:175], v[120:123]
    s_waitcnt lgkmcnt(5)
    v_exp_f32 v20, v20
    v_mfma_f32_16x16x32_bf16 v[68:71], v[124:127], v[176:179], v[68:71]
    ds_read_b128 v[148:151], v1 offset:27648
    v_mul_f32 v21, v21, v192
    v_mfma_f32_16x16x32_bf16 v[72:75], v[124:127], v[180:183], v[72:75]
    s_waitcnt lgkmcnt(4)
    v_exp_f32 v21, v21
    v_mfma_f32_16x16x32_bf16 v[76:79], v[128:131], v[176:179], v[76:79]
    ds_read_b128 v[124:127], v1 offset:28672
    v_mul_f32 v22, v22, v192
    v_mfma_f32_16x16x32_bf16 v[80:83], v[128:131], v[180:183], v[80:83]
    buffer_load_dwordx4 v[168:171], v1, s[4:7], s74 offen offset:3072 sc1
    v_mfma_f32_16x16x32_bf16 v[84:87], v[132:135], v[176:179], v[84:87]
    ds_read_b128 v[128:131], v1 offset:29696
    v_mul_f32 v23, v23, v192
    v_mfma_f32_16x16x32_bf16 v[88:91], v[132:135], v[180:183], v[88:91]
    s_waitcnt lgkmcnt(4)
    v_exp_f32 v22, v22
    v_mfma_f32_16x16x32_bf16 v[92:95], v[136:139], v[176:179], v[92:95]
    ds_read_b128 v[132:135], v1 offset:30720
    v_fma_f32 v20, v20, v196, v196
    v_mfma_f32_16x16x32_bf16 v[96:99], v[136:139], v[180:183], v[96:99]
    buffer_load_dwordx4 v[172:175], v1, s[4:7], s75 offen offset:3072 sc1
    v_mfma_f32_16x16x32_bf16 v[100:103], v[140:143], v[176:179], v[100:103]
    s_add_u32 s74, s74, 4096
    ds_read_b128 v[136:139], v1 offset:31744
    v_fma_f32 v21, v21, v196, v196
    v_mfma_f32_16x16x32_bf16 v[104:107], v[140:143], v[180:183], v[104:107]
    s_waitcnt lgkmcnt(4)
    v_exp_f32 v23, v23
    v_mfma_f32_16x16x32_bf16 v[108:111], v[144:147], v[176:179], v[108:111]
    s_add_u32 s75, s75, 4096
    ds_read_b128 v[140:143], v1 offset:32768
    v_fma_f32 v22, v22, v196, v196
    v_mfma_f32_16x16x32_bf16 v[112:115], v[144:147], v[180:183], v[112:115]
    buffer_load_dwordx4 a[180:183], v1, s[4:7], s81 offen offset:1024 sc1
    v_mfma_f32_16x16x32_bf16 v[116:119], v[148:151], v[176:179], v[116:119]
    s_waitcnt vmcnt(10)
    ds_read_b128 v[144:147], v1 offset:33792
    v_fma_f32 v23, v23, v196, v196
    v_mfma_f32_16x16x32_bf16 v[120:123], v[148:151], v[180:183], v[120:123]
    s_waitcnt lgkmcnt(5)
    v_rcp_f32 v20, v20
    v_mfma_f32_16x16x32_bf16 v[68:71], v[124:127], v[184:187], v[68:71]
    ds_read_b128 v[148:151], v1 offset:34816
    v_mul_f32 v36, v36, v20
    v_mfma_f32_16x16x32_bf16 v[72:75], v[124:127], v[188:191], v[72:75]
    s_waitcnt lgkmcnt(4)
    v_rcp_f32 v21, v21
    v_mfma_f32_16x16x32_bf16 v[76:79], v[128:131], v[184:187], v[76:79]
    ds_read_b128 v[124:127], v1 offset:35840
    v_mul_f32 v37, v37, v21
    v_mfma_f32_16x16x32_bf16 v[80:83], v[128:131], v[188:191], v[80:83]
    buffer_load_dwordx4 v[176:179], v1, s[4:7], s74 offen offset:0 sc1
    v_mfma_f32_16x16x32_bf16 v[84:87], v[132:135], v[184:187], v[84:87]
    ds_read_b128 v[128:131], v1 offset:36864
    v_cvt_pk_bf16_f32 v14, v36, v37
    v_mfma_f32_16x16x32_bf16 v[88:91], v[132:135], v[188:191], v[88:91]
    s_waitcnt lgkmcnt(4)
    v_rcp_f32 v22, v22
    v_mfma_f32_16x16x32_bf16 v[92:95], v[136:139], v[184:187], v[92:95]
    ds_read_b128 v[132:135], v1 offset:37888
    v_mul_f32 v38, v38, v22
    v_mfma_f32_16x16x32_bf16 v[96:99], v[136:139], v[188:191], v[96:99]
    buffer_load_dwordx4 v[180:183], v1, s[4:7], s75 offen offset:0 sc1
    v_mfma_f32_16x16x32_bf16 v[100:103], v[140:143], v[184:187], v[100:103]
    ds_read_b128 v[136:139], v1 offset:38912
    v_mul_f32 v32, v16, v32
    v_mfma_f32_16x16x32_bf16 v[104:107], v[140:143], v[188:191], v[104:107]
    s_waitcnt lgkmcnt(4)
    v_rcp_f32 v23, v23
    v_mfma_f32_16x16x32_bf16 v[108:111], v[144:147], v[184:187], v[108:111]
    ds_read_b128 v[140:143], v1 offset:39936
    v_mul_f32 v39, v39, v23
    v_mfma_f32_16x16x32_bf16 v[112:115], v[144:147], v[188:191], v[112:115]
    buffer_load_dwordx4 a[184:187], v1, s[4:7], s81 offen offset:2048 sc1
    v_mfma_f32_16x16x32_bf16 v[116:119], v[148:151], v[184:187], v[116:119]
    s_waitcnt vmcnt(10)
    ds_read_b128 v[144:147], v1 offset:40960
    v_cvt_pk_bf16_f32 v15, v38, v39
    v_mfma_f32_16x16x32_bf16 v[120:123], v[148:151], v[188:191], v[120:123]
    s_waitcnt lgkmcnt(5)
    buffer_store_dwordx4 v[12:15], v1, s[4:7], s76 offen sc1
    v_mfma_f32_16x16x32_bf16 v[68:71], v[124:127], v[152:155], v[68:71]
    ds_read_b128 v[148:151], v1 offset:41984
    v_mul_f32 v33, v17, v33
    v_mfma_f32_16x16x32_bf16 v[72:75], v[124:127], v[156:159], v[72:75]
    s_waitcnt lgkmcnt(4)
    v_mul_f32 v34, v18, v34
    v_mul_f32 v35, v19, v35
    v_mfma_f32_16x16x32_bf16 v[76:79], v[128:131], v[152:155], v[76:79]
    ds_read_b128 v[124:127], v1 offset:43008
    v_mul_f32 v16, v16, v193
    v_mfma_f32_16x16x32_bf16 v[80:83], v[128:131], v[156:159], v[80:83]
    buffer_load_dwordx4 v[184:187], v1, s[4:7], s74 offen offset:1024 sc1
    v_mfma_f32_16x16x32_bf16 v[84:87], v[132:135], v[152:155], v[84:87]
    ds_read_b128 v[128:131], v1 offset:44032
    v_mul_f32 v17, v17, v193
    v_mfma_f32_16x16x32_bf16 v[88:91], v[132:135], v[156:159], v[88:91]
    s_waitcnt lgkmcnt(4)
    v_exp_f32 v16, v16
    v_mfma_f32_16x16x32_bf16 v[92:95], v[136:139], v[152:155], v[92:95]
    ds_read_b128 v[132:135], v1 offset:45056
    v_mul_f32 v18, v18, v193
    v_mfma_f32_16x16x32_bf16 v[96:99], v[136:139], v[156:159], v[96:99]
    buffer_load_dwordx4 v[188:191], v1, s[4:7], s75 offen offset:1024 sc1
    v_mfma_f32_16x16x32_bf16 v[100:103], v[140:143], v[152:155], v[100:103]
    ds_read_b128 v[136:139], v1 offset:46080
    v_mul_f32 v19, v19, v193
    v_mfma_f32_16x16x32_bf16 v[104:107], v[140:143], v[156:159], v[104:107]
    s_waitcnt lgkmcnt(4)
    v_exp_f32 v17, v17
    v_mfma_f32_16x16x32_bf16 v[108:111], v[144:147], v[152:155], v[108:111]
    ds_read_b128 v[140:143], v1 offset:47104
    v_fma_f32 v16, v16, v197, v197
    v_mfma_f32_16x16x32_bf16 v[112:115], v[144:147], v[156:159], v[112:115]
    buffer_load_dwordx4 a[188:191], v1, s[4:7], s81 offen offset:3072 sc1
    v_mfma_f32_16x16x32_bf16 v[116:119], v[148:151], v[152:155], v[116:119]
    s_add_u32 s81, s81, 4096
    s_waitcnt vmcnt(11)
    ds_read_b128 v[144:147], v1 offset:48128
    v_fma_f32 v17, v17, v197, v197
    v_mfma_f32_16x16x32_bf16 v[120:123], v[148:151], v[156:159], v[120:123]
    s_waitcnt lgkmcnt(5)
    v_exp_f32 v18, v18
    v_mfma_f32_16x16x32_bf16 v[68:71], v[124:127], v[160:163], v[68:71]
    ds_read_b128 v[148:151], v1 offset:49152
    v_fma_f32 v18, v18, v197, v197
    v_mfma_f32_16x16x32_bf16 v[72:75], v[124:127], v[164:167], v[72:75]
    s_waitcnt lgkmcnt(4)
    v_exp_f32 v19, v19
    v_mfma_f32_16x16x32_bf16 v[76:79], v[128:131], v[160:163], v[76:79]
    ds_read_b128 v[124:127], v1 offset:50176
    v_fma_f32 v19, v19, v197, v197
    v_mfma_f32_16x16x32_bf16 v[80:83], v[128:131], v[164:167], v[80:83]
    buffer_load_dwordx4 v[152:155], v1, s[4:7], s74 offen offset:2048 sc1
    v_mfma_f32_16x16x32_bf16 v[84:87], v[132:135], v[160:163], v[84:87]
    ds_read_b128 v[128:131], v1 offset:51200
    v_mul_f32 v40, v24, v40
    v_mfma_f32_16x16x32_bf16 v[88:91], v[132:135], v[164:167], v[88:91]
    s_waitcnt lgkmcnt(4)
    v_rcp_f32 v16, v16
    v_mfma_f32_16x16x32_bf16 v[92:95], v[136:139], v[160:163], v[92:95]
    ds_read_b128 v[132:135], v1 offset:52224
    v_mul_f32 v32, v32, v16
    v_mfma_f32_16x16x32_bf16 v[96:99], v[136:139], v[164:167], v[96:99]
    buffer_load_dwordx4 v[156:159], v1, s[4:7], s75 offen offset:2048 sc1
    v_mfma_f32_16x16x32_bf16 v[100:103], v[140:143], v[160:163], v[100:103]
    ds_read_b128 v[136:139], v1 offset:53248
    v_mul_f32 v41, v25, v41
    v_mfma_f32_16x16x32_bf16 v[104:107], v[140:143], v[164:167], v[104:107]
    s_waitcnt lgkmcnt(4)
    v_rcp_f32 v17, v17
    v_mfma_f32_16x16x32_bf16 v[108:111], v[144:147], v[160:163], v[108:111]
    ds_read_b128 v[140:143], v1 offset:54272
    v_mul_f32 v33, v33, v17
    v_mfma_f32_16x16x32_bf16 v[112:115], v[144:147], v[164:167], v[112:115]
    buffer_load_dwordx4 a[192:195], v1, s[4:7], s81 offen offset:0 sc1
    v_mfma_f32_16x16x32_bf16 v[116:119], v[148:151], v[160:163], v[116:119]
    s_waitcnt vmcnt(11)
    ds_read_b128 v[144:147], v1 offset:55296
    v_cvt_pk_bf16_f32 v16, v32, v33
    v_mfma_f32_16x16x32_bf16 v[120:123], v[148:151], v[164:167], v[120:123]
    s_waitcnt lgkmcnt(5)
    v_rcp_f32 v18, v18
    v_mfma_f32_16x16x32_bf16 v[68:71], v[124:127], v[168:171], v[68:71]
    ds_read_b128 v[148:151], v1 offset:56320
    v_mul_f32 v34, v34, v18
    v_mfma_f32_16x16x32_bf16 v[72:75], v[124:127], v[172:175], v[72:75]
    s_waitcnt lgkmcnt(4)
    v_rcp_f32 v19, v19
    v_mfma_f32_16x16x32_bf16 v[76:79], v[128:131], v[168:171], v[76:79]
    ds_read_b128 v[124:127], v1 offset:57344
    v_mul_f32 v35, v35, v19
    v_mfma_f32_16x16x32_bf16 v[80:83], v[128:131], v[172:175], v[80:83]
    buffer_load_dwordx4 v[160:163], v1, s[4:7], s74 offen offset:3072 sc1
    v_mfma_f32_16x16x32_bf16 v[84:87], v[132:135], v[168:171], v[84:87]
    ds_read_b128 v[128:131], v1 offset:58368
    v_cvt_pk_bf16_f32 v17, v34, v35
    v_mfma_f32_16x16x32_bf16 v[88:91], v[132:135], v[172:175], v[88:91]
    s_waitcnt lgkmcnt(4)
    v_mul_f32 v42, v26, v42
    v_mul_f32 v43, v27, v43
    v_mfma_f32_16x16x32_bf16 v[92:95], v[136:139], v[168:171], v[92:95]
    ds_read_b128 v[132:135], v1 offset:59392
    v_mul_f32 v24, v24, v193
    v_mfma_f32_16x16x32_bf16 v[96:99], v[136:139], v[172:175], v[96:99]
    buffer_load_dwordx4 v[164:167], v1, s[4:7], s75 offen offset:3072 sc1
    v_mfma_f32_16x16x32_bf16 v[100:103], v[140:143], v[168:171], v[100:103]
    s_add_u32 s74, s74, 4096
    ds_read_b128 v[136:139], v1 offset:60416
    v_mul_f32 v25, v25, v193
    v_mfma_f32_16x16x32_bf16 v[104:107], v[140:143], v[172:175], v[104:107]
    s_waitcnt lgkmcnt(4)
    v_exp_f32 v24, v24
    v_mfma_f32_16x16x32_bf16 v[108:111], v[144:147], v[168:171], v[108:111]
    s_add_u32 s75, s75, 4096
    ds_read_b128 v[140:143], v1 offset:61440
    v_mul_f32 v26, v26, v193
    v_mfma_f32_16x16x32_bf16 v[112:115], v[144:147], v[172:175], v[112:115]
    buffer_load_dwordx4 a[196:199], v1, s[4:7], s81 offen offset:1024 sc1
    v_mfma_f32_16x16x32_bf16 v[116:119], v[148:151], v[168:171], v[116:119]
    s_waitcnt vmcnt(11)
    ds_read_b128 v[144:147], v1 offset:62464
    v_mul_f32 v27, v27, v193
    v_mfma_f32_16x16x32_bf16 v[120:123], v[148:151], v[172:175], v[120:123]
    s_waitcnt lgkmcnt(5)
    v_exp_f32 v25, v25
    v_mfma_f32_16x16x32_bf16 v[68:71], v[124:127], v[176:179], v[68:71]
    ds_read_b128 v[148:151], v1 offset:63488
    v_fma_f32 v24, v24, v197, v197
    v_mfma_f32_16x16x32_bf16 v[72:75], v[124:127], v[180:183], v[72:75]
    s_waitcnt lgkmcnt(4)
    v_exp_f32 v26, v26
    v_mfma_f32_16x16x32_bf16 v[76:79], v[128:131], v[176:179], v[76:79]
    ds_read_b128 v[124:127], v9 offset:0
    v_fma_f32 v25, v25, v197, v197
    v_mfma_f32_16x16x32_bf16 v[80:83], v[128:131], v[180:183], v[80:83]
    buffer_load_dwordx4 v[168:171], v1, s[4:7], s74 offen offset:0 sc1
    v_mfma_f32_16x16x32_bf16 v[84:87], v[132:135], v[176:179], v[84:87]
    ds_read_b128 v[128:131], v9 offset:1024
    v_fma_f32 v26, v26, v197, v197
    v_mfma_f32_16x16x32_bf16 v[88:91], v[132:135], v[180:183], v[88:91]
    s_waitcnt lgkmcnt(4)
    v_exp_f32 v27, v27
    v_mfma_f32_16x16x32_bf16 v[92:95], v[136:139], v[176:179], v[92:95]
    ds_read_b128 v[132:135], v9 offset:2048
    v_fma_f32 v27, v27, v197, v197
    v_mfma_f32_16x16x32_bf16 v[96:99], v[136:139], v[180:183], v[96:99]
    buffer_load_dwordx4 v[172:175], v1, s[4:7], s75 offen offset:0 sc1
    v_mfma_f32_16x16x32_bf16 v[100:103], v[140:143], v[176:179], v[100:103]
    ds_read_b128 v[136:139], v9 offset:3072
    v_mul_f32 v52, v44, v52
    v_mfma_f32_16x16x32_bf16 v[104:107], v[140:143], v[180:183], v[104:107]
    s_waitcnt lgkmcnt(4)
    v_rcp_f32 v24, v24
    v_mfma_f32_16x16x32_bf16 v[108:111], v[144:147], v[176:179], v[108:111]
    ds_read_b128 v[140:143], v9 offset:4096
    v_mul_f32 v40, v40, v24
    v_mfma_f32_16x16x32_bf16 v[112:115], v[144:147], v[180:183], v[112:115]
    buffer_load_dwordx4 a[200:203], v1, s[4:7], s81 offen offset:2048 sc1
    v_mfma_f32_16x16x32_bf16 v[116:119], v[148:151], v[176:179], v[116:119]
    s_waitcnt vmcnt(10)
    ds_read_b128 v[144:147], v9 offset:5120
    v_mul_f32 v53, v45, v53
    v_mfma_f32_16x16x32_bf16 v[120:123], v[148:151], v[180:183], v[120:123]
    s_waitcnt lgkmcnt(5)
    v_rcp_f32 v25, v25
    v_mfma_f32_16x16x32_bf16 v[68:71], v[124:127], v[184:187], v[68:71]
    ds_read_b128 v[148:151], v9 offset:6144
    v_mul_f32 v41, v41, v25
    v_mfma_f32_16x16x32_bf16 v[72:75], v[124:127], v[188:191], v[72:75]
    s_waitcnt lgkmcnt(4)
    v_rcp_f32 v26, v26
    v_mfma_f32_16x16x32_bf16 v[76:79], v[128:131], v[184:187], v[76:79]
    ds_read_b128 v[124:127], v9 offset:7168
    v_mul_f32 v42, v42, v26
    v_mfma_f32_16x16x32_bf16 v[80:83], v[128:131], v[188:191], v[80:83]
    buffer_load_dwordx4 v[176:179], v1, s[4:7], s74 offen offset:1024 sc1
    v_mfma_f32_16x16x32_bf16 v[84:87], v[132:135], v[184:187], v[84:87]
    ds_read_b128 v[128:131], v9 offset:8192
    v_cvt_pk_bf16_f32 v18, v40, v41
    v_mfma_f32_16x16x32_bf16 v[88:91], v[132:135], v[188:191], v[88:91]
    s_waitcnt lgkmcnt(4)
    buffer_load_dwordx4 a[204:207], v1, s[4:7], s81 offen offset:3072 sc1
    v_mfma_f32_16x16x32_bf16 v[92:95], v[136:139], v[184:187], v[92:95]
    s_add_u32 s81, s81, 4096
    ds_read_b128 v[132:135], v9 offset:9216
    v_mul_f32 v54, v46, v54
    v_mfma_f32_16x16x32_bf16 v[96:99], v[136:139], v[188:191], v[96:99]
    buffer_load_dwordx4 v[180:183], v1, s[4:7], s75 offen offset:1024 sc1
    v_mfma_f32_16x16x32_bf16 v[100:103], v[140:143], v[184:187], v[100:103]
    ds_read_b128 v[136:139], v9 offset:10240
    v_mul_f32 v55, v47, v55
    v_mfma_f32_16x16x32_bf16 v[104:107], v[140:143], v[188:191], v[104:107]
    s_waitcnt lgkmcnt(4)
    v_rcp_f32 v27, v27
    v_mfma_f32_16x16x32_bf16 v[108:111], v[144:147], v[184:187], v[108:111]
    ds_read_b128 v[140:143], v9 offset:11264
    v_mul_f32 v43, v43, v27
    v_mfma_f32_16x16x32_bf16 v[112:115], v[144:147], v[188:191], v[112:115]
    buffer_load_dwordx4 a[208:211], v1, s[4:7], s81 offen offset:0 sc1
    v_mfma_f32_16x16x32_bf16 v[116:119], v[148:151], v[184:187], v[116:119]
    s_waitcnt vmcnt(11)
    ds_read_b128 v[144:147], v9 offset:12288
    v_cvt_pk_bf16_f32 v19, v42, v43
    v_mfma_f32_16x16x32_bf16 v[120:123], v[148:151], v[188:191], v[120:123]
    s_waitcnt lgkmcnt(5)
    buffer_store_dwordx4 v[16:19], v1, s[4:7], s77 offen sc1
    v_mfma_f32_16x16x32_bf16 v[68:71], v[124:127], v[152:155], v[68:71]
    ds_read_b128 v[148:151], v9 offset:13312
    v_mul_f32 v44, v44, v192
    v_mfma_f32_16x16x32_bf16 v[72:75], v[124:127], v[156:159], v[72:75]
    s_waitcnt lgkmcnt(4)
    v_exp_f32 v44, v44
    v_mfma_f32_16x16x32_bf16 v[76:79], v[128:131], v[152:155], v[76:79]
    ds_read_b128 v[124:127], v9 offset:14336
    v_mul_f32 v45, v45, v192
    v_mfma_f32_16x16x32_bf16 v[80:83], v[128:131], v[156:159], v[80:83]
    buffer_load_dwordx4 v[184:187], v1, s[4:7], s74 offen offset:2048 sc1
    v_mfma_f32_16x16x32_bf16 v[84:87], v[132:135], v[152:155], v[84:87]
    ds_read_b128 v[128:131], v9 offset:15360
    v_mul_f32 v46, v46, v192
    v_mfma_f32_16x16x32_bf16 v[88:91], v[132:135], v[156:159], v[88:91]
    s_waitcnt lgkmcnt(4)
    v_exp_f32 v45, v45
    v_mfma_f32_16x16x32_bf16 v[92:95], v[136:139], v[152:155], v[92:95]
    ds_read_b128 v[132:135], v9 offset:16384
    v_mul_f32 v47, v47, v192
    v_mfma_f32_16x16x32_bf16 v[96:99], v[136:139], v[156:159], v[96:99]
    buffer_load_dwordx4 v[188:191], v1, s[4:7], s75 offen offset:2048 sc1
    v_mfma_f32_16x16x32_bf16 v[100:103], v[140:143], v[152:155], v[100:103]
    ds_read_b128 v[136:139], v9 offset:17408
    v_fma_f32 v44, v44, v196, v196
    v_mfma_f32_16x16x32_bf16 v[104:107], v[140:143], v[156:159], v[104:107]
    s_waitcnt lgkmcnt(4)
    v_exp_f32 v46, v46
    v_mfma_f32_16x16x32_bf16 v[108:111], v[144:147], v[152:155], v[108:111]
    ds_read_b128 v[140:143], v9 offset:18432
    v_fma_f32 v45, v45, v196, v196
    v_mfma_f32_16x16x32_bf16 v[112:115], v[144:147], v[156:159], v[112:115]
    buffer_load_dwordx4 a[212:215], v1, s[4:7], s81 offen offset:1024 sc1
    v_mfma_f32_16x16x32_bf16 v[116:119], v[148:151], v[152:155], v[116:119]
    s_waitcnt vmcnt(12)
    ds_read_b128 v[144:147], v9 offset:19456
    v_fma_f32 v46, v46, v196, v196
    v_mfma_f32_16x16x32_bf16 v[120:123], v[148:151], v[156:159], v[120:123]
    s_waitcnt lgkmcnt(5)
    v_exp_f32 v47, v47
    v_mfma_f32_16x16x32_bf16 v[68:71], v[124:127], v[160:163], v[68:71]
    ds_read_b128 v[148:151], v9 offset:20480
    v_fma_f32 v47, v47, v196, v196
    v_mfma_f32_16x16x32_bf16 v[72:75], v[124:127], v[164:167], v[72:75]
    s_waitcnt lgkmcnt(4)
    v_rcp_f32 v44, v44
    v_mfma_f32_16x16x32_bf16 v[76:79], v[128:131], v[160:163], v[76:79]
    ds_read_b128 v[124:127], v9 offset:21504
    v_mul_f32 v52, v52, v44
    v_mfma_f32_16x16x32_bf16 v[80:83], v[128:131], v[164:167], v[80:83]
    buffer_load_dwordx4 v[152:155], v1, s[4:7], s74 offen offset:3072 sc1
    v_mfma_f32_16x16x32_bf16 v[84:87], v[132:135], v[160:163], v[84:87]
    ds_read_b128 v[128:131], v9 offset:22528
    v_mul_f32 v56, v48, v56
    v_mfma_f32_16x16x32_bf16 v[88:91], v[132:135], v[164:167], v[88:91]
    s_waitcnt lgkmcnt(4)
    v_rcp_f32 v45, v45
    v_mfma_f32_16x16x32_bf16 v[92:95], v[136:139], v[160:163], v[92:95]
    ds_read_b128 v[132:135], v9 offset:23552
    v_mul_f32 v53, v53, v45
    v_mfma_f32_16x16x32_bf16 v[96:99], v[136:139], v[164:167], v[96:99]
    buffer_load_dwordx4 v[156:159], v1, s[4:7], s75 offen offset:3072 sc1
    v_mfma_f32_16x16x32_bf16 v[100:103], v[140:143], v[160:163], v[100:103]
    s_add_u32 s74, s74, 4096
    ds_read_b128 v[136:139], v9 offset:24576
    v_cvt_pk_bf16_f32 v44, v52, v53
    v_mfma_f32_16x16x32_bf16 v[104:107], v[140:143], v[164:167], v[104:107]
    s_waitcnt lgkmcnt(4)
    v_rcp_f32 v46, v46
    v_mfma_f32_16x16x32_bf16 v[108:111], v[144:147], v[160:163], v[108:111]
    s_add_u32 s75, s75, 4096
    ds_read_b128 v[140:143], v9 offset:25600
    v_mul_f32 v54, v54, v46
    v_mfma_f32_16x16x32_bf16 v[112:115], v[144:147], v[164:167], v[112:115]
    buffer_load_dwordx4 a[216:219], v1, s[4:7], s81 offen offset:2048 sc1
    v_mfma_f32_16x16x32_bf16 v[116:119], v[148:151], v[160:163], v[116:119]
    s_waitcnt vmcnt(12)
    ds_read_b128 v[144:147], v9 offset:26624
    v_mul_f32 v57, v49, v57
    v_mfma_f32_16x16x32_bf16 v[120:123], v[148:151], v[164:167], v[120:123]
    s_waitcnt lgkmcnt(5)
    v_rcp_f32 v47, v47
    v_mfma_f32_16x16x32_bf16 v[68:71], v[124:127], v[168:171], v[68:71]
    ds_read_b128 v[148:151], v9 offset:27648
    v_mul_f32 v55, v55, v47
    v_mfma_f32_16x16x32_bf16 v[72:75], v[124:127], v[172:175], v[72:75]
    s_waitcnt lgkmcnt(4)
    v_cvt_pk_bf16_f32 v45, v54, v55
    v_mul_f32 v58, v50, v58
    v_mfma_f32_16x16x32_bf16 v[76:79], v[128:131], v[168:171], v[76:79]
    ds_read_b128 v[124:127], v9 offset:28672
    v_mul_f32 v59, v51, v59
    v_mfma_f32_16x16x32_bf16 v[80:83], v[128:131], v[172:175], v[80:83]
    buffer_load_dwordx4 v[160:163], v1, s[4:7], s74 offen offset:0 sc1
    v_mfma_f32_16x16x32_bf16 v[84:87], v[132:135], v[168:171], v[84:87]
    ds_read_b128 v[128:131], v9 offset:29696
    v_mul_f32 v48, v48, v193
    v_mfma_f32_16x16x32_bf16 v[88:91], v[132:135], v[172:175], v[88:91]
    s_waitcnt lgkmcnt(4)
    v_exp_f32 v48, v48
    v_mfma_f32_16x16x32_bf16 v[92:95], v[136:139], v[168:171], v[92:95]
    ds_read_b128 v[132:135], v9 offset:30720
    v_mul_f32 v49, v49, v193
    v_mfma_f32_16x16x32_bf16 v[96:99], v[136:139], v[172:175], v[96:99]
    buffer_load_dwordx4 v[164:167], v1, s[4:7], s75 offen offset:0 sc1
    v_mfma_f32_16x16x32_bf16 v[100:103], v[140:143], v[168:171], v[100:103]
    ds_read_b128 v[136:139], v9 offset:31744
    v_mul_f32 v50, v50, v193
    v_mfma_f32_16x16x32_bf16 v[104:107], v[140:143], v[172:175], v[104:107]
    s_waitcnt lgkmcnt(4)
    v_exp_f32 v49, v49
    v_mfma_f32_16x16x32_bf16 v[108:111], v[144:147], v[168:171], v[108:111]
    ds_read_b128 v[140:143], v9 offset:32768
    v_mul_f32 v51, v51, v193
    v_mfma_f32_16x16x32_bf16 v[112:115], v[144:147], v[172:175], v[112:115]
    buffer_load_dwordx4 a[220:223], v1, s[4:7], s81 offen offset:3072 sc1
    v_mfma_f32_16x16x32_bf16 v[116:119], v[148:151], v[168:171], v[116:119]
    s_add_u32 s81, s81, 4096
    s_waitcnt vmcnt(11)
    ds_read_b128 v[144:147], v9 offset:33792
    v_fma_f32 v48, v48, v197, v197
    v_mfma_f32_16x16x32_bf16 v[120:123], v[148:151], v[172:175], v[120:123]
    s_waitcnt lgkmcnt(5)
    v_exp_f32 v50, v50
    v_mfma_f32_16x16x32_bf16 v[68:71], v[124:127], v[176:179], v[68:71]
    ds_read_b128 v[148:151], v9 offset:34816
    v_fma_f32 v49, v49, v197, v197
    v_mfma_f32_16x16x32_bf16 v[72:75], v[124:127], v[180:183], v[72:75]
    s_waitcnt lgkmcnt(4)
    v_exp_f32 v51, v51
    v_mfma_f32_16x16x32_bf16 v[76:79], v[128:131], v[176:179], v[76:79]
    ds_read_b128 v[124:127], v9 offset:35840
    v_fma_f32 v50, v50, v197, v197
    v_mfma_f32_16x16x32_bf16 v[80:83], v[128:131], v[180:183], v[80:83]
    buffer_load_dwordx4 v[168:171], v1, s[4:7], s74 offen offset:1024 sc1
    v_mfma_f32_16x16x32_bf16 v[84:87], v[132:135], v[176:179], v[84:87]
    ds_read_b128 v[128:131], v9 offset:36864
    v_fma_f32 v51, v51, v197, v197
    v_mfma_f32_16x16x32_bf16 v[88:91], v[132:135], v[180:183], v[88:91]
    s_waitcnt lgkmcnt(4)
    v_rcp_f32 v48, v48
    v_mfma_f32_16x16x32_bf16 v[92:95], v[136:139], v[176:179], v[92:95]
    ds_read_b128 v[132:135], v9 offset:37888
    v_mul_f32 v56, v56, v48
    v_mfma_f32_16x16x32_bf16 v[96:99], v[136:139], v[180:183], v[96:99]
    buffer_load_dwordx4 v[172:175], v1, s[4:7], s75 offen offset:1024 sc1
    v_mfma_f32_16x16x32_bf16 v[100:103], v[140:143], v[176:179], v[100:103]
    ds_read_b128 v[136:139], v9 offset:38912
    v_cndmask_b32 v206, v193, v192, s[66:67]
    v_mfma_f32_16x16x32_bf16 v[104:107], v[140:143], v[180:183], v[104:107]
    s_waitcnt lgkmcnt(4)
    v_rcp_f32 v49, v49
    v_mfma_f32_16x16x32_bf16 v[108:111], v[144:147], v[176:179], v[108:111]
    ds_read_b128 v[140:143], v9 offset:39936
    v_mul_f32 v57, v57, v49
    v_mfma_f32_16x16x32_bf16 v[112:115], v[144:147], v[180:183], v[112:115]
    buffer_load_dwordx4 a[224:227], v1, s[4:7], s81 offen offset:0 sc1
    v_mfma_f32_16x16x32_bf16 v[116:119], v[148:151], v[176:179], v[116:119]
    s_waitcnt vmcnt(10)
    ds_read_b128 v[144:147], v9 offset:40960
    v_cvt_pk_bf16_f32 v46, v56, v57
    v_mfma_f32_16x16x32_bf16 v[120:123], v[148:151], v[180:183], v[120:123]
    s_waitcnt lgkmcnt(5)
    v_rcp_f32 v50, v50
    v_mfma_f32_16x16x32_bf16 v[68:71], v[124:127], v[184:187], v[68:71]
    ds_read_b128 v[148:151], v9 offset:41984
    v_mul_f32 v58, v58, v50
    v_mfma_f32_16x16x32_bf16 v[72:75], v[124:127], v[188:191], v[72:75]
    s_waitcnt lgkmcnt(4)
    v_rcp_f32 v51, v51
    v_mfma_f32_16x16x32_bf16 v[76:79], v[128:131], v[184:187], v[76:79]
    ds_read_b128 v[124:127], v9 offset:43008
    v_mul_f32 v59, v59, v51
    v_mfma_f32_16x16x32_bf16 v[80:83], v[128:131], v[188:191], v[80:83]
    buffer_load_dwordx4 v[176:179], v1, s[4:7], s74 offen offset:2048 sc1
    v_mfma_f32_16x16x32_bf16 v[84:87], v[132:135], v[184:187], v[84:87]
    ds_read_b128 v[128:131], v9 offset:44032
    v_cvt_pk_bf16_f32 v47, v58, v59
    v_mfma_f32_16x16x32_bf16 v[88:91], v[132:135], v[188:191], v[88:91]
    s_waitcnt lgkmcnt(4)
    v_permlane32_swap_b32 v60, v64
    v_mfma_f32_16x16x32_bf16 v[92:95], v[136:139], v[184:187], v[92:95]
    ds_read_b128 v[132:135], v9 offset:45056
    v_cndmask_b32 v207, v197, v196, s[66:67]
    v_mfma_f32_16x16x32_bf16 v[96:99], v[136:139], v[188:191], v[96:99]
    buffer_load_dwordx4 v[180:183], v1, s[4:7], s75 offen offset:2048 sc1
    v_mfma_f32_16x16x32_bf16 v[100:103], v[140:143], v[184:187], v[100:103]
    ds_read_b128 v[136:139], v9 offset:46080
    v_mul_f32 v64, v60, v64
    v_mfma_f32_16x16x32_bf16 v[104:107], v[140:143], v[188:191], v[104:107]
    s_waitcnt lgkmcnt(4)
    v_permlane32_swap_b32 v61, v65
    v_mfma_f32_16x16x32_bf16 v[108:111], v[144:147], v[184:187], v[108:111]
    ds_read_b128 v[140:143], v9 offset:47104
    v_mul_f32 v65, v61, v65
    v_mfma_f32_16x16x32_bf16 v[112:115], v[144:147], v[188:191], v[112:115]
    buffer_load_dwordx4 a[228:231], v1, s[4:7], s81 offen offset:1024 sc1
    v_mfma_f32_16x16x32_bf16 v[116:119], v[148:151], v[184:187], v[116:119]
    s_waitcnt vmcnt(10)
    ds_read_b128 v[144:147], v9 offset:48128
    v_mul_f32 v60, v60, v206
    v_mfma_f32_16x16x32_bf16 v[120:123], v[148:151], v[188:191], v[120:123]
    s_waitcnt lgkmcnt(5)
    v_permlane32_swap_b32 v62, v66
    v_mfma_f32_16x16x32_bf16 v[68:71], v[124:127], v[152:155], v[68:71]
    ds_read_b128 v[148:151], v9 offset:49152
    v_mul_f32 v66, v62, v66
    v_mfma_f32_16x16x32_bf16 v[72:75], v[124:127], v[156:159], v[72:75]
    s_waitcnt lgkmcnt(4)
    v_permlane32_swap_b32 v63, v67
    v_mfma_f32_16x16x32_bf16 v[76:79], v[128:131], v[152:155], v[76:79]
    ds_read_b128 v[124:127], v9 offset:50176
    v_mul_f32 v67, v63, v67
    v_mfma_f32_16x16x32_bf16 v[80:83], v[128:131], v[156:159], v[80:83]
    buffer_load_dwordx4 v[184:187], v1, s[4:7], s74 offen offset:3072 sc1
    v_mfma_f32_16x16x32_bf16 v[84:87], v[132:135], v[152:155], v[84:87]
    ds_read_b128 v[128:131], v9 offset:51200
    v_mul_f32 v61, v61, v206
    v_mfma_f32_16x16x32_bf16 v[88:91], v[132:135], v[156:159], v[88:91]
    s_waitcnt lgkmcnt(4)
    v_permlane32_swap_b32 v44, v46
    v_mfma_f32_16x16x32_bf16 v[92:95], v[136:139], v[152:155], v[92:95]
    ds_read_b128 v[132:135], v9 offset:52224
    v_mul_f32 v62, v62, v206
    v_mfma_f32_16x16x32_bf16 v[96:99], v[136:139], v[156:159], v[96:99]
    buffer_load_dwordx4 v[188:191], v1, s[4:7], s75 offen offset:3072 sc1
    v_mfma_f32_16x16x32_bf16 v[100:103], v[140:143], v[152:155], v[100:103]
    s_add_u32 s74, s74, 4096
    ds_read_b128 v[136:139], v9 offset:53248
    v_mul_f32 v63, v63, v206
    v_mfma_f32_16x16x32_bf16 v[104:107], v[140:143], v[156:159], v[104:107]
    s_waitcnt lgkmcnt(4)
    v_permlane32_swap_b32 v45, v47
    v_mfma_f32_16x16x32_bf16 v[108:111], v[144:147], v[152:155], v[108:111]
    s_add_u32 s75, s75, 4096
    ds_read_b128 v[140:143], v9 offset:54272
    v_and_b32 v200, 7, v0
    v_mfma_f32_16x16x32_bf16 v[112:115], v[144:147], v[156:159], v[112:115]
    buffer_load_dwordx4 a[232:235], v1, s[4:7], s81 offen offset:2048 sc1
    v_mfma_f32_16x16x32_bf16 v[116:119], v[148:151], v[152:155], v[116:119]
    s_waitcnt vmcnt(10)
    ds_read_b128 v[144:147], v9 offset:55296
    v_lshlrev_b32 v200, 12, v200
    v_mfma_f32_16x16x32_bf16 v[120:123], v[148:151], v[156:159], v[120:123]
    s_waitcnt lgkmcnt(5)
    buffer_store_dwordx4 v[44:47], v6, s[4:7], s76 offen sc1
    v_mfma_f32_16x16x32_bf16 v[68:71], v[124:127], v[160:163], v[68:71]
    ds_read_b128 v[148:151], v9 offset:56320
    v_lshrrev_b32 v201, 3, v0
    v_mfma_f32_16x16x32_bf16 v[72:75], v[124:127], v[164:167], v[72:75]
    s_waitcnt lgkmcnt(4)
    v_exp_f32 v60, v60
    v_mfma_f32_16x16x32_bf16 v[76:79], v[128:131], v[160:163], v[76:79]
    ds_read_b128 v[124:127], v9 offset:57344
    v_fma_f32 v60, v60, v207, v207
    v_mfma_f32_16x16x32_bf16 v[80:83], v[128:131], v[164:167], v[80:83]
    v_exp_f32 v61, v61
    v_mfma_f32_16x16x32_bf16 v[84:87], v[132:135], v[160:163], v[84:87]
    ds_read_b128 v[128:131], v9 offset:58368
    v_fma_f32 v61, v61, v207, v207
    v_mfma_f32_16x16x32_bf16 v[88:91], v[132:135], v[164:167], v[88:91]
    s_waitcnt lgkmcnt(4)
    v_exp_f32 v62, v62
    v_mfma_f32_16x16x32_bf16 v[92:95], v[136:139], v[160:163], v[92:95]
    ds_read_b128 v[132:135], v9 offset:59392
    v_fma_f32 v62, v62, v207, v207
    v_mfma_f32_16x16x32_bf16 v[96:99], v[136:139], v[164:167], v[96:99]
    v_exp_f32 v63, v63
    v_mfma_f32_16x16x32_bf16 v[100:103], v[140:143], v[160:163], v[100:103]
    ds_read_b128 v[136:139], v9 offset:60416
    v_fma_f32 v63, v63, v207, v207
    v_mfma_f32_16x16x32_bf16 v[104:107], v[140:143], v[164:167], v[104:107]
    s_waitcnt lgkmcnt(4)
    v_rcp_f32 v60, v60
    v_mfma_f32_16x16x32_bf16 v[108:111], v[144:147], v[160:163], v[108:111]
    ds_read_b128 v[140:143], v9 offset:61440
    v_mul_f32 v64, v64, v60
    v_mfma_f32_16x16x32_bf16 v[112:115], v[144:147], v[164:167], v[112:115]
    buffer_load_dwordx4 a[236:239], v1, s[4:7], s81 offen offset:3072 sc1
    v_mfma_f32_16x16x32_bf16 v[116:119], v[148:151], v[160:163], v[116:119]
    s_add_u32 s81, s81, s19
    s_waitcnt vmcnt(9)
    ds_read_b128 v[144:147], v9 offset:62464
    v_lshl_add_u32 v200, v201, 28, v200
    v_mfma_f32_16x16x32_bf16 v[120:123], v[148:151], v[164:167], v[120:123]
    s_waitcnt lgkmcnt(5)
    v_rcp_f32 v61, v61
    v_mfma_f32_16x16x32_bf16 v[68:71], v[124:127], v[168:171], v[68:71]
    ds_read_b128 v[148:151], v9 offset:63488
    v_mul_f32 v65, v65, v61
    v_mfma_f32_16x16x32_bf16 v[72:75], v[124:127], v[172:175], v[72:75]
    s_waitcnt lgkmcnt(4)
    v_rcp_f32 v62, v62
    v_mfma_f32_16x16x32_bf16 v[76:79], v[128:131], v[168:171], v[76:79]
    ds_read_b128 v[124:127], v10 offset:0
    v_mul_f32 v66, v66, v62
    v_mfma_f32_16x16x32_bf16 v[80:83], v[128:131], v[172:175], v[80:83]
    v_rcp_f32 v63, v63
    v_mfma_f32_16x16x32_bf16 v[84:87], v[132:135], v[168:171], v[84:87]
    ds_read_b128 v[128:131], v10 offset:1024
    v_mul_f32 v67, v67, v63
    v_mfma_f32_16x16x32_bf16 v[88:91], v[132:135], v[172:175], v[88:91]
    s_waitcnt lgkmcnt(4)
    v_cvt_pk_bf16_f32 v60, v64, v65
    v_cvt_pk_bf16_f32 v61, v66, v67
    v_mfma_f32_16x16x32_bf16 v[92:95], v[136:139], v[168:171], v[92:95]
    ds_read_b128 v[132:135], v10 offset:2048
    v_mov_b32 v201, 1
    v_mfma_f32_16x16x32_bf16 v[96:99], v[136:139], v[172:175], v[96:99]
    buffer_store_dwordx2 v[60:61], v7, s[4:7], s76 offen sc1
    v_mfma_f32_16x16x32_bf16 v[100:103], v[140:143], v[168:171], v[100:103]
    ds_read_b128 v[136:139], v10 offset:3072
    s_sub_u32 s69, s86, s4
    v_mfma_f32_16x16x32_bf16 v[104:107], v[140:143], v[172:175], v[104:107]
    s_waitcnt lgkmcnt(4)
    s_add_u32 s69, s69, 4
    s_mul_i32 s50, s40, 229376
    v_mfma_f32_16x16x32_bf16 v[108:111], v[144:147], v[168:171], v[108:111]
    ds_read_b128 v[140:143], v10 offset:4096
    s_mul_i32 s51, s36, 14336
    v_mfma_f32_16x16x32_bf16 v[112:115], v[144:147], v[172:175], v[112:115]
    buffer_load_dwordx4 a[240:243], v1, s[4:7], s81 offen offset:0 sc1
    v_mfma_f32_16x16x32_bf16 v[116:119], v[148:151], v[168:171], v[116:119]
    s_waitcnt vmcnt(8)
    ds_read_b128 v[144:147], v10 offset:5120
    s_add_u32 s50, s50, s51
    v_mfma_f32_16x16x32_bf16 v[120:123], v[148:151], v[172:175], v[120:123]
    s_waitcnt lgkmcnt(5)
    s_add_u32 s50, s50, 23527424
    s_lshr_b32 s54, s36, 1
    v_mfma_f32_16x16x32_bf16 v[68:71], v[124:127], v[176:179], v[68:71]
    ds_read_b128 v[148:151], v10 offset:6144
    s_xor_b32 s54, s54, s36
    v_mfma_f32_16x16x32_bf16 v[72:75], v[124:127], v[180:183], v[72:75]
    s_waitcnt lgkmcnt(4)
    s_and_b32 s54, s54, 1
    s_lshl_b32 s51, s39, 7
    v_mfma_f32_16x16x32_bf16 v[76:79], v[128:131], v[176:179], v[76:79]
    ds_read_b128 v[124:127], v10 offset:7168
    s_xor_b32 s55, s54, 1
    v_mfma_f32_16x16x32_bf16 v[80:83], v[128:131], v[180:183], v[80:83]
    s_mul_i32 s52, s55, 57344
    s_add_u32 s52, s50, s52
    v_add_u32 v8, s52, v1
    v_mfma_f32_16x16x32_bf16 v[84:87], v[132:135], v[176:179], v[84:87]
    ds_read_b128 v[128:131], v10 offset:8192
    s_xor_b32 s55, s54, 0
    v_mfma_f32_16x16x32_bf16 v[88:91], v[132:135], v[180:183], v[88:91]
    s_waitcnt lgkmcnt(4)
    s_mul_i32 s52, s55, 57344
    s_add_u32 s52, s50, s52
    v_mfma_f32_16x16x32_bf16 v[92:95], v[136:139], v[176:179], v[92:95]
    ds_read_b128 v[132:135], v10 offset:9216
    v_add_u32 v208, s52, v1
    v_mfma_f32_16x16x32_bf16 v[96:99], v[136:139], v[180:183], v[96:99]
    s_xor_b32 s55, s54, 2
    s_mul_i32 s52, s55, 57344
    s_add_u32 s52, s50, s52
    v_mfma_f32_16x16x32_bf16 v[100:103], v[140:143], v[176:179], v[100:103]
    ds_read_b128 v[136:139], v10 offset:10240
    v_add_u32 v209, s52, v1
    v_mfma_f32_16x16x32_bf16 v[104:107], v[140:143], v[180:183], v[104:107]
    s_waitcnt lgkmcnt(4)
    s_xor_b32 s55, s54, 3
    s_mul_i32 s52, s55, 57344
    v_mfma_f32_16x16x32_bf16 v[108:111], v[144:147], v[176:179], v[108:111]
    ds_read_b128 v[140:143], v10 offset:11264
    s_add_u32 s52, s50, s52
    v_mfma_f32_16x16x32_bf16 v[112:115], v[144:147], v[180:183], v[112:115]
    buffer_load_dwordx4 a[244:247], v1, s[4:7], s81 offen offset:1024 sc1
    v_mfma_f32_16x16x32_bf16 v[116:119], v[148:151], v[176:179], v[116:119]
    s_waitcnt vmcnt(6)
    ds_read_b128 v[144:147], v10 offset:12288
    v_add_u32 v210, s52, v1
    v_mfma_f32_16x16x32_bf16 v[120:123], v[148:151], v[180:183], v[120:123]
    s_waitcnt lgkmcnt(5)
    v_mfma_f32_16x16x32_bf16 v[68:71], v[124:127], v[184:187], v[68:71]
    ds_read_b128 v[148:151], v10 offset:13312
    v_mfma_f32_16x16x32_bf16 v[72:75], v[124:127], v[188:191], v[72:75]
    s_waitcnt lgkmcnt(4)
    v_mfma_f32_16x16x32_bf16 v[76:79], v[128:131], v[184:187], v[76:79]
    v_mfma_f32_16x16x32_bf16 v[80:83], v[128:131], v[188:191], v[80:83]
    v_mfma_f32_16x16x32_bf16 v[84:87], v[132:135], v[184:187], v[84:87]
    v_mfma_f32_16x16x32_bf16 v[88:91], v[132:135], v[188:191], v[88:91]
    s_waitcnt lgkmcnt(2)
    buffer_load_dwordx4 a[248:251], v1, s[4:7], s81 offen offset:2048 sc1
    v_mfma_f32_16x16x32_bf16 v[92:95], v[136:139], v[184:187], v[92:95]
    v_mfma_f32_16x16x32_bf16 v[96:99], v[136:139], v[188:191], v[96:99]
    v_mfma_f32_16x16x32_bf16 v[100:103], v[140:143], v[184:187], v[100:103]
    v_mfma_f32_16x16x32_bf16 v[104:107], v[140:143], v[188:191], v[104:107]
    s_waitcnt lgkmcnt(0)
    v_mfma_f32_16x16x32_bf16 v[108:111], v[144:147], v[184:187], v[108:111]
    v_mfma_f32_16x16x32_bf16 v[112:115], v[144:147], v[188:191], v[112:115]
    buffer_load_dwordx4 a[252:255], v1, s[4:7], s81 offen offset:3072 sc1
    v_mfma_f32_16x16x32_bf16 v[116:119], v[148:151], v[184:187], v[116:119]
    s_add_u32 s81, s81, 4096
    v_mfma_f32_16x16x32_bf16 v[120:123], v[148:151], v[188:191], v[120:123]
    s_waitcnt vmcnt(4)
    buffer_atomic_add v201, v200, s[4:7], s69 offen sc1
    buffer_load_dwordx4 v[232:235], v1, s[4:7], s81 offen offset:0 sc1
    buffer_load_dwordx4 v[236:239], v1, s[4:7], s81 offen offset:1024 sc1
    buffer_load_dwordx4 v[240:243], v1, s[4:7], s81 offen offset:2048 sc1
    buffer_load_dwordx4 v[244:247], v1, s[4:7], s81 offen offset:3072 sc1
    s_add_u32 s81, s81, 4096
    buffer_load_dwordx4 v[248:251], v1, s[4:7], s81 offen offset:0 sc1
    buffer_load_dwordx4 v[252:255], v1, s[4:7], s81 offen offset:1024 sc1
    v_pk_mul_f32 v[84:85], v[68:69], v[84:85]
    v_pk_mul_f32 v[86:87], v[70:71], v[86:87]
    v_pk_mul_f32 v[68:69], v[68:69], v[194:195] op_sel:[0,0] op_sel_hi:[1,0]
    v_pk_mul_f32 v[70:71], v[70:71], v[194:195] op_sel:[0,0] op_sel_hi:[1,0]
    v_exp_f32 v68, v68
    v_exp_f32 v69, v69
    v_exp_f32 v70, v70
    v_exp_f32 v71, v71
    v_pk_fma_f32 v[68:69], v[68:69], v[198:199], v[198:199] op_sel:[0,0,0] op_sel_hi:[1,0,0]
    v_pk_fma_f32 v[70:71], v[70:71], v[198:199], v[198:199] op_sel:[0,0,0] op_sel_hi:[1,0,0]
    v_rcp_f32 v68, v68
    v_rcp_f32 v69, v69
    v_rcp_f32 v70, v70
    v_rcp_f32 v71, v71
    v_pk_mul_f32 v[84:85], v[84:85], v[68:69]
    v_pk_mul_f32 v[86:87], v[86:87], v[70:71]
    v_cvt_pk_bf16_f32 v68, v84, v85
    v_cvt_pk_bf16_f32 v69, v86, v87
    v_pk_mul_f32 v[92:93], v[76:77], v[92:93]
    v_pk_mul_f32 v[94:95], v[78:79], v[94:95]
    v_pk_mul_f32 v[76:77], v[76:77], v[194:195] op_sel:[0,0] op_sel_hi:[1,0]
    v_pk_mul_f32 v[78:79], v[78:79], v[194:195] op_sel:[0,0] op_sel_hi:[1,0]
    v_exp_f32 v76, v76
    v_exp_f32 v77, v77
    v_exp_f32 v78, v78
    v_exp_f32 v79, v79
    v_pk_fma_f32 v[76:77], v[76:77], v[198:199], v[198:199] op_sel:[0,0,0] op_sel_hi:[1,0,0]
    v_pk_fma_f32 v[78:79], v[78:79], v[198:199], v[198:199] op_sel:[0,0,0] op_sel_hi:[1,0,0]
    v_rcp_f32 v76, v76
    v_rcp_f32 v77, v77
    v_rcp_f32 v78, v78
    v_rcp_f32 v79, v79
    v_pk_mul_f32 v[92:93], v[92:93], v[76:77]
    v_pk_mul_f32 v[94:95], v[94:95], v[78:79]
    v_cvt_pk_bf16_f32 v70, v92, v93
    v_cvt_pk_bf16_f32 v71, v94, v95
    buffer_store_dwordx4 v[68:71], v1, s[4:7], s78 offen sc1
    v_pk_mul_f32 v[88:89], v[72:73], v[88:89]
    v_pk_mul_f32 v[90:91], v[74:75], v[90:91]
    v_pk_mul_f32 v[72:73], v[72:73], v[194:195] op_sel:[0,1] op_sel_hi:[1,1]
    v_pk_mul_f32 v[74:75], v[74:75], v[194:195] op_sel:[0,1] op_sel_hi:[1,1]
    v_exp_f32 v72, v72
    v_exp_f32 v73, v73
    v_exp_f32 v74, v74
    v_exp_f32 v75, v75
    v_pk_fma_f32 v[72:73], v[72:73], v[198:199], v[198:199] op_sel:[0,1,1] op_sel_hi:[1,1,1]
    v_pk_fma_f32 v[74:75], v[74:75], v[198:199], v[198:199] op_sel:[0,1,1] op_sel_hi:[1,1,1]
    v_rcp_f32 v72, v72
    v_rcp_f32 v73, v73
    v_rcp_f32 v74, v74
    v_rcp_f32 v75, v75
    v_pk_mul_f32 v[88:89], v[88:89], v[72:73]
    v_pk_mul_f32 v[90:91], v[90:91], v[74:75]
    v_cvt_pk_bf16_f32 v72, v88, v89
    v_cvt_pk_bf16_f32 v73, v90, v91
    v_pk_mul_f32 v[96:97], v[80:81], v[96:97]
    v_pk_mul_f32 v[98:99], v[82:83], v[98:99]
    v_pk_mul_f32 v[80:81], v[80:81], v[194:195] op_sel:[0,1] op_sel_hi:[1,1]
    v_pk_mul_f32 v[82:83], v[82:83], v[194:195] op_sel:[0,1] op_sel_hi:[1,1]
    v_exp_f32 v80, v80
    v_exp_f32 v81, v81
    v_exp_f32 v82, v82
    v_exp_f32 v83, v83
    v_pk_fma_f32 v[80:81], v[80:81], v[198:199], v[198:199] op_sel:[0,1,1] op_sel_hi:[1,1,1]
    v_pk_fma_f32 v[82:83], v[82:83], v[198:199], v[198:199] op_sel:[0,1,1] op_sel_hi:[1,1,1]
    v_rcp_f32 v80, v80
    v_rcp_f32 v81, v81
    v_rcp_f32 v82, v82
    v_rcp_f32 v83, v83
    v_pk_mul_f32 v[96:97], v[96:97], v[80:81]
    s_load_dword s91, s[92:93], 4 glc
    v_pk_mul_f32 v[98:99], v[98:99], v[82:83]
    v_cvt_pk_bf16_f32 v74, v96, v97
    v_cvt_pk_bf16_f32 v75, v98, v99
    buffer_store_dwordx4 v[72:75], v1, s[4:7], s79 offen sc1
    v_pk_mul_f32 v[108:109], v[100:101], v[108:109]
    v_pk_mul_f32 v[110:111], v[102:103], v[110:111]
    v_pk_mul_f32 v[100:101], v[100:101], v[194:195] op_sel:[0,0] op_sel_hi:[1,0]
    v_pk_mul_f32 v[102:103], v[102:103], v[194:195] op_sel:[0,0] op_sel_hi:[1,0]
    v_exp_f32 v100, v100
    v_exp_f32 v101, v101
    v_exp_f32 v102, v102
    v_exp_f32 v103, v103
    v_pk_fma_f32 v[100:101], v[100:101], v[198:199], v[198:199] op_sel:[0,0,0] op_sel_hi:[1,0,0]
    v_pk_fma_f32 v[102:103], v[102:103], v[198:199], v[198:199] op_sel:[0,0,0] op_sel_hi:[1,0,0]
    v_rcp_f32 v100, v100
    v_rcp_f32 v101, v101
    v_rcp_f32 v102, v102
    v_rcp_f32 v103, v103
    v_pk_mul_f32 v[108:109], v[108:109], v[100:101]
    v_pk_mul_f32 v[110:111], v[110:111], v[102:103]
    v_cvt_pk_bf16_f32 v100, v108, v109
    v_cvt_pk_bf16_f32 v101, v110, v111
    v_pk_mul_f32 v[112:113], v[104:105], v[112:113]
    v_pk_mul_f32 v[114:115], v[106:107], v[114:115]
    v_pk_mul_f32 v[104:105], v[104:105], v[194:195] op_sel:[0,1] op_sel_hi:[1,1]
    v_pk_mul_f32 v[106:107], v[106:107], v[194:195] op_sel:[0,1] op_sel_hi:[1,1]
    v_exp_f32 v104, v104
    v_exp_f32 v105, v105
    v_exp_f32 v106, v106
    v_exp_f32 v107, v107
    v_pk_fma_f32 v[104:105], v[104:105], v[198:199], v[198:199] op_sel:[0,1,1] op_sel_hi:[1,1,1]
    v_pk_fma_f32 v[106:107], v[106:107], v[198:199], v[198:199] op_sel:[0,1,1] op_sel_hi:[1,1,1]
    v_rcp_f32 v104, v104
    v_rcp_f32 v105, v105
    v_rcp_f32 v106, v106
    v_rcp_f32 v107, v107
    v_pk_mul_f32 v[112:113], v[112:113], v[104:105]
    v_pk_mul_f32 v[114:115], v[114:115], v[106:107]
    v_cvt_pk_bf16_f32 v102, v112, v113
    v_cvt_pk_bf16_f32 v103, v114, v115
    v_permlane32_swap_b32 v116, v120
    v_permlane32_swap_b32 v117, v121
    v_permlane32_swap_b32 v118, v122
    v_permlane32_swap_b32 v119, v123
    v_cndmask_b32 v206, v195, v194, s[66:67]
    v_cndmask_b32 v207, v199, v198, s[66:67]
    v_permlane32_swap_b32 v100, v102
    v_permlane32_swap_b32 v101, v103
    buffer_store_dwordx4 v[100:103], v6, s[4:7], s78 offen sc1
    v_pk_mul_f32 v[120:121], v[116:117], v[120:121]
    v_pk_mul_f32 v[122:123], v[118:119], v[122:123]
    v_pk_mul_f32 v[116:117], v[116:117], v[206:207] op_sel:[0,0] op_sel_hi:[1,0]
    v_pk_mul_f32 v[118:119], v[118:119], v[206:207] op_sel:[0,0] op_sel_hi:[1,0]
    v_exp_f32 v116, v116
    v_exp_f32 v117, v117
    v_exp_f32 v118, v118
    v_exp_f32 v119, v119
    v_pk_fma_f32 v[116:117], v[116:117], v[206:207], v[206:207] op_sel:[0,1,1] op_sel_hi:[1,1,1]
    v_pk_fma_f32 v[118:119], v[118:119], v[206:207], v[206:207] op_sel:[0,1,1] op_sel_hi:[1,1,1]
    v_rcp_f32 v116, v116
    v_rcp_f32 v117, v117
    v_rcp_f32 v118, v118
    v_rcp_f32 v119, v119
    v_pk_mul_f32 v[120:121], v[120:121], v[116:117]
    v_pk_mul_f32 v[122:123], v[122:123], v[118:119]
    v_cvt_pk_bf16_f32 v116, v120, v121
    v_cvt_pk_bf16_f32 v117, v122, v123
    buffer_store_dwordx2 v[116:117], v7, s[4:7], s78 offen sc1
    s_waitcnt lgkmcnt(0)
    s_cmp_ge_u32 s91, 8
    s_cbranch_scc1 POLLX12
    s_mov_b32 s68, 0
POLL11:
    s_load_dword s91, s[92:93], 4 glc
    s_add_u32 s68, s68, 1
    s_waitcnt lgkmcnt(0)
    s_cmp_ge_u32 s91, 8
    s_cbranch_scc1 POLLX12
    s_cmp_lt_u32 s68, 400000
    s_cbranch_scc1 POLL11
POLLX12:
    buffer_load_dwordx4 v[124:127], v8, s[4:7], 0 offen offset:0 sc1
    buffer_load_dwordx4 v[128:131], v8, s[4:7], 0 offen offset:1024 sc1
    buffer_load_dwordx4 v[132:135], v8, s[4:7], 0 offen offset:2048 sc1
    buffer_load_dwordx4 v[136:139], v8, s[4:7], 0 offen offset:3072 sc1
    buffer_load_dwordx4 v[140:143], v8, s[4:7], s16 offen offset:0 sc1
    buffer_load_dwordx4 v[144:147], v8, s[4:7], s16 offen offset:1024 sc1
    buffer_load_dwordx4 v[148:151], v8, s[4:7], s16 offen offset:2048 sc1
    s_min_u32 s50, s43, 6
    s_add_u32 s50, s50, 13
    s_mul_i32 s50, s50, 7168
    s_lshl_b32 s51, s36, 11
    s_min_u32 s51, s51, 5120
    s_add_u32 s50, s50, s51
    v_add_u32 v191, s50, v1
    s_mul_i32 s71, s42, 143360
    s_add_u32 s71, s71, 2097152
    ds_read_b128 v[192:195], v191
    ds_read_b128 v[196:199], v191 offset:1024
    s_waitcnt lgkmcnt(0)
    s_waitcnt vmcnt(7)
    s_barrier
    s_waitcnt vmcnt(6)
    v_mfma_f32_16x16x32_bf16 v[12:15], a[0:3], v[124:127], 0
    s_atomic_add s90, s[86:87], 131076
    buffer_load_dwordx4 v[152:155], v8, s[4:7], s16 offen offset:3072 sc1
    v_mfma_f32_16x16x32_bf16 v[16:19], a[4:7], v[124:127], 0
    s_atomic_add s90, s[86:87], 135172
    v_mfma_f32_16x16x32_bf16 v[20:23], a[8:11], v[124:127], 0
    s_atomic_add s90, s[86:87], 139268
    buffer_load_dwordx4 v[156:159], v8, s[4:7], s17 offen offset:0 sc1
    v_mfma_f32_16x16x32_bf16 v[24:27], a[12:15], v[124:127], 0
    s_waitcnt vmcnt(7)
    v_mfma_f32_16x16x32_bf16 v[28:31], a[16:19], v[124:127], 0
    s_atomic_add s90, s[86:87], 143364
    v_mfma_f32_16x16x32_bf16 v[12:15], a[20:23], v[128:131], v[12:15]
    s_atomic_add s90, s[86:87], 147460
    buffer_load_dwordx4 v[160:163], v8, s[4:7], s17 offen offset:1024 sc1
    v_mfma_f32_16x16x32_bf16 v[16:19], a[24:27], v[128:131], v[16:19]
    s_atomic_add s90, s[86:87], 151556
    v_mfma_f32_16x16x32_bf16 v[20:23], a[28:31], v[128:131], v[20:23]
    s_atomic_add s90, s[86:87], 155652
    buffer_load_dwordx4 v[164:167], v8, s[4:7], s17 offen offset:2048 sc1
    v_mfma_f32_16x16x32_bf16 v[24:27], a[32:35], v[128:131], v[24:27]
    s_waitcnt vmcnt(7)
    v_mfma_f32_16x16x32_bf16 v[28:31], a[36:39], v[128:131], v[28:31]
    s_atomic_add s90, s[86:87], 159748
    v_mfma_f32_16x16x32_bf16 v[12:15], a[40:43], v[132:135], v[12:15]
    buffer_load_dwordx4 v[168:171], v8, s[4:7], s17 offen offset:3072 sc1
    v_mfma_f32_16x16x32_bf16 v[12:15], a[60:63], v[136:139], v[12:15]
    v_mfma_f32_16x16x32_bf16 v[16:19], a[64:67], v[136:139], v[16:19]
    buffer_load_dwordx4 v[172:175], v8, s[4:7], s18 offen offset:0 sc1
    v_mfma_f32_16x16x32_bf16 v[16:19], a[44:47], v[132:135], v[16:19]
    s_xor_b32 s55, s54, 1
    s_mul_i32 s53, s55, 15360
    s_sub_u32 s52, s36, s55
    v_mfma_f32_16x16x32_bf16 v[20:23], a[48:51], v[132:135], v[20:23]
    s_sub_u32 s52, s52, 1
    s_and_b32 s52, s52, 3
    s_mul_i32 s52, s52, 5120
    v_mfma_f32_16x16x32_bf16 v[20:23], a[68:71], v[136:139], v[20:23]
    buffer_load_dwordx4 v[176:179], v8, s[4:7], s18 offen offset:1024 sc1
    v_mfma_f32_16x16x32_bf16 v[24:27], a[72:75], v[136:139], v[24:27]
    s_add_u32 s52, s52, s53
    s_add_u32 s52, s52, 93184
    v_add_u32 v184, s52, v1
    v_mfma_f32_16x16x32_bf16 v[24:27], a[52:55], v[132:135], v[24:27]
    buffer_load_dwordx4 v[124:127], v208, s[4:7], 0 offen offset:0 sc1
    v_mfma_f32_16x16x32_bf16 v[28:31], a[56:59], v[132:135], v[28:31]
    s_waitcnt vmcnt(9)
    s_xor_b32 s55, s54, 0
    s_mul_i32 s53, s55, 15360
    v_mfma_f32_16x16x32_bf16 v[28:31], a[76:79], v[136:139], v[28:31]
    s_sub_u32 s52, s36, s55
    s_sub_u32 s52, s52, 1
    s_and_b32 s52, s52, 3
    v_mfma_f32_16x16x32_bf16 v[12:15], a[80:83], v[140:143], v[12:15]
    buffer_load_dwordx4 v[128:131], v208, s[4:7], 0 offen offset:1024 sc1
    v_mfma_f32_16x16x32_bf16 v[12:15], a[100:103], v[144:147], v[12:15]
    s_mul_i32 s52, s52, 5120
    s_add_u32 s52, s52, s53
    s_add_u32 s52, s52, 93184
    v_mfma_f32_16x16x32_bf16 v[16:19], a[104:107], v[144:147], v[16:19]
    buffer_load_dwordx4 v[132:135], v208, s[4:7], 0 offen offset:2048 sc1
    v_mfma_f32_16x16x32_bf16 v[16:19], a[84:87], v[140:143], v[16:19]
    s_cmp_eq_u32 s55, s36
    s_cselect_b32 s52, 156672, s52
    s_cselect_b32 s20, 1.0, 0
    v_mfma_f32_16x16x32_bf16 v[20:23], a[88:91], v[140:143], v[20:23]
    s_xor_b32 s55, s54, 2
    v_add_u32 v185, s52, v1
    s_mul_i32 s53, s55, 15360
    v_mfma_f32_16x16x32_bf16 v[20:23], a[108:111], v[144:147], v[20:23]
    buffer_load_dwordx4 v[136:139], v208, s[4:7], 0 offen offset:3072 sc1
    v_mfma_f32_16x16x32_bf16 v[24:27], a[112:115], v[144:147], v[24:27]
    s_sub_u32 s52, s36, s55
    s_sub_u32 s52, s52, 1
    s_and_b32 s52, s52, 3
    v_mfma_f32_16x16x32_bf16 v[24:27], a[92:95], v[140:143], v[24:27]
    s_mul_i32 s52, s52, 5120
    s_add_u32 s52, s52, s53
    s_add_u32 s52, s52, 93184
    v_mfma_f32_16x16x32_bf16 v[28:31], a[96:99], v[140:143], v[28:31]
    s_waitcnt vmcnt(10)
    v_add_u32 v186, s52, v1
    s_xor_b32 s55, s54, 3
    v_mfma_f32_16x16x32_bf16 v[28:31], a[116:119], v[144:147], v[28:31]
    s_mul_i32 s53, s55, 15360
    s_sub_u32 s52, s36, s55
    s_sub_u32 s52, s52, 1
    v_mfma_f32_16x16x32_bf16 v[12:15], a[120:123], v[148:151], v[12:15]
    buffer_load_dwordx4 v[140:143], v208, s[4:7], s16 offen offset:0 sc1
    v_mfma_f32_16x16x32_bf16 v[12:15], a[140:143], v[152:155], v[12:15]
    s_and_b32 s52, s52, 3
    s_mul_i32 s52, s52, 5120
    s_add_u32 s52, s52, s53
    v_mfma_f32_16x16x32_bf16 v[16:19], a[144:147], v[152:155], v[16:19]
    buffer_load_dwordx4 v[144:147], v208, s[4:7], s16 offen offset:1024 sc1
    v_mfma_f32_16x16x32_bf16 v[16:19], a[124:127], v[148:151], v[16:19]
    s_add_u32 s52, s52, 93184
    s_cmp_eq_u32 s55, s36
    s_cselect_b32 s52, 156672, s52
    s_cselect_b32 s21, 1.0, 0
    v_mfma_f32_16x16x32_bf16 v[20:23], a[128:131], v[148:151], v[20:23]
    v_add_u32 v187, s52, v1
    s_mul_i32 s52, s36, 15360
    v_mfma_f32_16x16x32_bf16 v[20:23], a[148:151], v[152:155], v[20:23]
    s_add_u32 s52, s52, 93184
    s_cmp_eq_u32 s36, 3
    s_cselect_b32 s53, 5120, 0
    s_cselect_b32 s55, 0, 10240
    v_mfma_f32_16x16x32_bf16 v[24:27], a[152:155], v[152:155], v[24:27]
    v_add_u32 v188, s52, v1
    v_add_u32 v189, s53, v188
    v_mfma_f32_16x16x32_bf16 v[24:27], a[132:135], v[148:151], v[24:27]
    v_add_u32 v190, s55, v188
    v_mfma_f32_16x16x32_bf16 v[28:31], a[136:139], v[148:151], v[28:31]
    s_waitcnt vmcnt(10)
    v_mfma_f32_16x16x32_bf16 v[28:31], a[156:159], v[152:155], v[28:31]
    v_mfma_f32_16x16x32_bf16 v[12:15], a[160:163], v[156:159], v[12:15]
    buffer_load_dwordx4 v[148:151], v208, s[4:7], s16 offen offset:2048 sc1
    v_mfma_f32_16x16x32_bf16 v[12:15], a[180:183], v[160:163], v[12:15]
    v_mfma_f32_16x16x32_bf16 v[16:19], a[184:187], v[160:163], v[16:19]
    buffer_load_dwordx4 v[152:155], v208, s[4:7], s16 offen offset:3072 sc1
    v_mfma_f32_16x16x32_bf16 v[16:19], a[164:167], v[156:159], v[16:19]
    v_mfma_f32_16x16x32_bf16 v[20:23], a[168:171], v[156:159], v[20:23]
    v_mfma_f32_16x16x32_bf16 v[20:23], a[188:191], v[160:163], v[20:23]
    v_mfma_f32_16x16x32_bf16 v[24:27], a[192:195], v[160:163], v[24:27]
    v_mfma_f32_16x16x32_bf16 v[24:27], a[172:175], v[156:159], v[24:27]
    v_mfma_f32_16x16x32_bf16 v[28:31], a[176:179], v[156:159], v[28:31]
    s_waitcnt vmcnt(10)
    v_mfma_f32_16x16x32_bf16 v[28:31], a[196:199], v[160:163], v[28:31]
    v_mfma_f32_16x16x32_bf16 v[12:15], a[200:203], v[164:167], v[12:15]
    buffer_load_dwordx4 v[156:159], v208, s[4:7], s17 offen offset:0 sc1
    v_mfma_f32_16x16x32_bf16 v[12:15], a[220:223], v[168:171], v[12:15]
    v_mfma_f32_16x16x32_bf16 v[16:19], a[224:227], v[168:171], v[16:19]
    buffer_load_dwordx4 v[160:163], v208, s[4:7], s17 offen offset:1024 sc1
    v_mfma_f32_16x16x32_bf16 v[16:19], a[204:207], v[164:167], v[16:19]
    v_mfma_f32_16x16x32_bf16 v[20:23], a[208:211], v[164:167], v[20:23]
    v_mfma_f32_16x16x32_bf16 v[20:23], a[228:231], v[168:171], v[20:23]
    v_mfma_f32_16x16x32_bf16 v[24:27], a[232:235], v[168:171], v[24:27]
    s_load_dword s91, s[92:93], 131076 glc
    v_mfma_f32_16x16x32_bf16 v[24:27], a[212:215], v[164:167], v[24:27]
    v_mfma_f32_16x16x32_bf16 v[28:31], a[216:219], v[164:167], v[28:31]
    s_waitcnt vmcnt(10)
    v_mfma_f32_16x16x32_bf16 v[28:31], a[236:239], v[168:171], v[28:31]
    v_mfma_f32_16x16x32_bf16 v[12:15], a[240:243], v[172:175], v[12:15]
    buffer_load_dwordx4 v[164:167], v208, s[4:7], s17 offen offset:2048 sc1
    v_mfma_f32_16x16x32_bf16 v[12:15], v[236:239], v[176:179], v[12:15]
    v_mfma_f32_16x16x32_bf16 v[16:19], v[240:243], v[176:179], v[16:19]
    buffer_load_dwordx4 v[168:171], v208, s[4:7], s17 offen offset:3072 sc1
    v_mfma_f32_16x16x32_bf16 v[16:19], a[244:247], v[172:175], v[16:19]
    v_mfma_f32_16x16x32_bf16 v[20:23], a[248:251], v[172:175], v[20:23]
    v_mfma_f32_16x16x32_bf16 v[20:23], v[244:247], v[176:179], v[20:23]
    v_mfma_f32_16x16x32_bf16 v[24:27], v[248:251], v[176:179], v[24:27]
    v_mfma_f32_16x16x32_bf16 v[24:27], a[252:255], v[172:175], v[24:27]
    v_mfma_f32_16x16x32_bf16 v[28:31], v[232:235], v[172:175], v[28:31]
    s_waitcnt vmcnt(10)
    v_mfma_f32_16x16x32_bf16 v[28:31], v[252:255], v[176:179], v[28:31]
    v_mfma_f32_16x16x32_bf16 v[32:35], a[0:3], v[124:127], 0
    buffer_load_dwordx4 v[172:175], v208, s[4:7], s18 offen offset:0 sc1
    v_mfma_f32_16x16x32_bf16 v[32:35], a[20:23], v[128:131], v[32:35]
    v_mfma_f32_16x16x32_bf16 v[36:39], a[24:27], v[128:131], 0
    buffer_load_dwordx4 v[176:179], v208, s[4:7], s18 offen offset:1024 sc1
    v_mfma_f32_16x16x32_bf16 v[36:39], a[4:7], v[124:127], v[36:39]
    v_mfma_f32_16x16x32_bf16 v[40:43], a[8:11], v[124:127], 0
    v_mfma_f32_16x16x32_bf16 v[40:43], a[28:31], v[128:131], v[40:43]
    v_mfma_f32_16x16x32_bf16 v[44:47], a[32:35], v[128:131], 0
    v_mfma_f32_16x16x32_bf16 v[44:47], a[12:15], v[124:127], v[44:47]
    v_mfma_f32_16x16x32_bf16 v[48:51], a[16:19], v[124:127], 0
    s_waitcnt vmcnt(10)
    v_mfma_f32_16x16x32_bf16 v[48:51], a[36:39], v[128:131], v[48:51]
    ds_write_b128 v184, v[12:15] offset:0
    v_mfma_f32_16x16x32_bf16 v[32:35], a[40:43], v[132:135], v[32:35]
    v_mfma_f32_16x16x32_bf16 v[32:35], a[60:63], v[136:139], v[32:35]
    v_mfma_f32_16x16x32_bf16 v[36:39], a[64:67], v[136:139], v[36:39]
    v_mfma_f32_16x16x32_bf16 v[36:39], a[44:47], v[132:135], v[36:39]
    v_mfma_f32_16x16x32_bf16 v[40:43], a[48:51], v[132:135], v[40:43]
    ds_write_b128 v184, v[16:19] offset:1024
    v_mfma_f32_16x16x32_bf16 v[40:43], a[68:71], v[136:139], v[40:43]
    v_mfma_f32_16x16x32_bf16 v[44:47], a[72:75], v[136:139], v[44:47]
    v_mfma_f32_16x16x32_bf16 v[44:47], a[52:55], v[132:135], v[44:47]
    v_mfma_f32_16x16x32_bf16 v[48:51], a[56:59], v[132:135], v[48:51]
    s_waitcnt vmcnt(8)
    v_mfma_f32_16x16x32_bf16 v[48:51], a[76:79], v[136:139], v[48:51]
    ds_write_b128 v184, v[20:23] offset:2048
    v_mfma_f32_16x16x32_bf16 v[32:35], a[80:83], v[140:143], v[32:35]
    v_mfma_f32_16x16x32_bf16 v[32:35], a[100:103], v[144:147], v[32:35]
    v_mfma_f32_16x16x32_bf16 v[36:39], a[104:107], v[144:147], v[36:39]
    v_mfma_f32_16x16x32_bf16 v[36:39], a[84:87], v[140:143], v[36:39]
    v_mfma_f32_16x16x32_bf16 v[40:43], a[88:91], v[140:143], v[40:43]
    s_waitcnt lgkmcnt(0)
    s_cmp_ge_u32 s91, 8
    s_cbranch_scc1 POLLX14
    s_mov_b32 s68, 0
POLL13:
    s_load_dword s91, s[92:93], 131076 glc
    s_add_u32 s68, s68, 1
    s_waitcnt lgkmcnt(0)
    s_cmp_ge_u32 s91, 8
    s_cbranch_scc1 POLLX14
    s_cmp_lt_u32 s68, 400000
    s_cbranch_scc1 POLL13
POLLX14:
    ds_write_b128 v184, v[24:27] offset:3072
    v_mfma_f32_16x16x32_bf16 v[40:43], a[108:111], v[144:147], v[40:43]
    buffer_load_dwordx4 v[124:127], v209, s[4:7], 0 offen offset:0 sc1
    v_mfma_f32_16x16x32_bf16 v[44:47], a[112:115], v[144:147], v[44:47]
    v_mfma_f32_16x16x32_bf16 v[44:47], a[92:95], v[140:143], v[44:47]
    buffer_load_dwordx4 v[128:131], v209, s[4:7], 0 offen offset:1024 sc1
    v_mfma_f32_16x16x32_bf16 v[48:51], a[96:99], v[140:143], v[48:51]
    s_waitcnt vmcnt(8)
    v_mfma_f32_16x16x32_bf16 v[48:51], a[116:119], v[144:147], v[48:51]
    ds_write_b128 v184, v[28:31] offset:4096
    v_mfma_f32_16x16x32_bf16 v[32:35], a[120:123], v[148:151], v[32:35]
    buffer_load_dwordx4 v[132:135], v209, s[4:7], 0 offen offset:2048 sc1
    v_mfma_f32_16x16x32_bf16 v[32:35], a[140:143], v[152:155], v[32:35]
    s_add_u32 s56, s64, 20512768
    s_mul_i32 s59, s39, 1280
    s_add_u32 s57, s56, s59
    v_mfma_f32_16x16x32_bf16 v[36:39], a[144:147], v[152:155], v[36:39]
    buffer_load_dwordx4 v[136:139], v209, s[4:7], 0 offen offset:3072 sc1
    v_mfma_f32_16x16x32_bf16 v[36:39], a[124:127], v[148:151], v[36:39]
    s_sub_u32 s58, s56, s59
    s_add_u32 s58, s58, 19200
    s_lshl_b32 s59, s39, 7
    v_mfma_f32_16x16x32_bf16 v[40:43], a[128:131], v[148:151], v[40:43]
    s_add_u32 s59, s59, s65
    s_add_u32 s59, s59, 23396288
    s_mov_b32 s60, 0x3f803f80
    v_mfma_f32_16x16x32_bf16 v[40:43], a[148:151], v[152:155], v[40:43]
    buffer_load_dwordx4 v[140:143], v209, s[4:7], s16 offen offset:0 sc1
    v_mfma_f32_16x16x32_bf16 v[44:47], a[152:155], v[152:155], v[44:47]
    s_lshl_b32 s50, s38, 2
    v_mov_b32 v112, 0
    v_mov_b32 v113, 0
    v_mfma_f32_16x16x32_bf16 v[44:47], a[132:135], v[148:151], v[44:47]
    buffer_load_dwordx4 v[144:147], v209, s[4:7], s16 offen offset:1024 sc1
    v_mfma_f32_16x16x32_bf16 v[48:51], a[136:139], v[148:151], v[48:51]
    s_waitcnt vmcnt(10)
    v_subrev_u32 v114, 16, v0
    v_lshrrev_b32 v115, 5, v114
    v_mfma_f32_16x16x32_bf16 v[48:51], a[156:159], v[152:155], v[48:51]
    s_add_u32 s50, s50, s36
    v_min_u32 v115, 1, v115
    v_lshlrev_b32 v115, 28, v115
    v_mfma_f32_16x16x32_bf16 v[32:35], a[160:163], v[156:159], v[32:35]
    buffer_load_dwordx4 v[148:151], v209, s[4:7], s16 offen offset:2048 sc1
    v_mfma_f32_16x16x32_bf16 v[32:35], a[180:183], v[160:163], v[32:35]
    s_mul_i32 s50, s50, 3200
    v_add_u32 v114, v115, v5
    s_mul_i32 s51, s39, 51200
    v_mfma_f32_16x16x32_bf16 v[36:39], a[184:187], v[160:163], v[36:39]
    buffer_load_dwordx4 v[152:155], v209, s[4:7], s16 offen offset:3072 sc1
    v_mfma_f32_16x16x32_bf16 v[36:39], a[164:167], v[156:159], v[36:39]
    s_add_u32 s50, s50, s51
    s_add_u32 s46, s50, 38207488
    v_min_u32 v92, 24, v0
    v_mfma_f32_16x16x32_bf16 v[40:43], a[168:171], v[156:159], v[40:43]
    v_lshlrev_b32 v92, 7, v92
    v_mfma_f32_16x16x32_bf16 v[40:43], a[188:191], v[160:163], v[40:43]
    v_mfma_f32_16x16x32_bf16 v[44:47], a[192:195], v[160:163], v[44:47]
    v_mfma_f32_16x16x32_bf16 v[44:47], a[172:175], v[156:159], v[44:47]
    v_mfma_f32_16x16x32_bf16 v[48:51], a[176:179], v[156:159], v[48:51]
    s_waitcnt vmcnt(10)
    v_mfma_f32_16x16x32_bf16 v[48:51], a[196:199], v[160:163], v[48:51]
    v_mfma_f32_16x16x32_bf16 v[32:35], a[200:203], v[164:167], v[32:35]
    buffer_load_dwordx4 v[156:159], v209, s[4:7], s17 offen offset:0 sc1
    v_mfma_f32_16x16x32_bf16 v[32:35], a[220:223], v[168:171], v[32:35]
    v_mfma_f32_16x16x32_bf16 v[36:39], a[224:227], v[168:171], v[36:39]
    buffer_load_dwordx4 v[160:163], v209, s[4:7], s17 offen offset:1024 sc1
    v_mfma_f32_16x16x32_bf16 v[36:39], a[204:207], v[164:167], v[36:39]
    v_mfma_f32_16x16x32_bf16 v[40:43], a[208:211], v[164:167], v[40:43]
    v_mfma_f32_16x16x32_bf16 v[40:43], a[228:231], v[168:171], v[40:43]
    v_mfma_f32_16x16x32_bf16 v[44:47], a[232:235], v[168:171], v[44:47]
    v_mfma_f32_16x16x32_bf16 v[44:47], a[212:215], v[164:167], v[44:47]
    v_mfma_f32_16x16x32_bf16 v[48:51], a[216:219], v[164:167], v[48:51]
    s_waitcnt vmcnt(10)
    v_mfma_f32_16x16x32_bf16 v[48:51], a[236:239], v[168:171], v[48:51]
    v_mfma_f32_16x16x32_bf16 v[32:35], a[240:243], v[172:175], v[32:35]
    buffer_load_dwordx4 v[164:167], v209, s[4:7], s17 offen offset:2048 sc1
    v_mfma_f32_16x16x32_bf16 v[32:35], v[236:239], v[176:179], v[32:35]
    v_mfma_f32_16x16x32_bf16 v[36:39], v[240:243], v[176:179], v[36:39]
    buffer_load_dwordx4 v[168:171], v209, s[4:7], s17 offen offset:3072 sc1
    v_mfma_f32_16x16x32_bf16 v[36:39], a[244:247], v[172:175], v[36:39]
    v_mfma_f32_16x16x32_bf16 v[40:43], a[248:251], v[172:175], v[40:43]
    v_mfma_f32_16x16x32_bf16 v[40:43], v[244:247], v[176:179], v[40:43]
    v_mfma_f32_16x16x32_bf16 v[44:47], v[248:251], v[176:179], v[44:47]
    v_mfma_f32_16x16x32_bf16 v[44:47], a[252:255], v[172:175], v[44:47]
    v_mfma_f32_16x16x32_bf16 v[48:51], v[232:235], v[172:175], v[48:51]
    s_waitcnt vmcnt(10)
    v_mfma_f32_16x16x32_bf16 v[48:51], v[252:255], v[176:179], v[48:51]
    v_mfma_f32_16x16x32_bf16 v[52:55], a[0:3], v[124:127], 0
    buffer_load_dwordx4 v[172:175], v209, s[4:7], s18 offen offset:0 sc1
    v_mfma_f32_16x16x32_bf16 v[52:55], a[20:23], v[128:131], v[52:55]
    v_mfma_f32_16x16x32_bf16 v[56:59], a[24:27], v[128:131], 0
    buffer_load_dwordx4 v[176:179], v209, s[4:7], s18 offen offset:1024 sc1
    v_mfma_f32_16x16x32_bf16 v[56:59], a[4:7], v[124:127], v[56:59]
    v_mfma_f32_16x16x32_bf16 v[60:63], a[8:11], v[124:127], 0
    v_mfma_f32_16x16x32_bf16 v[60:63], a[28:31], v[128:131], v[60:63]
    v_mfma_f32_16x16x32_bf16 v[64:67], a[32:35], v[128:131], 0
    v_fmac_f32 v212, s20, v32
    v_fmac_f32 v213, s20, v33
    v_mfma_f32_16x16x32_bf16 v[64:67], a[12:15], v[124:127], v[64:67]
    v_fmac_f32 v214, s20, v34
    v_fmac_f32 v215, s20, v35
    v_mfma_f32_16x16x32_bf16 v[68:71], a[16:19], v[124:127], 0
    s_waitcnt vmcnt(10)
    v_fmac_f32 v216, s20, v36
    v_fmac_f32 v217, s20, v37
    v_mfma_f32_16x16x32_bf16 v[68:71], a[36:39], v[128:131], v[68:71]
    ds_write_b128 v185, v[32:35] offset:0
    v_mfma_f32_16x16x32_bf16 v[52:55], a[40:43], v[132:135], v[52:55]
    buffer_load_dwordx4 v[124:127], v210, s[4:7], 0 offen offset:0 sc1
    v_mfma_f32_16x16x32_bf16 v[52:55], a[60:63], v[136:139], v[52:55]
    v_fmac_f32 v218, s20, v38
    v_fmac_f32 v219, s20, v39
    v_mfma_f32_16x16x32_bf16 v[56:59], a[64:67], v[136:139], v[56:59]
    buffer_load_dwordx4 v[128:131], v210, s[4:7], 0 offen offset:1024 sc1
    v_mfma_f32_16x16x32_bf16 v[56:59], a[44:47], v[132:135], v[56:59]
    v_fmac_f32 v220, s20, v40
    v_fmac_f32 v221, s20, v41
    v_mfma_f32_16x16x32_bf16 v[60:63], a[48:51], v[132:135], v[60:63]
    ds_write_b128 v185, v[36:39] offset:1024
    v_mfma_f32_16x16x32_bf16 v[60:63], a[68:71], v[136:139], v[60:63]
    v_fmac_f32 v222, s20, v42
    v_fmac_f32 v223, s20, v43
    v_mfma_f32_16x16x32_bf16 v[64:67], a[72:75], v[136:139], v[64:67]
    v_fmac_f32 v224, s20, v44
    v_fmac_f32 v225, s20, v45
    v_mfma_f32_16x16x32_bf16 v[64:67], a[52:55], v[132:135], v[64:67]
    v_fmac_f32 v226, s20, v46
    v_fmac_f32 v227, s20, v47
    v_mfma_f32_16x16x32_bf16 v[68:71], a[56:59], v[132:135], v[68:71]
    s_waitcnt vmcnt(10)
    v_fmac_f32 v228, s20, v48
    v_fmac_f32 v229, s20, v49
    v_mfma_f32_16x16x32_bf16 v[68:71], a[76:79], v[136:139], v[68:71]
    ds_write_b128 v185, v[40:43] offset:2048
    v_mfma_f32_16x16x32_bf16 v[52:55], a[80:83], v[140:143], v[52:55]
    buffer_load_dwordx4 v[132:135], v210, s[4:7], 0 offen offset:2048 sc1
    v_mfma_f32_16x16x32_bf16 v[52:55], a[100:103], v[144:147], v[52:55]
    v_fmac_f32 v230, s20, v50
    v_fmac_f32 v231, s20, v51
    v_mfma_f32_16x16x32_bf16 v[56:59], a[104:107], v[144:147], v[56:59]
    buffer_load_dwordx4 v[136:139], v210, s[4:7], 0 offen offset:3072 sc1
    v_mfma_f32_16x16x32_bf16 v[56:59], a[84:87], v[140:143], v[56:59]
    v_mfma_f32_16x16x32_bf16 v[60:63], a[88:91], v[140:143], v[60:63]
    ds_write_b128 v185, v[44:47] offset:3072
    v_mfma_f32_16x16x32_bf16 v[60:63], a[108:111], v[144:147], v[60:63]
    v_mfma_f32_16x16x32_bf16 v[64:67], a[112:115], v[144:147], v[64:67]
    v_mfma_f32_16x16x32_bf16 v[64:67], a[92:95], v[140:143], v[64:67]
    v_mfma_f32_16x16x32_bf16 v[68:71], a[96:99], v[140:143], v[68:71]
    s_waitcnt vmcnt(10)
    v_mfma_f32_16x16x32_bf16 v[68:71], a[116:119], v[144:147], v[68:71]
    ds_write_b128 v185, v[48:51] offset:4096
    v_mfma_f32_16x16x32_bf16 v[52:55], a[120:123], v[148:151], v[52:55]
    buffer_load_dwordx4 v[140:143], v210, s[4:7], s16 offen offset:0 sc1
    v_mfma_f32_16x16x32_bf16 v[52:55], a[140:143], v[152:155], v[52:55]
    v_mfma_f32_16x16x32_bf16 v[56:59], a[144:147], v[152:155], v[56:59]
    buffer_load_dwordx4 v[144:147], v210, s[4:7], s16 offen offset:1024 sc1
    v_mfma_f32_16x16x32_bf16 v[56:59], a[124:127], v[148:151], v[56:59]
    v_mfma_f32_16x16x32_bf16 v[60:63], a[128:131], v[148:151], v[60:63]
    v_mfma_f32_16x16x32_bf16 v[60:63], a[148:151], v[152:155], v[60:63]
    v_mfma_f32_16x16x32_bf16 v[64:67], a[152:155], v[152:155], v[64:67]
    v_mfma_f32_16x16x32_bf16 v[64:67], a[132:135], v[148:151], v[64:67]
    v_mfma_f32_16x16x32_bf16 v[68:71], a[136:139], v[148:151], v[68:71]
    s_waitcnt vmcnt(10)
    v_mfma_f32_16x16x32_bf16 v[68:71], a[156:159], v[152:155], v[68:71]
    v_mfma_f32_16x16x32_bf16 v[52:55], a[160:163], v[156:159], v[52:55]
    buffer_load_dwordx4 v[148:151], v210, s[4:7], s16 offen offset:2048 sc1
    v_mfma_f32_16x16x32_bf16 v[52:55], a[180:183], v[160:163], v[52:55]
    v_mfma_f32_16x16x32_bf16 v[56:59], a[184:187], v[160:163], v[56:59]
    buffer_load_dwordx4 v[152:155], v210, s[4:7], s16 offen offset:3072 sc1
    v_mfma_f32_16x16x32_bf16 v[56:59], a[164:167], v[156:159], v[56:59]
    v_mfma_f32_16x16x32_bf16 v[60:63], a[168:171], v[156:159], v[60:63]
    v_mfma_f32_16x16x32_bf16 v[60:63], a[188:191], v[160:163], v[60:63]
    v_mfma_f32_16x16x32_bf16 v[64:67], a[192:195], v[160:163], v[64:67]
    v_mfma_f32_16x16x32_bf16 v[64:67], a[172:175], v[156:159], v[64:67]
    v_mfma_f32_16x16x32_bf16 v[68:71], a[176:179], v[156:159], v[68:71]
    s_waitcnt vmcnt(10)
    v_mfma_f32_16x16x32_bf16 v[68:71], a[196:199], v[160:163], v[68:71]
    v_mfma_f32_16x16x32_bf16 v[52:55], a[200:203], v[164:167], v[52:55]
    buffer_load_dwordx4 v[156:159], v210, s[4:7], s17 offen offset:0 sc1
    v_mfma_f32_16x16x32_bf16 v[52:55], a[220:223], v[168:171], v[52:55]
    v_mfma_f32_16x16x32_bf16 v[56:59], a[224:227], v[168:171], v[56:59]
    buffer_load_dwordx4 v[160:163], v210, s[4:7], s17 offen offset:1024 sc1
    v_mfma_f32_16x16x32_bf16 v[56:59], a[204:207], v[164:167], v[56:59]
    v_mfma_f32_16x16x32_bf16 v[60:63], a[208:211], v[164:167], v[60:63]
    v_mfma_f32_16x16x32_bf16 v[60:63], a[228:231], v[168:171], v[60:63]
    v_mfma_f32_16x16x32_bf16 v[64:67], a[232:235], v[168:171], v[64:67]
    v_mfma_f32_16x16x32_bf16 v[64:67], a[212:215], v[164:167], v[64:67]
    v_mfma_f32_16x16x32_bf16 v[68:71], a[216:219], v[164:167], v[68:71]
    s_waitcnt vmcnt(10)
    v_mfma_f32_16x16x32_bf16 v[68:71], a[236:239], v[168:171], v[68:71]
    v_mfma_f32_16x16x32_bf16 v[52:55], a[240:243], v[172:175], v[52:55]
    buffer_load_dwordx4 v[164:167], v210, s[4:7], s17 offen offset:2048 sc1
    v_mfma_f32_16x16x32_bf16 v[52:55], v[236:239], v[176:179], v[52:55]
    v_mfma_f32_16x16x32_bf16 v[56:59], v[240:243], v[176:179], v[56:59]
    buffer_load_dwordx4 v[168:171], v210, s[4:7], s17 offen offset:3072 sc1
    v_mfma_f32_16x16x32_bf16 v[56:59], a[244:247], v[172:175], v[56:59]
    v_mfma_f32_16x16x32_bf16 v[60:63], a[248:251], v[172:175], v[60:63]
    v_mfma_f32_16x16x32_bf16 v[60:63], v[244:247], v[176:179], v[60:63]
    v_mfma_f32_16x16x32_bf16 v[64:67], v[248:251], v[176:179], v[64:67]
    v_mfma_f32_16x16x32_bf16 v[64:67], a[252:255], v[172:175], v[64:67]
    v_mfma_f32_16x16x32_bf16 v[68:71], v[232:235], v[172:175], v[68:71]
    s_waitcnt vmcnt(10)
    v_mfma_f32_16x16x32_bf16 v[68:71], v[252:255], v[176:179], v[68:71]
    v_mfma_f32_16x16x32_bf16 v[72:75], a[0:3], v[124:127], 0
    buffer_load_dwordx4 v[172:175], v210, s[4:7], s18 offen offset:0 sc1
    v_mfma_f32_16x16x32_bf16 v[72:75], a[20:23], v[128:131], v[72:75]
    v_mfma_f32_16x16x32_bf16 v[76:79], a[24:27], v[128:131], 0
    buffer_load_dwordx4 v[176:179], v210, s[4:7], s18 offen offset:1024 sc1
    v_mfma_f32_16x16x32_bf16 v[76:79], a[4:7], v[124:127], v[76:79]
    buffer_store_dwordx4 v[192:195], v191, s[4:7], s71 offen offset:0 sc1
    v_mfma_f32_16x16x32_bf16 v[80:83], a[8:11], v[124:127], 0
    ds_write_b128 v186, v[52:55] offset:0
    v_mfma_f32_16x16x32_bf16 v[80:83], a[28:31], v[128:131], v[80:83]
    buffer_store_dwordx4 v[196:199], v191, s[4:7], s71 offen offset:1024 sc1
    v_mfma_f32_16x16x32_bf16 v[84:87], a[32:35], v[128:131], 0
    ds_write_b128 v186, v[56:59] offset:1024
    v_mfma_f32_16x16x32_bf16 v[84:87], a[12:15], v[124:127], v[84:87]
    v_mfma_f32_16x16x32_bf16 v[88:91], a[16:19], v[124:127], 0
    s_waitcnt vmcnt(12)
    ds_write_b128 v186, v[60:63] offset:2048
    v_mfma_f32_16x16x32_bf16 v[88:91], a[36:39], v[128:131], v[88:91]
    v_mfma_f32_16x16x32_bf16 v[72:75], a[40:43], v[132:135], v[72:75]
    ds_write_b128 v186, v[64:67] offset:3072
    v_mfma_f32_16x16x32_bf16 v[72:75], a[60:63], v[136:139], v[72:75]
    buffer_load_dword v93, v92, s[4:7], s46 offen sc1
    v_mfma_f32_16x16x32_bf16 v[76:79], a[64:67], v[136:139], v[76:79]
    ds_write_b128 v186, v[68:71] offset:4096
    v_mfma_f32_16x16x32_bf16 v[76:79], a[44:47], v[132:135], v[76:79]
    v_mfma_f32_16x16x32_bf16 v[80:83], a[48:51], v[132:135], v[80:83]
    v_mfma_f32_16x16x32_bf16 v[80:83], a[68:71], v[136:139], v[80:83]
    v_mfma_f32_16x16x32_bf16 v[84:87], a[72:75], v[136:139], v[84:87]
    v_mfma_f32_16x16x32_bf16 v[84:87], a[52:55], v[132:135], v[84:87]
    v_mfma_f32_16x16x32_bf16 v[88:91], a[56:59], v[132:135], v[88:91]
    s_waitcnt lgkmcnt(0)
    s_waitcnt vmcnt(11)
    s_barrier
    v_mfma_f32_16x16x32_bf16 v[88:91], a[76:79], v[136:139], v[88:91]
    ds_read_b128 v[12:15], v189 offset:0
    v_mfma_f32_16x16x32_bf16 v[72:75], a[80:83], v[140:143], v[72:75]
    ds_read_b128 v[32:35], v189 offset:5120
    v_mfma_f32_16x16x32_bf16 v[72:75], a[100:103], v[144:147], v[72:75]
    ds_read_b128 v[16:19], v189 offset:1024
    v_mfma_f32_16x16x32_bf16 v[76:79], a[104:107], v[144:147], v[76:79]
    ds_read_b128 v[36:39], v189 offset:6144
    v_mfma_f32_16x16x32_bf16 v[76:79], a[84:87], v[140:143], v[76:79]
    ds_read_b128 v[20:23], v189 offset:2048
    v_mfma_f32_16x16x32_bf16 v[80:83], a[88:91], v[140:143], v[80:83]
    ds_read_b128 v[40:43], v189 offset:7168
    v_mfma_f32_16x16x32_bf16 v[80:83], a[108:111], v[144:147], v[80:83]
    ds_read_b128 v[24:27], v189 offset:3072
    v_mfma_f32_16x16x32_bf16 v[84:87], a[112:115], v[144:147], v[84:87]
    ds_read_b128 v[44:47], v189 offset:8192
    v_mfma_f32_16x16x32_bf16 v[84:87], a[92:95], v[140:143], v[84:87]
    ds_read_b128 v[28:31], v189 offset:4096
    s_waitcnt lgkmcnt(8)
    v_add_f32 v212, v212, v12
    v_mfma_f32_16x16x32_bf16 v[88:91], a[96:99], v[140:143], v[88:91]
    s_waitcnt vmcnt(10)
    ds_read_b128 v[48:51], v189 offset:9216
    v_add_f32 v213, v213, v13
    v_mfma_f32_16x16x32_bf16 v[88:91], a[116:119], v[144:147], v[88:91]
    v_add_f32 v214, v214, v14
    v_add_f32 v215, v215, v15
    v_mfma_f32_16x16x32_bf16 v[72:75], a[120:123], v[148:151], v[72:75]
    s_waitcnt lgkmcnt(8)
    v_add_f32 v212, v212, v32
    v_add_f32 v213, v213, v33
    v_mfma_f32_16x16x32_bf16 v[76:79], a[124:127], v[148:151], v[76:79]
    v_add_f32 v214, v214, v34
    v_add_f32 v215, v215, v35
    v_mfma_f32_16x16x32_bf16 v[80:83], a[128:131], v[148:151], v[80:83]
    s_waitcnt lgkmcnt(7)
    v_add_f32 v216, v216, v16
    v_add_f32 v217, v217, v17
    v_mfma_f32_16x16x32_bf16 v[84:87], a[132:135], v[148:151], v[84:87]
    s_waitcnt vmcnt(9)
    v_add_f32 v218, v218, v18
    v_add_f32 v219, v219, v19
    v_mfma_f32_16x16x32_bf16 v[88:91], a[136:139], v[148:151], v[88:91]
    s_waitcnt lgkmcnt(6)
    v_add_f32 v216, v216, v36
    v_add_f32 v217, v217, v37
    v_mfma_f32_16x16x32_bf16 v[72:75], a[140:143], v[152:155], v[72:75]
    v_add_f32 v218, v218, v38
    v_add_f32 v219, v219, v39
    s_waitcnt vmcnt(8)
    v_mfma_f32_16x16x32_bf16 v[72:75], a[160:163], v[156:159], v[72:75]
    s_waitcnt lgkmcnt(5)
    v_add_f32 v220, v220, v20
    v_add_f32 v221, v221, v21
    s_waitcnt vmcnt(7)
    v_mfma_f32_16x16x32_bf16 v[72:75], a[180:183], v[160:163], v[72:75]
    v_add_f32 v222, v222, v22
    v_add_f32 v223, v223, v23
    s_waitcnt vmcnt(6)
    v_mfma_f32_16x16x32_bf16 v[72:75], a[200:203], v[164:167], v[72:75]
    s_waitcnt lgkmcnt(4)
    v_add_f32 v220, v220, v40
    v_add_f32 v221, v221, v41
    s_waitcnt vmcnt(5)
    v_mfma_f32_16x16x32_bf16 v[72:75], a[220:223], v[168:171], v[72:75]
    v_add_f32 v222, v222, v42
    v_add_f32 v223, v223, v43
    s_waitcnt vmcnt(4)
    v_mfma_f32_16x16x32_bf16 v[72:75], a[240:243], v[172:175], v[72:75]
    s_waitcnt lgkmcnt(3)
    v_add_f32 v224, v224, v24
    v_add_f32 v225, v225, v25
    s_waitcnt vmcnt(3)
    v_mfma_f32_16x16x32_bf16 v[72:75], v[236:239], v[176:179], v[72:75]
    v_add_f32 v226, v226, v26
    v_add_f32 v227, v227, v27
    v_mfma_f32_16x16x32_bf16 v[76:79], a[144:147], v[152:155], v[76:79]
    s_waitcnt lgkmcnt(2)
    v_add_f32 v224, v224, v44
    v_add_f32 v225, v225, v45
    v_mfma_f32_16x16x32_bf16 v[76:79], a[164:167], v[156:159], v[76:79]
    v_add_f32 v226, v226, v46
    v_add_f32 v227, v227, v47
    v_mfma_f32_16x16x32_bf16 v[76:79], a[184:187], v[160:163], v[76:79]
    s_waitcnt lgkmcnt(1)
    v_add_f32 v228, v228, v28
    v_add_f32 v229, v229, v29
    v_mfma_f32_16x16x32_bf16 v[76:79], a[204:207], v[164:167], v[76:79]
    ds_write_b128 v187, v[72:75] offset:0
    v_mfma_f32_16x16x32_bf16 v[76:79], a[224:227], v[168:171], v[76:79]
    v_add_f32 v230, v230, v30
    v_add_f32 v231, v231, v31
    v_mfma_f32_16x16x32_bf16 v[76:79], a[244:247], v[172:175], v[76:79]
    s_waitcnt lgkmcnt(1)
    v_add_f32 v228, v228, v48
    v_add_f32 v229, v229, v49
    v_mfma_f32_16x16x32_bf16 v[76:79], v[240:243], v[176:179], v[76:79]
    v_add_f32 v230, v230, v50
    v_add_f32 v231, v231, v51
    v_mfma_f32_16x16x32_bf16 v[80:83], a[148:151], v[152:155], v[80:83]
    v_fmac_f32 v212, s21, v72
    v_fmac_f32 v213, s21, v73
    v_mfma_f32_16x16x32_bf16 v[80:83], a[168:171], v[156:159], v[80:83]
    v_fmac_f32 v214, s21, v74
    v_fmac_f32 v215, s21, v75
    v_mfma_f32_16x16x32_bf16 v[80:83], a[188:191], v[160:163], v[80:83]
    v_mfma_f32_16x16x32_bf16 v[80:83], a[208:211], v[164:167], v[80:83]
    ds_write_b128 v187, v[76:79] offset:1024
    v_mfma_f32_16x16x32_bf16 v[80:83], a[228:231], v[168:171], v[80:83]
    v_fmac_f32 v216, s21, v76
    v_fmac_f32 v217, s21, v77
    v_mfma_f32_16x16x32_bf16 v[80:83], a[248:251], v[172:175], v[80:83]
    v_fmac_f32 v218, s21, v78
    v_fmac_f32 v219, s21, v79
    v_mfma_f32_16x16x32_bf16 v[80:83], v[244:247], v[176:179], v[80:83]
    v_mfma_f32_16x16x32_bf16 v[84:87], a[152:155], v[152:155], v[84:87]
    v_mfma_f32_16x16x32_bf16 v[84:87], a[172:175], v[156:159], v[84:87]
    s_nop 1
    v_mfma_f32_16x16x32_bf16 v[84:87], a[192:195], v[160:163], v[84:87]
    s_nop 1
    v_mfma_f32_16x16x32_bf16 v[84:87], a[212:215], v[164:167], v[84:87]
    ds_write_b128 v187, v[80:83] offset:2048
    v_mfma_f32_16x16x32_bf16 v[84:87], a[232:235], v[168:171], v[84:87]
    v_fmac_f32 v220, s21, v80
    v_fmac_f32 v221, s21, v81
    v_mfma_f32_16x16x32_bf16 v[84:87], a[252:255], v[172:175], v[84:87]
    v_fmac_f32 v222, s21, v82
    v_fmac_f32 v223, s21, v83
    v_mfma_f32_16x16x32_bf16 v[84:87], v[248:251], v[176:179], v[84:87]
    v_mfma_f32_16x16x32_bf16 v[88:91], a[156:159], v[152:155], v[88:91]
    v_mfma_f32_16x16x32_bf16 v[88:91], a[176:179], v[156:159], v[88:91]
    s_nop 1
    v_mfma_f32_16x16x32_bf16 v[88:91], a[196:199], v[160:163], v[88:91]
    s_nop 1
    v_mfma_f32_16x16x32_bf16 v[88:91], a[216:219], v[164:167], v[88:91]
    ds_write_b128 v187, v[84:87] offset:3072
    v_mfma_f32_16x16x32_bf16 v[88:91], a[236:239], v[168:171], v[88:91]
    v_fmac_f32 v224, s21, v84
    v_fmac_f32 v225, s21, v85
    v_mfma_f32_16x16x32_bf16 v[88:91], v[232:235], v[172:175], v[88:91]
    v_fmac_f32 v226, s21, v86
    v_fmac_f32 v227, s21, v87
    v_mfma_f32_16x16x32_bf16 v[88:91], v[252:255], v[176:179], v[88:91]
    s_nop 7
    ds_write_b128 v187, v[88:91] offset:4096
    v_fmac_f32 v228, s21, v88
    v_fmac_f32 v229, s21, v89
    v_fmac_f32 v230, s21, v90
    v_fmac_f32 v231, s21, v91
    s_waitcnt lgkmcnt(0)
    s_barrier
    ds_read_b128 v[52:55], v190 offset:0
    ds_read_b128 v[56:59], v190 offset:1024
    ds_read_b128 v[60:63], v190 offset:2048
    ds_read_b128 v[64:67], v190 offset:3072
    ds_read_b128 v[68:71], v190 offset:4096
    s_waitcnt lgkmcnt(4)
    v_pk_add_f32 v[212:213], v[212:213], v[52:53]
    v_pk_add_f32 v[214:215], v[214:215], v[54:55]
    v_cvt_pk_bf16_f32 v100, v212, v213
    v_cvt_pk_bf16_f32 v101, v214, v215
    s_waitcnt lgkmcnt(3)
    v_pk_add_f32 v[216:217], v[216:217], v[56:57]
    v_pk_add_f32 v[218:219], v[218:219], v[58:59]
    v_cvt_pk_bf16_f32 v102, v216, v217
    v_cvt_pk_bf16_f32 v103, v218, v219
    buffer_store_dwordx4 v[100:103], v1, s[4:7], s57 offen sc1
    s_waitcnt lgkmcnt(2)
    v_pk_add_f32 v[220:221], v[220:221], v[60:61]
    v_pk_add_f32 v[222:223], v[222:223], v[62:63]
    v_cvt_pk_bf16_f32 v104, v220, v221
    v_cvt_pk_bf16_f32 v105, v222, v223
    s_waitcnt lgkmcnt(1)
    v_pk_add_f32 v[224:225], v[224:225], v[64:65]
    v_pk_add_f32 v[226:227], v[226:227], v[66:67]
    v_cvt_pk_bf16_f32 v106, v224, v225
    v_cvt_pk_bf16_f32 v107, v226, v227
    buffer_store_dwordx4 v[104:107], v1, s[4:7], s58 offen sc1
    s_waitcnt lgkmcnt(0)
    v_pk_add_f32 v[228:229], v[228:229], v[68:69]
    v_pk_add_f32 v[230:231], v[230:231], v[70:71]
    v_cvt_pk_bf16_f32 v108, v228, v229
    v_cvt_pk_bf16_f32 v109, v230, v231
    buffer_store_dwordx2 v[108:109], v4, s[4:7], s56 offen sc1
    v_dot2c_f32_bf16 v112, s60, v100
    v_dot2c_f32_bf16 v113, v100, v100
    v_dot2c_f32_bf16 v112, s60, v101
    v_dot2c_f32_bf16 v113, v101, v101
    v_dot2c_f32_bf16 v112, s60, v102
    v_dot2c_f32_bf16 v113, v102, v102
    v_dot2c_f32_bf16 v112, s60, v103
    v_dot2c_f32_bf16 v113, v103, v103
    v_dot2c_f32_bf16 v112, s60, v104
    v_dot2c_f32_bf16 v113, v104, v104
    v_dot2c_f32_bf16 v112, s60, v105
    v_dot2c_f32_bf16 v113, v105, v105
    v_dot2c_f32_bf16 v112, s60, v106
    v_dot2c_f32_bf16 v113, v106, v106
    v_dot2c_f32_bf16 v112, s60, v107
    v_dot2c_f32_bf16 v113, v107, v107
    v_dot2c_f32_bf16 v112, s60, v108
    v_dot2c_f32_bf16 v113, v108, v108
    v_dot2c_f32_bf16 v112, s60, v109
    v_dot2c_f32_bf16 v113, v109, v109
    s_nop 2
    v_permlane32_swap_b32 v112, v113
    v_add_f32 v112, v112, v113
    v_mov_b32 v113, v112
    s_nop 1
    v_permlane16_swap_b32 v112, v113
    v_add_f32 v112, v112, v113
    buffer_store_dword v112, v114, s[4:7], s59 offen sc1
    s_lshr_b32 s50, s2, 3
    s_lshl_b32 s50, s50, 2
    s_add_u32 s50, s50, s36
    s_lshl_b32 s50, s50, 9
    v_lshl_add_u32 v50, v3, 7, s50
    v_min_u32 v50, CODE_END-PC0-4, v50
    global_load_dword v51, v50, s[94:95] sc1
    s_barrier
    s_mul_i32 s51, s36, 37
    s_mul_i32 s51, s51, 21846
    s_lshr_b32 s51, s51, 16
    s_lshl_b32 s51, s51, 10
    s_mul_i32 s50, s39, 51200
    s_add_u32 s50, s50, s51
    s_add_u32 s50, s50, 38207488
    s_add_u32 s51, s51, 105472
    s_mov_b32 s76, s50
    s_mov_b32 s77, s51
    s_add_u32 m0, s77, 0
    s_add_u32 s61, s76, 0
    buffer_load_dwordx4 v1, s[4:7], s61 offen offset:0 sc1 lds
    buffer_load_dwordx4 v1, s[4:7], s61 offen offset:1024 sc1 lds
    buffer_load_dwordx4 v1, s[4:7], s61 offen offset:2048 sc1 lds
    buffer_load_dwordx4 v1, s[4:7], s61 offen offset:3072 sc1 lds
    s_add_u32 m0, s77, 4096
    s_add_u32 s61, s76, 4096
    buffer_load_dwordx4 v1, s[4:7], s61 offen offset:0 sc1 lds
    buffer_load_dwordx4 v1, s[4:7], s61 offen offset:1024 sc1 lds
    v_and_b32 v48, 7, v0
    v_lshlrev_b32 v48, 12, v48
    v_lshrrev_b32 v49, 3, v0
    v_lshl_add_u32 v48, v49, 28, v48
    v_mov_b32 v49, 1
    s_sub_u32 s69, s88, s4
    s_add_u32 s69, s69, 8
    s_waitcnt vmcnt(7)
    buffer_atomic_add v49, v48, s[4:7], s69 offen sc1
    s_add_u32 m0, s77, 6144
    s_add_u32 s61, s76, 6144
    buffer_load_dwordx4 v1, s[4:7], s61 offen offset:0 sc1 lds
    buffer_load_dwordx4 v1, s[4:7], s61 offen offset:1024 sc1 lds
    buffer_load_dwordx4 v1, s[4:7], s61 offen offset:2048 sc1 lds
    buffer_load_dwordx4 v1, s[4:7], s61 offen offset:3072 sc1 lds
    s_add_u32 m0, s77, 10240
    s_add_u32 s61, s76, 10240
    buffer_load_dwordx4 v1, s[4:7], s61 offen offset:0 sc1 lds
    buffer_load_dwordx4 v1, s[4:7], s61 offen offset:1024 sc1 lds
    buffer_load_dwordx4 v1, s[4:7], s61 offen offset:2048 sc1 lds
    s_lshl_b32 s50, s36, 3
    v_lshrrev_b32 v20, 1, v2
    v_add_u32 v20, s50, v20
    v_lshrrev_b32 v21, 1, v20
    v_cmp_eq_u32 vcc, 1, v20
    v_sub_u32 v22, 32, v21
    v_and_b32 v23, 2, v0
    v_cndmask_b32 v22, v22, 16, vcc
    v_cmp_ne_u32 vcc, 0, v23
    v_and_b32 v20, 1, v0
    v_lshl_add_u32 v23, v3, 8, s41
    v_cndmask_b32 v21, v21, v22, vcc
    v_lshl_add_u32 v21, v20, 5, v21
    v_mul_u32_u24 v22, v21, v23
    v_and_b32 v22, 2047, v22
    v_bfe_i32 v20, v21, 0, 1
    v_and_b32 v20, 0x80008000, v20
    v_cvt_f32_u32 v21, v21
    v_cvt_f32_u32 v22, v22
    v_mul_f32 v21, 0x3c800000, v21
    v_mul_f32 v22, 0x3a000000, v22
    v_fmamk_f32 v23, v21, 0x0, v22
    v_fmamk_f32 v24, v21, 0x40000000, v22
    v_cos_f32 v25, v23
    v_cos_f32 v26, v24
    v_sin_f32 v27, v23
    v_sin_f32 v28, v24
    v_cvt_pk_bf16_f32 v52, v25, v26
    v_cvt_pk_bf16_f32 v60, v27, v28
    v_xor_b32 v54, v20, v52
    v_xor_b32 v62, v20, v60
    v_fmamk_f32 v23, v21, 0x40800000, v22
    v_fmamk_f32 v24, v21, 0x40c00000, v22
    v_cos_f32 v25, v23
    v_cos_f32 v26, v24
    v_sin_f32 v27, v23
    v_sin_f32 v28, v24
    v_cvt_pk_bf16_f32 v53, v25, v26
    v_cvt_pk_bf16_f32 v61, v27, v28
    v_xor_b32 v55, v20, v53
    v_xor_b32 v63, v20, v61
    v_fmamk_f32 v23, v21, 0x3f800000, v22
    v_fmamk_f32 v24, v21, 0x40400000, v22
    v_cos_f32 v25, v23
    v_cos_f32 v26, v24
    v_sin_f32 v27, v23
    v_sin_f32 v28, v24
    v_cvt_pk_bf16_f32 v56, v25, v26
    v_cvt_pk_bf16_f32 v64, v27, v28
    v_xor_b32 v58, v20, v56
    v_xor_b32 v66, v20, v64
    v_fmamk_f32 v23, v21, 0x40a00000, v22
    v_fmamk_f32 v24, v21, 0x40e00000, v22
    v_cos_f32 v25, v23
    v_cos_f32 v26, v24
    v_sin_f32 v27, v23
    v_sin_f32 v28, v24
    v_cvt_pk_bf16_f32 v57, v25, v26
    v_cvt_pk_bf16_f32 v65, v27, v28
    v_xor_b32 v59, v20, v57
    v_xor_b32 v67, v20, v65
    s_mul_i32 s53, s39, 40
    s_add_u32 s53, s53, 40
    v_and_b32 v20, 1, v0
    v_sub_u32 v22, 1, v20
    v_mul_u32_u24 v22, s53, v22
    v_and_b32 v26, 2, v0
    v_cvt_f32_u32 v23, v22
    v_cvt_f32_u32 v26, v26
    v_mul_f32 v26, 0x3e000000, v26
    v_mul_f32 v23, 0x3acccccd, v23
    v_lshlrev_b32 v27, 3, v3
    v_cvt_f32_u32 v27, v27
    v_fma_f32 v24, v23, v27, v26
    v_fmamk_f32 v27, v23, 0x3f800000, v24
    v_fmamk_f32 v28, v23, 0x40000000, v24
    v_fmamk_f32 v29, v23, 0x40400000, v24
    v_fmamk_f32 v30, v23, 0x40800000, v24
    v_fmamk_f32 v31, v23, 0x40a00000, v24
    v_fmamk_f32 v32, v23, 0x40c00000, v24
    v_fmamk_f32 v33, v23, 0x40e00000, v24
    v_cos_f32 v26, v24
    v_cos_f32 v27, v27
    v_cos_f32 v28, v28
    v_cos_f32 v29, v29
    v_cos_f32 v30, v30
    v_cos_f32 v31, v31
    v_cos_f32 v32, v32
    v_cos_f32 v33, v33
    v_cvt_pk_bf16_f32 v68, v26, v27
    v_cvt_pk_bf16_f32 v69, v28, v29
    v_cvt_pk_bf16_f32 v70, v30, v31
    v_cvt_pk_bf16_f32 v71, v32, v33
    v_add_u32 v8, 105472, v1
    s_add_u32 s72, s64, 20512768
    s_add_u32 s74, s65, 23396352
    v_add_u32 v36, s72, v1
    v_add_u32 v37, 10240, v36
    s_load_dword s91, s[92:93], 8 glc
    s_waitcnt lgkmcnt(0)
    s_cmp_ge_u32 s91, 8
    s_cbranch_scc1 POLLX16
    s_mov_b32 s68, 0
POLL15:
    s_load_dword s91, s[92:93], 8 glc
    s_add_u32 s68, s68, 1
    s_waitcnt lgkmcnt(0)
    s_cmp_ge_u32 s91, 8
    s_cbranch_scc1 POLLX16
    s_cmp_lt_u32 s68, 400000
    s_cbranch_scc1 POLL15
POLLX16:
    buffer_load_dwordx4 v[132:135], v36, s[4:7], 0 offen offset:0 sc1
    buffer_load_dwordx4 v[136:139], v37, s[4:7], 0 offen offset:0 sc1
    buffer_load_dwordx4 v[140:143], v36, s[4:7], 0 offen offset:1024 sc1
    buffer_load_dwordx4 v[144:147], v37, s[4:7], 0 offen offset:1024 sc1
    buffer_load_dwordx4 v[148:151], v36, s[4:7], 0 offen offset:2048 sc1
    buffer_load_dwordx4 v[152:155], v37, s[4:7], 0 offen offset:2048 sc1
    buffer_load_dwordx4 v[156:159], v36, s[4:7], 0 offen offset:3072 sc1
    buffer_load_dwordx4 v[160:163], v37, s[4:7], 0 offen offset:3072 sc1
    buffer_load_dword v32, v5, s[4:7], s74 offen offset:0 sc1
    buffer_load_dword v33, v5, s[4:7], s74 offen offset:256 sc1
    buffer_load_dword v34, v5, s[4:7], s74 offen offset:512 sc1
    buffer_load_dword v35, v5, s[4:7], s74 offen offset:768 sc1
    s_waitcnt vmcnt(12)
    s_barrier
    ds_read_b128 v[72:75], v8 offset:0
    ds_read_b128 v[76:79], v8 offset:1024
    ds_read_b128 v[80:83], v8 offset:2048
    ds_read_b128 v[84:87], v8 offset:3072
    ds_read_b128 v[16:19], v8 offset:4096
    ds_read_b128 v[20:23], v8 offset:5120
    s_waitcnt vmcnt(10)
    v_mfma_f32_16x16x32_bf16 v[128:131], v[132:135], v[68:71], 0
    buffer_load_dwordx4 v[164:167], v36, s[4:7], s16 offen offset:0 sc1
    v_mfma_f32_16x16x32_bf16 v[128:131], v[136:139], v[68:71], v[128:131]
    s_waitcnt lgkmcnt(5)
    v_mfma_f32_16x16x32_bf16 v[88:91], v[132:135], v[72:75], 0
    ds_read_b128 v[24:27], v8 offset:6144
    v_mfma_f32_16x16x32_bf16 v[108:111], v[136:139], v[72:75], 0
    s_waitcnt lgkmcnt(5)
    buffer_load_dwordx4 v[168:171], v37, s[4:7], s16 offen offset:0 sc1
    v_mfma_f32_16x16x32_bf16 v[92:95], v[132:135], v[76:79], 0
    ds_read_b128 v[72:75], v8 offset:7168
    v_mfma_f32_16x16x32_bf16 v[112:115], v[136:139], v[76:79], 0
    s_waitcnt lgkmcnt(5)
    v_mfma_f32_16x16x32_bf16 v[96:99], v[132:135], v[80:83], 0
    ds_read_b128 v[76:79], v8 offset:8192
    v_mfma_f32_16x16x32_bf16 v[116:119], v[136:139], v[80:83], 0
    s_waitcnt lgkmcnt(5)
    buffer_load_dwordx4 v[172:175], v36, s[4:7], s16 offen offset:1024 sc1
    v_mfma_f32_16x16x32_bf16 v[100:103], v[132:135], v[84:87], 0
    ds_read_b128 v[80:83], v8 offset:9216
    v_mfma_f32_16x16x32_bf16 v[120:123], v[136:139], v[84:87], 0
    s_waitcnt lgkmcnt(5)
    v_mfma_f32_16x16x32_bf16 v[104:107], v[132:135], v[16:19], 0
    s_waitcnt vmcnt(11)
    ds_read_b128 v[84:87], v8 offset:10240
    v_mfma_f32_16x16x32_bf16 v[124:127], v[136:139], v[16:19], 0
    v_mfma_f32_16x16x32_bf16 v[128:131], v[140:143], v[68:71], v[128:131]
    buffer_load_dwordx4 v[176:179], v37, s[4:7], s16 offen offset:1024 sc1
    v_mfma_f32_16x16x32_bf16 v[128:131], v[144:147], v[68:71], v[128:131]
    s_waitcnt lgkmcnt(5)
    v_mfma_f32_16x16x32_bf16 v[88:91], v[140:143], v[20:23], v[88:91]
    ds_read_b128 v[16:19], v8 offset:11264
    v_mfma_f32_16x16x32_bf16 v[108:111], v[144:147], v[20:23], v[108:111]
    s_waitcnt lgkmcnt(5)
    buffer_load_dwordx4 v[180:183], v36, s[4:7], s16 offen offset:2048 sc1
    v_mfma_f32_16x16x32_bf16 v[92:95], v[140:143], v[24:27], v[92:95]
    ds_read_b128 v[20:23], v8 offset:12288
    v_mfma_f32_16x16x32_bf16 v[112:115], v[144:147], v[24:27], v[112:115]
    s_waitcnt lgkmcnt(5)
    v_mfma_f32_16x16x32_bf16 v[96:99], v[140:143], v[72:75], v[96:99]
    ds_read_b128 v[24:27], v8 offset:13312
    v_mfma_f32_16x16x32_bf16 v[116:119], v[144:147], v[72:75], v[116:119]
    s_waitcnt lgkmcnt(5)
    buffer_load_dwordx4 v[184:187], v37, s[4:7], s16 offen offset:2048 sc1
    v_mfma_f32_16x16x32_bf16 v[100:103], v[140:143], v[76:79], v[100:103]
    ds_read_b128 v[72:75], v8 offset:14336
    v_mfma_f32_16x16x32_bf16 v[120:123], v[144:147], v[76:79], v[120:123]
    s_waitcnt lgkmcnt(5)
    v_mfma_f32_16x16x32_bf16 v[104:107], v[140:143], v[80:83], v[104:107]
    s_waitcnt vmcnt(12)
    ds_read_b128 v[76:79], v8 offset:15360
    v_mfma_f32_16x16x32_bf16 v[124:127], v[144:147], v[80:83], v[124:127]
    v_mfma_f32_16x16x32_bf16 v[128:131], v[148:151], v[68:71], v[128:131]
    buffer_load_dwordx4 v[188:191], v36, s[4:7], s16 offen offset:3072 sc1
    v_mfma_f32_16x16x32_bf16 v[128:131], v[152:155], v[68:71], v[128:131]
    s_waitcnt lgkmcnt(5)
    v_mfma_f32_16x16x32_bf16 v[88:91], v[148:151], v[84:87], v[88:91]
    ds_read_b128 v[80:83], v8 offset:16384
    v_mfma_f32_16x16x32_bf16 v[108:111], v[152:155], v[84:87], v[108:111]
    s_waitcnt lgkmcnt(5)
    buffer_load_dwordx4 v[192:195], v37, s[4:7], s16 offen offset:3072 sc1
    v_mfma_f32_16x16x32_bf16 v[92:95], v[148:151], v[16:19], v[92:95]
    ds_read_b128 v[84:87], v8 offset:17408
    v_mfma_f32_16x16x32_bf16 v[112:115], v[152:155], v[16:19], v[112:115]
    s_waitcnt lgkmcnt(5)
    v_mfma_f32_16x16x32_bf16 v[96:99], v[148:151], v[20:23], v[96:99]
    ds_read_b128 v[16:19], v8 offset:18432
    s_waitcnt vmcnt(10)
    v_add_f32 v32, v32, v33
    v_mfma_f32_16x16x32_bf16 v[116:119], v[152:155], v[20:23], v[116:119]
    s_waitcnt lgkmcnt(5)
    buffer_load_dwordx4 v[196:199], v36, s[4:7], s17 offen offset:0 sc1
    v_mfma_f32_16x16x32_bf16 v[100:103], v[148:151], v[24:27], v[100:103]
    ds_read_b128 v[20:23], v8 offset:19456
    s_waitcnt vmcnt(9)
    v_add_f32 v34, v34, v35
    v_mfma_f32_16x16x32_bf16 v[120:123], v[152:155], v[24:27], v[120:123]
    s_waitcnt lgkmcnt(5)
    v_add_f32 v32, v32, v34
    v_and_b32 v33, 1, v3
    v_mfma_f32_16x16x32_bf16 v[104:107], v[148:151], v[72:75], v[104:107]
    ds_read_b128 v[24:27], v8 offset:20480
    v_cvt_f32_u32 v33, v33
    v_mfma_f32_16x16x32_bf16 v[124:127], v[152:155], v[72:75], v[124:127]
    v_sub_f32 v34, 1.0, v33
    v_mfma_f32_16x16x32_bf16 v[128:131], v[156:159], v[68:71], v[128:131]
    buffer_load_dwordx4 v[200:203], v37, s[4:7], s17 offen offset:0 sc1
    v_mfma_f32_16x16x32_bf16 v[128:131], v[160:163], v[68:71], v[128:131]
    s_waitcnt lgkmcnt(5)
    v_mfma_f32_16x16x32_bf16 v[88:91], v[156:159], v[76:79], v[88:91]
    ds_read_b128 v[72:75], v8 offset:21504
    v_mfma_f32_16x16x32_bf16 v[108:111], v[160:163], v[76:79], v[108:111]
    s_waitcnt lgkmcnt(5)
    buffer_load_dwordx4 v[204:207], v36, s[4:7], s17 offen offset:1024 sc1
    v_mfma_f32_16x16x32_bf16 v[92:95], v[156:159], v[80:83], v[92:95]
    ds_read_b128 v[76:79], v8 offset:22528
    v_mfma_f32_16x16x32_bf16 v[112:115], v[160:163], v[80:83], v[112:115]
    s_waitcnt lgkmcnt(5)
    v_mfma_f32_16x16x32_bf16 v[96:99], v[156:159], v[84:87], v[96:99]
    ds_read_b128 v[80:83], v8 offset:23552
    v_mfma_f32_16x16x32_bf16 v[116:119], v[160:163], v[84:87], v[116:119]
    s_waitcnt lgkmcnt(5)
    buffer_load_dwordx4 v[208:211], v37, s[4:7], s17 offen offset:1024 sc1
    v_mfma_f32_16x16x32_bf16 v[100:103], v[156:159], v[16:19], v[100:103]
    ds_read_b128 v[84:87], v8 offset:24576
    v_mfma_f32_16x16x32_bf16 v[120:123], v[160:163], v[16:19], v[120:123]
    s_waitcnt lgkmcnt(5)
    v_mfma_f32_16x16x32_bf16 v[104:107], v[156:159], v[20:23], v[104:107]
    s_waitcnt vmcnt(10)
    ds_read_b128 v[16:19], v8 offset:25600
    v_mfma_f32_16x16x32_bf16 v[124:127], v[160:163], v[20:23], v[124:127]
    v_mfma_f32_16x16x4_f32 v[40:43], v32, v34, 0
    v_mfma_f32_16x16x4_f32 v[44:47], v32, v33, 0
    v_mfma_f32_16x16x32_bf16 v[128:131], v[164:167], v[68:71], v[128:131]
    s_and_b32 s50, s36, 1
    v_and_b32 v29, 1, v0
    v_cvt_f32_u32 v29, v29
    v_mfma_f32_16x16x32_bf16 v[128:131], v[168:171], v[68:71], v[128:131]
    s_waitcnt lgkmcnt(5)
    v_fma_f32 v29, v29, -2.0, 1.0
    s_lshl_b32 s50, s50, 3
    v_mfma_f32_16x16x32_bf16 v[88:91], v[164:167], v[24:27], v[88:91]
    ds_read_b128 v[20:23], v8 offset:26624
    s_lshr_b32 s51, s36, 1
    v_mfma_f32_16x16x32_bf16 v[108:111], v[168:171], v[24:27], v[108:111]
    s_waitcnt lgkmcnt(5)
    s_lshl_b32 s51, s51, 10
    s_add_u32 s50, s50, s51
    v_mfma_f32_16x16x32_bf16 v[92:95], v[164:167], v[72:75], v[92:95]
    ds_read_b128 v[24:27], v8 offset:27648
    v_add_u32 v10, 93184, v1
    v_mfma_f32_16x16x32_bf16 v[112:115], v[168:171], v[72:75], v[112:115]
    s_waitcnt lgkmcnt(5)
    v_add_u32 v9, s50, v10
    s_lshl_b32 s50, s40, 3
    v_mfma_f32_16x16x32_bf16 v[96:99], v[164:167], v[76:79], v[96:99]
    ds_read_b128 v[72:75], v8 offset:28672
    s_add_u32 s50, s50, s39
    v_mfma_f32_16x16x32_bf16 v[116:119], v[168:171], v[76:79], v[116:119]
    s_waitcnt lgkmcnt(5)
    s_mul_i32 s50, s50, 12288
    s_lshl_b32 s51, s36, 10
    v_mfma_f32_16x16x32_bf16 v[100:103], v[164:167], v[80:83], v[100:103]
    ds_read_b128 v[76:79], v8 offset:29696
    s_add_u32 s50, s50, s51
    v_mfma_f32_16x16x32_bf16 v[120:123], v[168:171], v[80:83], v[120:123]
    s_waitcnt lgkmcnt(5)
    s_add_u32 s70, s50, 12124160
    s_add_u32 s60, s70, 4096
    v_mfma_f32_16x16x32_bf16 v[104:107], v[164:167], v[84:87], v[104:107]
    s_waitcnt vmcnt(8)
    ds_read_b128 v[80:83], v8 offset:30720
    s_add_u32 s61, s70, 8192
    v_mfma_f32_16x16x32_bf16 v[124:127], v[168:171], v[84:87], v[124:127]
    v_lshlrev_b32 v12, 6, v2
    v_lshl_add_u32 v12, v3, 4, v12
    v_mfma_f32_16x16x32_bf16 v[128:131], v[172:175], v[68:71], v[128:131]
    v_mul_f32 v40, 0x3acccccd, v40
    v_mul_f32 v41, 0x3acccccd, v41
    v_mfma_f32_16x16x32_bf16 v[128:131], v[176:179], v[68:71], v[128:131]
    s_waitcnt lgkmcnt(5)
    v_mul_f32 v42, 0x3acccccd, v42
    v_mul_f32 v43, 0x3acccccd, v43
    v_mfma_f32_16x16x32_bf16 v[88:91], v[172:175], v[16:19], v[88:91]
    ds_read_b128 v[84:87], v8 offset:31744
    v_mul_f32 v44, 0x3acccccd, v44
    v_mfma_f32_16x16x32_bf16 v[108:111], v[176:179], v[16:19], v[108:111]
    s_waitcnt lgkmcnt(5)
    v_mul_f32 v45, 0x3acccccd, v45
    v_mul_f32 v46, 0x3acccccd, v46
    v_mfma_f32_16x16x32_bf16 v[92:95], v[172:175], v[20:23], v[92:95]
    ds_read_b128 v[16:19], v8 offset:32768
    v_mul_f32 v47, 0x3acccccd, v47
    v_mfma_f32_16x16x32_bf16 v[112:115], v[176:179], v[20:23], v[112:115]
    s_waitcnt lgkmcnt(5)
    v_fma_f32 v44, -v40, v40, v44
    v_fma_f32 v45, -v41, v41, v45
    v_mfma_f32_16x16x32_bf16 v[96:99], v[172:175], v[24:27], v[96:99]
    ds_read_b128 v[20:23], v8 offset:33792
    v_fma_f32 v46, -v42, v42, v46
    v_mfma_f32_16x16x32_bf16 v[116:119], v[176:179], v[24:27], v[116:119]
    s_waitcnt lgkmcnt(5)
    v_fma_f32 v47, -v43, v43, v47
    v_max_f32 v44, 0, v44
    v_mfma_f32_16x16x32_bf16 v[100:103], v[172:175], v[72:75], v[100:103]
    ds_read_b128 v[24:27], v8 offset:34816
    v_max_f32 v45, 0, v45
    v_mfma_f32_16x16x32_bf16 v[120:123], v[176:179], v[72:75], v[120:123]
    s_waitcnt lgkmcnt(5)
    v_max_f32 v46, 0, v46
    v_max_f32 v47, 0, v47
    v_mfma_f32_16x16x32_bf16 v[104:107], v[172:175], v[76:79], v[104:107]
    s_waitcnt vmcnt(6)
    ds_read_b128 v[72:75], v8 offset:39936
    v_add_f32 v44, 0x3727c5ac, v44
    v_mfma_f32_16x16x32_bf16 v[124:127], v[176:179], v[76:79], v[124:127]
    v_rsq_f32 v44, v44
    v_mfma_f32_16x16x32_bf16 v[128:131], v[180:183], v[68:71], v[128:131]
    v_add_f32 v45, 0x3727c5ac, v45
    v_add_f32 v46, 0x3727c5ac, v46
    v_mfma_f32_16x16x32_bf16 v[128:131], v[184:187], v[68:71], v[128:131]
    s_waitcnt lgkmcnt(5)
    v_rsq_f32 v45, v45
    v_mfma_f32_16x16x32_bf16 v[88:91], v[180:183], v[80:83], v[88:91]
    ds_read_b128 v[76:79], v8 offset:45056
    v_add_f32 v47, 0x3727c5ac, v47
    v_mfma_f32_16x16x32_bf16 v[108:111], v[184:187], v[80:83], v[108:111]
    s_waitcnt lgkmcnt(5)
    v_rsq_f32 v46, v46
    v_mfma_f32_16x16x32_bf16 v[92:95], v[180:183], v[84:87], v[92:95]
    ds_read_b128 v[80:83], v8 offset:50176
    v_mfma_f32_16x16x32_bf16 v[112:115], v[184:187], v[84:87], v[112:115]
    s_waitcnt lgkmcnt(5)
    v_rsq_f32 v47, v47
    v_mfma_f32_16x16x32_bf16 v[96:99], v[180:183], v[16:19], v[96:99]
    ds_read_b128 v[84:87], v8 offset:35840
    v_mfma_f32_16x16x32_bf16 v[116:119], v[184:187], v[16:19], v[116:119]
    s_waitcnt lgkmcnt(5)
    v_mfma_f32_16x16x32_bf16 v[100:103], v[180:183], v[20:23], v[100:103]
    ds_read_b128 v[16:19], v8 offset:40960
    v_mfma_f32_16x16x32_bf16 v[120:123], v[184:187], v[20:23], v[120:123]
    s_waitcnt lgkmcnt(5)
    v_mfma_f32_16x16x32_bf16 v[104:107], v[180:183], v[24:27], v[104:107]
    s_waitcnt vmcnt(4)
    ds_read_b128 v[20:23], v8 offset:46080
    v_mfma_f32_16x16x32_bf16 v[124:127], v[184:187], v[24:27], v[124:127]
    v_mfma_f32_16x16x32_bf16 v[128:131], v[188:191], v[68:71], v[128:131]
    s_waitcnt vmcnt(2)
    v_mfma_f32_16x16x32_bf16 v[128:131], v[192:195], v[68:71], v[128:131]
    v_mfma_f32_16x16x32_bf16 v[128:131], v[196:199], v[68:71], v[128:131]
    s_waitcnt vmcnt(0)
    v_mfma_f32_16x16x32_bf16 v[128:131], v[200:203], v[68:71], v[128:131]
    v_mfma_f32_16x16x32_bf16 v[128:131], v[204:207], v[68:71], v[128:131]
    v_mfma_f32_16x16x32_bf16 v[128:131], v[208:211], v[68:71], v[128:131]
    s_waitcnt lgkmcnt(5)
    v_mfma_f32_16x16x32_bf16 v[104:107], v[188:191], v[72:75], v[104:107]
    ds_read_b128 v[24:27], v8 offset:36864
    v_mfma_f32_16x16x32_bf16 v[124:127], v[192:195], v[72:75], v[124:127]
    s_waitcnt lgkmcnt(5)
    v_mfma_f32_16x16x32_bf16 v[104:107], v[196:199], v[76:79], v[104:107]
    ds_read_b128 v[72:75], v8 offset:41984
    s_nop 0
    v_mul_f32 v128, v128, v44
    v_mfma_f32_16x16x32_bf16 v[124:127], v[200:203], v[76:79], v[124:127]
    s_waitcnt lgkmcnt(5)
    v_mul_f32 v129, v129, v45
    v_mul_f32 v130, v130, v46
    v_mfma_f32_16x16x32_bf16 v[104:107], v[204:207], v[80:83], v[104:107]
    ds_read_b128 v[76:79], v8 offset:47104
    v_mul_f32 v131, v131, v47
    v_mfma_f32_16x16x32_bf16 v[124:127], v[208:211], v[80:83], v[124:127]
    s_waitcnt lgkmcnt(5)
    v_cvt_pk_bf16_f32 v128, v128, v129
    v_cvt_pk_bf16_f32 v129, v130, v131
    v_mfma_f32_16x16x32_bf16 v[88:91], v[188:191], v[84:87], v[88:91]
    ds_read_b128 v[80:83], v8 offset:37888
    v_mfma_f32_16x16x32_bf16 v[108:111], v[192:195], v[84:87], v[108:111]
    s_waitcnt lgkmcnt(5)
    ds_write_b64 v9, v[128:129] offset:10240
    v_mfma_f32_16x16x32_bf16 v[88:91], v[196:199], v[16:19], v[88:91]
    ds_read_b128 v[84:87], v8 offset:43008
    v_fmac_f32 v104, v29, v124
    v_mfma_f32_16x16x32_bf16 v[108:111], v[200:203], v[16:19], v[108:111]
    s_waitcnt lgkmcnt(6)
    v_fmac_f32 v105, v29, v125
    v_fmac_f32 v106, v29, v126
    v_mfma_f32_16x16x32_bf16 v[88:91], v[204:207], v[20:23], v[88:91]
    ds_read_b128 v[16:19], v8 offset:48128
    v_fmac_f32 v107, v29, v127
    v_mfma_f32_16x16x32_bf16 v[108:111], v[208:211], v[20:23], v[108:111]
    s_waitcnt lgkmcnt(6)
    v_mul_f32 v104, v104, v44
    v_mul_f32 v105, v105, v45
    v_mfma_f32_16x16x32_bf16 v[92:95], v[188:191], v[24:27], v[92:95]
    ds_read_b128 v[20:23], v8 offset:38912
    v_mul_f32 v106, v106, v46
    v_mfma_f32_16x16x32_bf16 v[112:115], v[192:195], v[24:27], v[112:115]
    s_waitcnt lgkmcnt(6)
    v_mul_f32 v107, v107, v47
    v_cvt_pk_bf16_f32 v104, v104, v105
    v_mfma_f32_16x16x32_bf16 v[92:95], v[196:199], v[72:75], v[92:95]
    ds_read_b128 v[24:27], v8 offset:44032
    v_cvt_pk_bf16_f32 v105, v106, v107
    v_mfma_f32_16x16x32_bf16 v[112:115], v[200:203], v[72:75], v[112:115]
    s_waitcnt lgkmcnt(6)
    ds_write_b64 v9, v[104:105] offset:8192
    v_mfma_f32_16x16x32_bf16 v[92:95], v[204:207], v[76:79], v[92:95]
    ds_read_b128 v[72:75], v8 offset:49152
    v_fmac_f32 v88, v29, v108
    v_mfma_f32_16x16x32_bf16 v[112:115], v[208:211], v[76:79], v[112:115]
    s_waitcnt lgkmcnt(7)
    v_fmac_f32 v89, v29, v109
    v_fmac_f32 v90, v29, v110
    v_mfma_f32_16x16x32_bf16 v[96:99], v[188:191], v[80:83], v[96:99]
    v_fmac_f32 v91, v29, v111
    v_mul_f32 v88, v88, v44
    v_mfma_f32_16x16x32_bf16 v[116:119], v[192:195], v[80:83], v[116:119]
    s_waitcnt lgkmcnt(5)
    s_waitcnt lgkmcnt(1)
    s_barrier
    ds_read_b128 v[164:167], v10 offset:8192
    v_mfma_f32_16x16x32_bf16 v[96:99], v[196:199], v[84:87], v[96:99]
    ds_read_b128 v[168:171], v10 offset:9216
    v_mul_f32 v89, v89, v45
    v_mfma_f32_16x16x32_bf16 v[116:119], v[200:203], v[84:87], v[116:119]
    ds_read_b128 v[172:175], v10 offset:10240
    v_mul_f32 v90, v90, v46
    v_mfma_f32_16x16x32_bf16 v[96:99], v[204:207], v[16:19], v[96:99]
    ds_read_b128 v[176:179], v10 offset:11264
    v_mul_f32 v91, v91, v47
    v_mfma_f32_16x16x32_bf16 v[116:119], v[208:211], v[16:19], v[116:119]
    v_cvt_pk_bf16_f32 v88, v88, v89
    v_cvt_pk_bf16_f32 v89, v90, v91
    v_mfma_f32_16x16x32_bf16 v[100:103], v[188:191], v[20:23], v[100:103]
    ds_write_b64 v9, v[88:89] offset:0
    v_mfma_f32_16x16x32_bf16 v[120:123], v[192:195], v[20:23], v[120:123]
    v_fmac_f32 v92, v29, v112
    v_fmac_f32 v93, v29, v113
    v_mfma_f32_16x16x32_bf16 v[100:103], v[196:199], v[24:27], v[100:103]
    v_fmac_f32 v94, v29, v114
    v_fmac_f32 v95, v29, v115
    v_mfma_f32_16x16x32_bf16 v[120:123], v[200:203], v[24:27], v[120:123]
    s_waitcnt lgkmcnt(5)
    v_mul_f32 v92, v92, v44
    v_mul_f32 v93, v93, v45
    v_mfma_f32_16x16x32_bf16 v[100:103], v[204:207], v[72:75], v[100:103]
    v_mul_f32 v94, v94, v46
    v_mul_f32 v95, v95, v47
    v_mfma_f32_16x16x32_bf16 v[120:123], v[208:211], v[72:75], v[120:123]
    v_cvt_pk_bf16_f32 v92, v92, v93
    v_cvt_pk_bf16_f32 v93, v94, v95
    s_waitcnt lgkmcnt(4)
    v_mfma_f32_16x16x32_bf16 v[180:183], v[164:167], v[52:55], 0
    ds_write_b64 v9, v[92:93] offset:2048
    v_mfma_f32_16x16x32_bf16 v[184:187], v[164:167], v[60:63], 0
    v_fmac_f32 v96, v29, v116
    v_fmac_f32 v97, v29, v117
    s_waitcnt lgkmcnt(4)
    v_mfma_f32_16x16x32_bf16 v[180:183], v[168:171], v[56:59], v[180:183]
    v_fmac_f32 v98, v29, v118
    v_fmac_f32 v99, v29, v119
    v_mfma_f32_16x16x32_bf16 v[184:187], v[168:171], v[64:67], v[184:187]
    v_mul_f32 v96, v96, v44
    v_mul_f32 v97, v97, v45
    s_waitcnt lgkmcnt(3)
    v_mfma_f32_16x16x32_bf16 v[188:191], v[172:175], v[52:55], 0
    s_waitcnt lgkmcnt(0)
    s_barrier
    ds_read_b128 v[132:135], v10 offset:0
    v_mfma_f32_16x16x32_bf16 v[192:195], v[172:175], v[60:63], 0
    ds_read_b128 v[136:139], v10 offset:1024
    v_mul_f32 v98, v98, v46
    v_mfma_f32_16x16x32_bf16 v[188:191], v[176:179], v[56:59], v[188:191]
    ds_read_b128 v[140:143], v10 offset:2048
    v_mul_f32 v99, v99, v47
    v_mfma_f32_16x16x32_bf16 v[192:195], v[176:179], v[64:67], v[192:195]
    ds_read_b128 v[144:147], v10 offset:3072
    v_cvt_pk_bf16_f32 v96, v96, v97
    s_waitcnt lgkmcnt(3)
    v_mfma_f32_16x16x32_bf16 v[196:199], v[132:135], v[52:55], 0
    v_cvt_pk_bf16_f32 v97, v98, v99
    v_fmac_f32 v100, v29, v120
    v_mfma_f32_16x16x32_bf16 v[200:203], v[132:135], v[60:63], 0
    ds_write_b64 v9, v[96:97] offset:4096
    s_waitcnt lgkmcnt(3)
    v_mfma_f32_16x16x32_bf16 v[196:199], v[136:139], v[56:59], v[196:199]
    v_fmac_f32 v101, v29, v121
    v_fmac_f32 v102, v29, v122
    v_mfma_f32_16x16x32_bf16 v[200:203], v[136:139], v[64:67], v[200:203]
    v_fmac_f32 v103, v29, v123
    v_mul_f32 v100, v100, v44
    s_waitcnt lgkmcnt(2)
    v_mfma_f32_16x16x32_bf16 v[204:207], v[140:143], v[52:55], 0
    v_mul_f32 v101, v101, v45
    v_mul_f32 v102, v102, v46
    v_mfma_f32_16x16x32_bf16 v[208:211], v[140:143], v[60:63], 0
    v_mul_f32 v103, v103, v47
    v_cvt_pk_bf16_f32 v100, v100, v101
    s_waitcnt lgkmcnt(1)
    v_mfma_f32_16x16x32_bf16 v[204:207], v[144:147], v[56:59], v[204:207]
    v_cvt_pk_bf16_f32 v101, v102, v103
    v_mfma_f32_16x16x32_bf16 v[208:211], v[144:147], v[64:67], v[208:211]
    ds_write_b64 v9, v[100:101] offset:6144
    v_pk_add_f32 v[180:181], v[180:181], v[186:187]
    v_pk_add_f32 v[182:183], v[182:183], v[184:185] neg_lo:[0,1] neg_hi:[0,1]
    v_cvt_pk_bf16_f32 v24, v180, v182
    v_cvt_pk_bf16_f32 v25, v181, v183
    v_pk_add_f32 v[188:189], v[188:189], v[194:195]
    v_pk_add_f32 v[190:191], v[190:191], v[192:193] neg_lo:[0,1] neg_hi:[0,1]
    v_cvt_pk_bf16_f32 v26, v188, v190
    v_cvt_pk_bf16_f32 v27, v189, v191
    buffer_store_dwordx4 v[24:27], v12, s[4:7], s61 offen sc1
    s_waitcnt lgkmcnt(0)
    s_barrier
    ds_read_b128 v[148:151], v10 offset:4096
    ds_read_b128 v[152:155], v10 offset:5120
    ds_read_b128 v[156:159], v10 offset:6144
    ds_read_b128 v[160:163], v10 offset:7168
    v_pk_add_f32 v[196:197], v[196:197], v[202:203]
    v_pk_add_f32 v[198:199], v[198:199], v[200:201] neg_lo:[0,1] neg_hi:[0,1]
    v_cvt_pk_bf16_f32 v16, v196, v198
    v_cvt_pk_bf16_f32 v17, v197, v199
    v_pk_add_f32 v[204:205], v[204:205], v[210:211]
    v_pk_add_f32 v[206:207], v[206:207], v[208:209] neg_lo:[0,1] neg_hi:[0,1]
    v_cvt_pk_bf16_f32 v18, v204, v206
    v_cvt_pk_bf16_f32 v19, v205, v207
    buffer_store_dwordx4 v[16:19], v12, s[4:7], s70 offen sc1
    s_waitcnt lgkmcnt(3)
    v_mfma_f32_16x16x32_bf16 v[88:91], v[148:151], v[52:55], 0
    v_mfma_f32_16x16x32_bf16 v[92:95], v[148:151], v[60:63], 0
    s_waitcnt lgkmcnt(2)
    v_mfma_f32_16x16x32_bf16 v[88:91], v[152:155], v[56:59], v[88:91]
    v_mfma_f32_16x16x32_bf16 v[92:95], v[152:155], v[64:67], v[92:95]
    s_waitcnt lgkmcnt(1)
    v_mfma_f32_16x16x32_bf16 v[108:111], v[156:159], v[52:55], 0
    s_nop 1
    v_mfma_f32_16x16x32_bf16 v[112:115], v[156:159], v[60:63], 0
    s_waitcnt lgkmcnt(0)
    v_mfma_f32_16x16x32_bf16 v[108:111], v[160:163], v[56:59], v[108:111]
    s_nop 0
    v_add_f32 v88, v88, v94
    v_sub_f32 v90, v90, v92
    v_mfma_f32_16x16x32_bf16 v[112:115], v[160:163], v[64:67], v[112:115]
    v_add_f32 v89, v89, v95
    v_sub_f32 v91, v91, v93
    v_cvt_pk_bf16_f32 v20, v88, v90
    v_cvt_pk_bf16_f32 v21, v89, v91
    s_nop 3
    v_pk_add_f32 v[108:109], v[108:109], v[114:115]
    v_pk_add_f32 v[110:111], v[110:111], v[112:113] neg_lo:[0,1] neg_hi:[0,1]
    v_cvt_pk_bf16_f32 v22, v108, v110
    v_cvt_pk_bf16_f32 v23, v109, v111
    buffer_store_dwordx4 v[20:23], v12, s[4:7], s60 offen sc1
    s_mul_i32 s76, s42, 143360
    s_add_u32 s76, s76, 2097152
    s_mul_i32 s77, s36, 12288
    s_add_u32 s77, s77, 93184
    s_add_u32 s76, s76, s77
    v_and_b32 v28, 3, v0
    v_bfe_u32 v29, v0, 2, 1
    v_lshlrev_b32 v28, 15, v28
    v_lshl_add_u32 v28, v29, 9, v28
    v_lshrrev_b32 v29, 3, v0
    v_lshl_add_u32 v28, v29, 28, v28
    v_mov_b32 v29, 1
    s_sub_u32 s69, s82, s4
    s_add_u32 s69, s69, 131080
    s_and_b32 s50, s36, 1
    s_lshl_b32 s50, s50, 4
    v_add_u32 v104, s50, v2
    s_lshr_b32 s54, s36, 1
    s_or_b32 s51, s54, s41
    s_cmp_eq_u32 s51, 0
    s_cselect_b32 s51, 32, 31
    v_sub_u32 v105, s51, v104
    v_cvt_f32_u32 v104, v104
    v_cvt_f32_u32 v105, v105
    v_cvt_f32_u32 v106, v3
    v_mul_f32 v104, 0x3d000000, v104
    v_mul_f32 v105, 0x3d000000, v105
    v_add_f32 v106, v106, v106
    v_cmp_eq_u32 vcc, 0, v3
    v_mul_f32 v107, v104, v106
    v_mul_f32 v108, v105, v106
    v_fmamk_f32 v109, v104, 0x0, v107
    v_fmamk_f32 v110, v104, 0x3f800000, v107
    v_fmamk_f32 v111, v104, 0x41000000, v107
    v_fmamk_f32 v112, v104, 0x41100000, v107
    v_mul_f32 v121, 0x41800000, v104
    v_cos_f32 v113, v109
    v_sin_f32 v117, v109
    v_cos_f32 v114, v110
    v_sin_f32 v118, v110
    v_cos_f32 v115, v111
    v_sin_f32 v119, v111
    v_cos_f32 v116, v112
    v_sin_f32 v120, v112
    v_cos_f32 v121, v121
    v_cvt_pk_bf16_f32 v40, v113, v117
    v_cvt_pk_bf16_f32 v42, v114, v118
    v_cvt_pk_bf16_f32 v44, v115, v119
    v_cvt_pk_bf16_f32 v46, v116, v120
    v_cndmask_b32 v113, v113, v121, vcc
    v_cvt_pk_bf16_f32 v41, v113, -v117
    v_cvt_pk_bf16_f32 v43, v114, -v118
    v_cvt_pk_bf16_f32 v45, v115, -v119
    v_cvt_pk_bf16_f32 v47, v116, -v120
    v_fmamk_f32 v109, v105, 0x0, v108
    v_fmamk_f32 v110, v105, 0x3f800000, v108
    v_fmamk_f32 v111, v105, 0x41000000, v108
    v_fmamk_f32 v112, v105, 0x41100000, v108
    v_mul_f32 v121, 0x41800000, v105
    v_cos_f32 v113, v109
    v_sin_f32 v117, v109
    v_cos_f32 v114, v110
    v_sin_f32 v118, v110
    v_cos_f32 v115, v111
    v_sin_f32 v119, v111
    v_cos_f32 v116, v112
    v_sin_f32 v120, v112
    v_cos_f32 v121, v121
    v_cvt_pk_bf16_f32 v48, v113, v117
    v_cvt_pk_bf16_f32 v50, v114, v118
    v_cvt_pk_bf16_f32 v52, v115, v119
    v_cvt_pk_bf16_f32 v54, v116, v120
    v_cndmask_b32 v113, v113, v121, vcc
    v_cvt_pk_bf16_f32 v49, v113, -v117
    v_cvt_pk_bf16_f32 v51, v114, -v118
    s_waitcnt vmcnt(0)
    buffer_atomic_add v29, v28, s[4:7], s69 offen sc1
    v_cvt_pk_bf16_f32 v53, v115, -v119
    v_cvt_pk_bf16_f32 v55, v116, -v120
    v_mul_u32_u24 v104, 98304, v3
    s_mul_i32 s50, s36, 786432
    s_mul_i32 s51, s39, 12288
    s_add_u32 s50, s50, s51
    s_lshr_b32 s51, s40, 1
    s_lshl_b32 s51, s51, 8
    s_add_u32 s50, s50, s51
    s_add_u32 s70, s50, 12124160
    s_mul_i32 s71, s36, 6144
    v_xor_b32 v105, 0, v2
    v_lshl_add_u32 v100, v105, 4, v104
    v_xor_b32 v105, 4, v2
    v_lshl_add_u32 v101, v105, 4, v104
    v_xor_b32 v105, 1, v2
    v_lshl_add_u32 v102, v105, 4, v104
    v_xor_b32 v105, 5, v2
    v_lshl_add_u32 v103, v105, 4, v104
    s_and_b32 s50, s40, 1
    s_xor_b32 s51, s50, 1
    s_cmp_lt_u32 s40, 2
    s_cselect_b32 s51, s50, s51
    s_xor_b32 s52, s54, 1
    s_cmp_eq_u32 s40, 0
    s_cselect_b32 s52, s54, s52
    s_lshl_b32 s50, s50, 7
    s_lshl_b32 s55, s54, 6
    s_add_u32 s50, s50, s55
    s_lshl_b32 s51, s51, 7
    s_lshl_b32 s52, s52, 6
    s_add_u32 s51, s51, s52
    v_lshrrev_b32 v104, 1, v3
    v_mul_u32_u24 v104, 6144, v104
    v_and_b32 v105, 1, v3
    v_lshl_add_u32 v104, v105, 10, v104
    v_add_u32 v104, 132096, v104
    v_lshlrev_b32 v105, 6, v105
    v_xor_b32 v106, s50, v105
    v_xor_b32 v107, s51, v105
    v_add_u32 v106, v106, v104
    v_add_u32 v107, v107, v104
    v_and_b32 v108, 12, v2
    v_add_u32 v108, v108, v2
    v_mov_b32 v109, v108
    v_lshrrev_b32 v110, 4, v109
    v_and_b32 v111, 15, v109
    v_lshl_add_u32 v30, v110, 11, v106
    v_and_b32 v110, 1, v110
    v_lshlrev_b32 v110, 2, v110
    v_xor_b32 v111, v111, v110
    v_lshl_add_u32 v30, v111, 2, v30
    v_xor_b32 v31, 16, v30
    v_sub_u32 v109, 40, v108
    v_cmp_lt_u32 vcc, 31, v109
    v_and_b32 v110, 6, v109
    v_add_u32 v110, v110, v109
    v_cndmask_b32 v109, v109, v110, vcc
    v_cmp_eq_u32 vcc, 0, v2
    v_nop
    v_nop
    v_cndmask_b32 v109, v109, 34, vcc
    v_lshrrev_b32 v110, 4, v109
    v_and_b32 v111, 15, v109
    v_lshl_add_u32 v32, v110, 11, v107
    v_and_b32 v110, 1, v110
    v_lshlrev_b32 v110, 2, v110
    v_xor_b32 v111, v111, v110
    v_lshl_add_u32 v32, v111, 2, v32
    v_sub_u32 v109, 36, v108
    v_cmp_lt_u32 vcc, 31, v109
    v_and_b32 v110, 6, v109
    v_add_u32 v110, v110, v109
    v_cndmask_b32 v109, v109, v110, vcc
    v_lshrrev_b32 v110, 4, v109
    v_and_b32 v111, 15, v109
    v_lshl_add_u32 v33, v110, 11, v107
    v_and_b32 v110, 1, v110
    v_lshlrev_b32 v110, 2, v110
    v_xor_b32 v111, v111, v110
    v_lshl_add_u32 v33, v111, 2, v33
    v_cmp_gt_u32 vcc, 8, v2
    v_and_b32 v110, 6, v2
    v_add3_u32 v110, v110, v2, 32
    v_sub_u32 v109, 16, v2
    v_cndmask_b32 v109, v109, v110, vcc
    v_cndmask_b32 v112, v107, v106, vcc
    v_lshrrev_b32 v110, 4, v109
    v_and_b32 v111, 15, v109
    v_lshl_add_u32 v34, v110, 11, v112
    v_and_b32 v110, 1, v110
    v_lshlrev_b32 v110, 2, v110
    v_xor_b32 v111, v111, v110
    v_lshl_add_u32 v34, v111, 2, v34
    s_add_u32 s56, s64, 17891328
    s_mul_i32 s59, s39, 1280
    s_add_u32 s57, s56, s59
    s_sub_u32 s58, s56, s59
    s_add_u32 s58, s58, 19200
    s_lshl_b32 s59, s39, 7
    s_add_u32 s59, s59, s65
    s_add_u32 s59, s59, 23265216
    s_mov_b32 s60, 0x3f803f80
    s_load_dword s91, s[92:93], 131080 glc
    v_mov_b32 v24, 0
    v_mov_b32 v25, 0
    v_subrev_u32 v26, 16, v0
    v_lshrrev_b32 v27, 5, v26
    v_min_u32 v27, 1, v27
    v_lshlrev_b32 v27, 28, v27
    v_add_u32 v26, v27, v5
    s_waitcnt lgkmcnt(0)
    s_cmp_ge_u32 s91, 8
    s_cbranch_scc1 POLLX18
    s_mov_b32 s68, 0
POLL17:
    s_load_dword s91, s[92:93], 131080 glc
    s_add_u32 s68, s68, 1
    s_waitcnt lgkmcnt(0)
    s_cmp_ge_u32 s91, 8
    s_cbranch_scc1 POLLX18
    s_cmp_lt_u32 s68, 400000
    s_cbranch_scc1 POLL17
POLLX18:
    s_add_u32 m0, s71, 132096
    s_add_u32 s50, s70, 0
    buffer_load_dwordx4 v100, s[4:7], s50 offen sc1 lds
    s_add_u32 m0, s71, 133120
    s_add_u32 s50, s70, 393216
    buffer_load_dwordx4 v101, s[4:7], s50 offen sc1 lds
    s_add_u32 m0, s71, 134144
    s_add_u32 s50, s70, 4096
    buffer_load_dwordx4 v102, s[4:7], s50 offen sc1 lds
    s_add_u32 m0, s71, 135168
    s_add_u32 s50, s70, 397312
    buffer_load_dwordx4 v103, s[4:7], s50 offen sc1 lds
    s_add_u32 m0, s71, 136192
    s_add_u32 s50, s70, 8192
    buffer_load_dwordx4 v100, s[4:7], s50 offen sc1 lds
    s_add_u32 m0, s71, 137216
    s_add_u32 s50, s70, 401408
    buffer_load_dwordx4 v101, s[4:7], s50 offen sc1 lds
    s_waitcnt vmcnt(0)
    s_barrier
    ds_read2st64_b32 v[60:61], v30 offset0:0 offset1:1
    ds_read2st64_b32 v[62:63], v30 offset0:2 offset1:3
    ds_read2st64_b32 v[64:65], v30 offset0:48 offset1:49
    ds_read2st64_b32 v[66:67], v30 offset0:50 offset1:51
    ds_read2st64_b32 v[68:69], v31 offset0:0 offset1:1
    ds_read2st64_b32 v[70:71], v31 offset0:2 offset1:3
    ds_read2st64_b32 v[72:73], v31 offset0:48 offset1:49
    ds_read2st64_b32 v[74:75], v31 offset0:50 offset1:51
    ds_read2st64_b32 v[76:77], v32 offset0:0 offset1:1
    ds_read2st64_b32 v[78:79], v32 offset0:2 offset1:3
    ds_read2st64_b32 v[80:81], v32 offset0:48 offset1:49
    ds_read2st64_b32 v[82:83], v32 offset0:50 offset1:51
    ds_read2st64_b32 v[84:85], v33 offset0:0 offset1:1
    ds_read2st64_b32 v[86:87], v33 offset0:2 offset1:3
    ds_read2st64_b32 v[88:89], v33 offset0:48 offset1:49
    ds_read2st64_b32 v[90:91], v33 offset0:50 offset1:51
    ds_read2st64_b32 v[92:93], v34 offset0:0 offset1:1
    ds_read2st64_b32 v[94:95], v34 offset0:2 offset1:3
    ds_read2st64_b32 v[96:97], v34 offset0:48 offset1:49
    ds_read2st64_b32 v[98:99], v34 offset0:50 offset1:51
    s_waitcnt lgkmcnt(15)
    v_mfma_f32_16x16x32_bf16 v[212:215], v[60:63], v[40:43], v[212:215]
    v_mfma_f32_16x16x32_bf16 v[212:215], v[64:67], v[44:47], v[212:215]
    s_waitcnt lgkmcnt(14)
    v_mfma_f32_16x16x32_bf16 v[216:219], v[68:71], v[40:43], v[216:219]
    s_waitcnt lgkmcnt(12)
    v_mfma_f32_16x16x32_bf16 v[216:219], v[72:75], v[44:47], v[216:219]
    s_waitcnt lgkmcnt(10)
    v_mfma_f32_16x16x32_bf16 v[220:223], v[76:79], v[48:51], v[220:223]
    s_nop 1
    v_cvt_pk_bf16_f32 v12, v212, v213
    v_cvt_pk_bf16_f32 v13, v214, v215
    s_waitcnt lgkmcnt(8)
    v_mfma_f32_16x16x32_bf16 v[220:223], v[80:83], v[52:55], v[220:223]
    s_waitcnt lgkmcnt(6)
    v_mfma_f32_16x16x32_bf16 v[224:227], v[84:87], v[48:51], v[224:227]
    v_cvt_pk_bf16_f32 v14, v216, v217
    v_cvt_pk_bf16_f32 v15, v218, v219
    s_waitcnt lgkmcnt(4)
    v_mfma_f32_16x16x32_bf16 v[224:227], v[88:91], v[52:55], v[224:227]
    buffer_store_dwordx4 v[12:15], v1, s[4:7], s57 offen sc1
    s_waitcnt lgkmcnt(2)
    v_mfma_f32_16x16x32_bf16 v[56:59], v[92:95], v[40:43], v[228:231]
    v_cvt_pk_bf16_f32 v16, v220, v221
    v_cvt_pk_bf16_f32 v17, v222, v223
    v_mfma_f32_16x16x32_bf16 v[228:231], v[92:95], v[48:51], v[228:231]
    s_waitcnt lgkmcnt(0)
    v_mfma_f32_16x16x32_bf16 v[56:59], v[96:99], v[44:47], v[56:59]
    v_cvt_pk_bf16_f32 v18, v224, v225
    v_cvt_pk_bf16_f32 v19, v226, v227
    v_mfma_f32_16x16x32_bf16 v[228:231], v[96:99], v[52:55], v[228:231]
    buffer_store_dwordx4 v[16:19], v1, s[4:7], s58 offen sc1
    v_dot2c_f32_bf16 v24, s60, v12
    v_dot2c_f32_bf16 v25, v12, v12
    v_dot2c_f32_bf16 v24, s60, v13
    v_dot2c_f32_bf16 v25, v13, v13
    v_dot2c_f32_bf16 v24, s60, v14
    v_dot2c_f32_bf16 v25, v14, v14
    v_dot2c_f32_bf16 v24, s60, v15
    v_dot2c_f32_bf16 v25, v15, v15
    v_cndmask_b32 v228, v228, v56, s[66:67]
    v_cndmask_b32 v229, v229, v57, s[66:67]
    v_cndmask_b32 v230, v230, v58, s[66:67]
    v_cndmask_b32 v231, v231, v59, s[66:67]
    v_cvt_pk_bf16_f32 v20, v228, v229
    v_cvt_pk_bf16_f32 v21, v230, v231
    buffer_store_dwordx2 v[20:21], v4, s[4:7], s56 offen sc1
    v_dot2c_f32_bf16 v24, s60, v16
    v_dot2c_f32_bf16 v25, v16, v16
    v_dot2c_f32_bf16 v24, s60, v17
    v_dot2c_f32_bf16 v25, v17, v17
    v_dot2c_f32_bf16 v24, s60, v18
    v_dot2c_f32_bf16 v25, v18, v18
    v_dot2c_f32_bf16 v24, s60, v19
    v_dot2c_f32_bf16 v25, v19, v19
    v_dot2c_f32_bf16 v24, s60, v20
    v_dot2c_f32_bf16 v25, v20, v20
    v_dot2c_f32_bf16 v24, s60, v21
    v_dot2c_f32_bf16 v25, v21, v21
    s_nop 2
    v_permlane32_swap_b32 v24, v25
    v_add_f32 v24, v24, v25
    v_mov_b32 v25, v24
    s_nop 1
    v_permlane16_swap_b32 v24, v25
    v_add_f32 v24, v24, v25
    buffer_store_dword v24, v26, s[4:7], s59 offen sc1
    s_barrier
    s_lshr_b32 s50, s2, 3
    s_lshl_b32 s50, s50, 2
    s_add_u32 s50, s50, s36
    s_lshl_b32 s50, s50, 9
    v_lshl_add_u32 v30, v3, 7, s50
    v_min_u32 v30, CODE_END-PC0-4, v30
    global_load_dword v31, v30, s[94:95] sc1
    s_add_u32 m0, s77, 0
    s_add_u32 s61, s76, 0
    buffer_load_dwordx4 v1, s[4:7], s61 offen offset:0 sc1 lds
    buffer_load_dwordx4 v1, s[4:7], s61 offen offset:1024 sc1 lds
    buffer_load_dwordx4 v1, s[4:7], s61 offen offset:2048 sc1 lds
    buffer_load_dwordx4 v1, s[4:7], s61 offen offset:3072 sc1 lds
    s_add_u32 m0, s77, 4096
    s_add_u32 s61, s76, 4096
    buffer_load_dwordx4 v1, s[4:7], s61 offen offset:0 sc1 lds
    buffer_load_dwordx4 v1, s[4:7], s61 offen offset:1024 sc1 lds
    v_add_u32 v9, 64512, v1
    v_add_u32 v10, 129024, v1
    s_mul_i32 s50, s44, 81920
    s_cmp_eq_u32 s42, 31
    s_cselect_b32 s50, 0x10000000, s50
    s_add_u32 s72, s50, 17891328
    s_add_u32 s73, s50, 17911808
    s_add_u32 s74, s50, 17932288
    s_add_u32 s75, s50, 17952768
    s_lshl_b32 s80, s44, 12
    s_add_u32 s80, s80, 23265280
    v_and_b32 v28, 7, v0
    v_lshlrev_b32 v28, 12, v28
    v_lshrrev_b32 v29, 3, v0
    v_lshl_add_u32 v28, v29, 28, v28
    v_mov_b32 v29, 1
    s_sub_u32 s69, s84, s4
    s_add_u32 s69, s69, 12
    s_waitcnt vmcnt(7)
    s_barrier
    buffer_atomic_add v29, v28, s[4:7], s69 offen sc1
    s_add_u32 m0, s77, 6144
    s_add_u32 s61, s76, 6144
    buffer_load_dwordx4 v1, s[4:7], s61 offen offset:0 sc1 lds
    buffer_load_dwordx4 v1, s[4:7], s61 offen offset:1024 sc1 lds
    buffer_load_dwordx4 v1, s[4:7], s61 offen offset:2048 sc1 lds
    buffer_load_dwordx4 v1, s[4:7], s61 offen offset:3072 sc1 lds
    s_add_u32 m0, s77, 10240
    s_add_u32 s61, s76, 10240
    buffer_load_dwordx4 v1, s[4:7], s61 offen offset:0 sc1 lds
    buffer_load_dwordx4 v1, s[4:7], s61 offen offset:1024 sc1 lds
    buffer_load_dwordx4 v1, s[4:7], s61 offen offset:2048 sc1 lds
    s_mul_i32 s50, s44, 229376
    s_mul_i32 s51, s42, 1792
    s_add_u32 s50, s50, s51
    s_cmp_eq_u32 s42, 31
    s_cselect_b32 s50, 0x10000000, s50
    s_add_u32 s76, s50, 30867456
    s_add_u32 s77, s50, 30924800
    s_add_u32 s78, s50, 30982144
    s_add_u32 s79, s50, 31039488
    s_load_dword s91, s[92:93], 12 glc
    s_waitcnt lgkmcnt(0)
    s_cmp_ge_u32 s91, 8
    s_cbranch_scc1 POLLX20
    s_mov_b32 s68, 0
POLL19:
    s_load_dword s91, s[92:93], 12 glc
    s_add_u32 s68, s68, 1
    s_waitcnt lgkmcnt(0)
    s_cmp_ge_u32 s91, 8
    s_cbranch_scc1 POLLX20
    s_cmp_lt_u32 s68, 400000
    s_cbranch_scc1 POLL19
POLLX20:
    buffer_load_dwordx4 v[152:155], v1, s[4:7], s72 offen offset:0 sc1
    buffer_load_dwordx4 v[156:159], v1, s[4:7], s73 offen offset:0 sc1
    buffer_load_dwordx4 v[160:163], v1, s[4:7], s72 offen offset:1024 sc1
    buffer_load_dwordx4 v[164:167], v1, s[4:7], s73 offen offset:1024 sc1
    buffer_load_dwordx4 v[168:171], v1, s[4:7], s72 offen offset:2048 sc1
    buffer_load_dwordx4 v[172:175], v1, s[4:7], s73 offen offset:2048 sc1
    buffer_load_dwordx4 v[176:179], v1, s[4:7], s72 offen offset:3072 sc1
    buffer_load_dwordx4 v[180:183], v1, s[4:7], s73 offen offset:3072 sc1
    s_add_u32 s72, s72, 4096
    s_add_u32 s73, s73, 4096
    ds_read_b128 v[124:127], v1 offset:0
    ds_read_b128 v[128:131], v1 offset:1024
    ds_read_b128 v[132:135], v1 offset:2048
    ds_read_b128 v[136:139], v1 offset:3072
    ds_read_b128 v[140:143], v1 offset:4096
    ds_read_b128 v[144:147], v1 offset:5120
    s_waitcnt vmcnt(8)
    s_barrier
    s_waitcnt vmcnt(7) lgkmcnt(5)
    v_mfma_f32_16x16x32_bf16 v[12:15], v[124:127], v[152:155], 0
    ds_read_b128 v[148:151], v1 offset:6144
    s_waitcnt vmcnt(6)
    v_mfma_f32_16x16x32_bf16 v[16:19], v[124:127], v[156:159], 0
    s_waitcnt lgkmcnt(4)
    buffer_load_dword v68, v5, s[4:7], s80 offen offset:0 sc1
    v_mfma_f32_16x16x32_bf16 v[20:23], v[128:131], v[152:155], 0
    ds_read_b128 v[124:127], v1 offset:7168
    v_lshlrev_b32 v211, 4, v3
    v_mfma_f32_16x16x32_bf16 v[24:27], v[128:131], v[156:159], 0
    buffer_load_dwordx4 v[184:187], v1, s[4:7], s72 offen offset:0 sc1
    v_mfma_f32_16x16x32_bf16 v[28:31], v[132:135], v[152:155], 0
    ds_read_b128 v[128:131], v1 offset:8192
    v_add_u32 v211, 163328, v211
    v_mfma_f32_16x16x32_bf16 v[32:35], v[132:135], v[156:159], 0
    s_waitcnt lgkmcnt(4)
    buffer_load_dword v69, v5, s[4:7], s80 offen offset:256 sc1
    v_mfma_f32_16x16x32_bf16 v[36:39], v[136:139], v[152:155], 0
    ds_read_b128 v[132:135], v1 offset:9216
    v_mfma_f32_16x16x32_bf16 v[40:43], v[136:139], v[156:159], 0
    buffer_load_dwordx4 v[188:191], v1, s[4:7], s73 offen offset:0 sc1
    v_mfma_f32_16x16x32_bf16 v[44:47], v[140:143], v[152:155], 0
    ds_read_b128 v[136:139], v1 offset:10240
    v_mfma_f32_16x16x32_bf16 v[48:51], v[140:143], v[156:159], 0
    s_waitcnt lgkmcnt(4)
    buffer_load_dword v70, v5, s[4:7], s80 offen offset:512 sc1
    v_mfma_f32_16x16x32_bf16 v[52:55], v[144:147], v[152:155], 0
    ds_read_b128 v[140:143], v1 offset:11264
    v_mfma_f32_16x16x32_bf16 v[56:59], v[144:147], v[156:159], 0
    v_mfma_f32_16x16x32_bf16 v[60:63], v[148:151], v[152:155], 0
    s_waitcnt vmcnt(9)
    ds_read_b128 v[144:147], v1 offset:12288
    v_mfma_f32_16x16x32_bf16 v[64:67], v[148:151], v[156:159], 0
    s_waitcnt lgkmcnt(5)
    buffer_load_dword v71, v5, s[4:7], s80 offen offset:768 sc1
    v_mfma_f32_16x16x32_bf16 v[12:15], v[124:127], v[160:163], v[12:15]
    ds_read_b128 v[148:151], v1 offset:13312
    v_mfma_f32_16x16x32_bf16 v[16:19], v[124:127], v[164:167], v[16:19]
    s_waitcnt lgkmcnt(4)
    buffer_load_dword v72, v5, s[4:7], s80 offen offset:1024 sc1
    v_mfma_f32_16x16x32_bf16 v[20:23], v[128:131], v[160:163], v[20:23]
    ds_read_b128 v[124:127], v1 offset:14336
    v_mfma_f32_16x16x32_bf16 v[24:27], v[128:131], v[164:167], v[24:27]
    buffer_load_dwordx4 v[152:155], v1, s[4:7], s72 offen offset:1024 sc1
    v_mfma_f32_16x16x32_bf16 v[28:31], v[132:135], v[160:163], v[28:31]
    ds_read_b128 v[128:131], v1 offset:15360
    v_mfma_f32_16x16x32_bf16 v[32:35], v[132:135], v[164:167], v[32:35]
    s_waitcnt lgkmcnt(4)
    buffer_load_dword v73, v5, s[4:7], s80 offen offset:1280 sc1
    v_mfma_f32_16x16x32_bf16 v[36:39], v[136:139], v[160:163], v[36:39]
    ds_read_b128 v[132:135], v1 offset:16384
    v_mfma_f32_16x16x32_bf16 v[40:43], v[136:139], v[164:167], v[40:43]
    buffer_load_dwordx4 v[156:159], v1, s[4:7], s73 offen offset:1024 sc1
    v_mfma_f32_16x16x32_bf16 v[44:47], v[140:143], v[160:163], v[44:47]
    ds_read_b128 v[136:139], v1 offset:17408
    v_mfma_f32_16x16x32_bf16 v[48:51], v[140:143], v[164:167], v[48:51]
    s_waitcnt lgkmcnt(4)
    buffer_load_dword v74, v5, s[4:7], s80 offen offset:1536 sc1
    v_mfma_f32_16x16x32_bf16 v[52:55], v[144:147], v[160:163], v[52:55]
    ds_read_b128 v[140:143], v1 offset:18432
    v_mfma_f32_16x16x32_bf16 v[56:59], v[144:147], v[164:167], v[56:59]
    v_mfma_f32_16x16x32_bf16 v[60:63], v[148:151], v[160:163], v[60:63]
    s_waitcnt vmcnt(13)
    ds_read_b128 v[144:147], v1 offset:19456
    v_mfma_f32_16x16x32_bf16 v[64:67], v[148:151], v[164:167], v[64:67]
    s_waitcnt lgkmcnt(5)
    buffer_load_dword v75, v5, s[4:7], s80 offen offset:1792 sc1
    v_mfma_f32_16x16x32_bf16 v[12:15], v[124:127], v[168:171], v[12:15]
    ds_read_b128 v[148:151], v1 offset:20480
    v_mfma_f32_16x16x32_bf16 v[16:19], v[124:127], v[172:175], v[16:19]
    s_waitcnt lgkmcnt(4)
    buffer_load_dword v76, v5, s[4:7], s80 offen offset:2048 sc1
    v_mfma_f32_16x16x32_bf16 v[20:23], v[128:131], v[168:171], v[20:23]
    ds_read_b128 v[124:127], v1 offset:21504
    v_mfma_f32_16x16x32_bf16 v[24:27], v[128:131], v[172:175], v[24:27]
    buffer_load_dwordx4 v[160:163], v1, s[4:7], s72 offen offset:2048 sc1
    v_mfma_f32_16x16x32_bf16 v[28:31], v[132:135], v[168:171], v[28:31]
    ds_read_b128 v[128:131], v1 offset:22528
    v_mfma_f32_16x16x32_bf16 v[32:35], v[132:135], v[172:175], v[32:35]
    s_waitcnt lgkmcnt(4)
    buffer_load_dword v77, v5, s[4:7], s80 offen offset:2304 sc1
    v_mfma_f32_16x16x32_bf16 v[36:39], v[136:139], v[168:171], v[36:39]
    ds_read_b128 v[132:135], v1 offset:23552
    v_mfma_f32_16x16x32_bf16 v[40:43], v[136:139], v[172:175], v[40:43]
    buffer_load_dwordx4 v[164:167], v1, s[4:7], s73 offen offset:2048 sc1
    v_mfma_f32_16x16x32_bf16 v[44:47], v[140:143], v[168:171], v[44:47]
    ds_read_b128 v[136:139], v1 offset:24576
    v_mfma_f32_16x16x32_bf16 v[48:51], v[140:143], v[172:175], v[48:51]
    s_waitcnt lgkmcnt(4)
    buffer_load_dword v78, v5, s[4:7], s80 offen offset:2560 sc1
    v_mfma_f32_16x16x32_bf16 v[52:55], v[144:147], v[168:171], v[52:55]
    ds_read_b128 v[140:143], v1 offset:25600
    v_mfma_f32_16x16x32_bf16 v[56:59], v[144:147], v[172:175], v[56:59]
    v_mfma_f32_16x16x32_bf16 v[60:63], v[148:151], v[168:171], v[60:63]
    s_waitcnt vmcnt(17)
    ds_read_b128 v[144:147], v1 offset:26624
    v_mfma_f32_16x16x32_bf16 v[64:67], v[148:151], v[172:175], v[64:67]
    s_waitcnt lgkmcnt(5)
    buffer_load_dword v79, v5, s[4:7], s80 offen offset:2816 sc1
    v_mfma_f32_16x16x32_bf16 v[12:15], v[124:127], v[176:179], v[12:15]
    ds_read_b128 v[148:151], v1 offset:27648
    v_mfma_f32_16x16x32_bf16 v[16:19], v[124:127], v[180:183], v[16:19]
    s_waitcnt lgkmcnt(4)
    buffer_load_dword v80, v5, s[4:7], s80 offen offset:3072 sc1
    v_mfma_f32_16x16x32_bf16 v[20:23], v[128:131], v[176:179], v[20:23]
    ds_read_b128 v[124:127], v1 offset:28672
    v_mfma_f32_16x16x32_bf16 v[24:27], v[128:131], v[180:183], v[24:27]
    buffer_load_dwordx4 v[168:171], v1, s[4:7], s72 offen offset:3072 sc1
    v_mfma_f32_16x16x32_bf16 v[28:31], v[132:135], v[176:179], v[28:31]
    ds_read_b128 v[128:131], v1 offset:29696
    v_mfma_f32_16x16x32_bf16 v[32:35], v[132:135], v[180:183], v[32:35]
    s_waitcnt lgkmcnt(4)
    buffer_load_dword v81, v5, s[4:7], s80 offen offset:3328 sc1
    v_mfma_f32_16x16x32_bf16 v[36:39], v[136:139], v[176:179], v[36:39]
    ds_read_b128 v[132:135], v1 offset:30720
    v_mfma_f32_16x16x32_bf16 v[40:43], v[136:139], v[180:183], v[40:43]
    buffer_load_dwordx4 v[172:175], v1, s[4:7], s73 offen offset:3072 sc1
    v_mfma_f32_16x16x32_bf16 v[44:47], v[140:143], v[176:179], v[44:47]
    s_add_u32 s72, s72, 4096
    ds_read_b128 v[136:139], v1 offset:31744
    v_mfma_f32_16x16x32_bf16 v[48:51], v[140:143], v[180:183], v[48:51]
    s_waitcnt lgkmcnt(4)
    buffer_load_dword v82, v5, s[4:7], s80 offen offset:3584 sc1
    v_mfma_f32_16x16x32_bf16 v[52:55], v[144:147], v[176:179], v[52:55]
    s_add_u32 s73, s73, 4096
    ds_read_b128 v[140:143], v1 offset:32768
    v_mfma_f32_16x16x32_bf16 v[56:59], v[144:147], v[180:183], v[56:59]
    v_mfma_f32_16x16x32_bf16 v[60:63], v[148:151], v[176:179], v[60:63]
    s_waitcnt vmcnt(19)
    ds_read_b128 v[144:147], v1 offset:33792
    v_mfma_f32_16x16x32_bf16 v[64:67], v[148:151], v[180:183], v[64:67]
    s_waitcnt lgkmcnt(5)
    buffer_load_dword v83, v5, s[4:7], s80 offen offset:3840 sc1
    v_mfma_f32_16x16x32_bf16 v[12:15], v[124:127], v[184:187], v[12:15]
    ds_read_b128 v[148:151], v1 offset:34816
    v_mfma_f32_16x16x32_bf16 v[16:19], v[124:127], v[188:191], v[16:19]
    s_waitcnt lgkmcnt(4)
    s_waitcnt vmcnt(18)
    v_add_f32 v68, v68, v69
    v_add_f32 v70, v70, v71
    v_mfma_f32_16x16x32_bf16 v[20:23], v[128:131], v[184:187], v[20:23]
    ds_read_b128 v[124:127], v1 offset:35840
    v_add_f32 v68, v68, v70
    v_mfma_f32_16x16x32_bf16 v[24:27], v[128:131], v[188:191], v[24:27]
    buffer_load_dwordx4 v[176:179], v1, s[4:7], s72 offen offset:0 sc1
    v_mfma_f32_16x16x32_bf16 v[28:31], v[132:135], v[184:187], v[28:31]
    ds_read_b128 v[128:131], v1 offset:36864
    v_mov_b32 v69, v68
    v_mfma_f32_16x16x32_bf16 v[32:35], v[132:135], v[188:191], v[32:35]
    s_waitcnt lgkmcnt(4)
    v_permlane32_swap_b32 v68, v69
    v_mfma_f32_16x16x32_bf16 v[36:39], v[136:139], v[184:187], v[36:39]
    ds_read_b128 v[132:135], v1 offset:37888
    v_add_f32 v68, v68, v69
    v_mfma_f32_16x16x32_bf16 v[40:43], v[136:139], v[188:191], v[40:43]
    buffer_load_dwordx4 v[180:183], v1, s[4:7], s73 offen offset:0 sc1
    v_mfma_f32_16x16x32_bf16 v[44:47], v[140:143], v[184:187], v[44:47]
    ds_read_b128 v[136:139], v1 offset:38912
    v_mov_b32 v69, v68
    v_mfma_f32_16x16x32_bf16 v[48:51], v[140:143], v[188:191], v[48:51]
    s_waitcnt lgkmcnt(4)
    v_permlane16_swap_b32 v68, v69
    v_mfma_f32_16x16x32_bf16 v[52:55], v[144:147], v[184:187], v[52:55]
    ds_read_b128 v[140:143], v1 offset:39936
    v_mul_f32 v200, 0xbacccccd, v68
    v_mfma_f32_16x16x32_bf16 v[56:59], v[144:147], v[188:191], v[56:59]
    v_mul_f32 v69, 0x3acccccd, v69
    v_fma_f32 v69, -v200, v200, v69
    v_mfma_f32_16x16x32_bf16 v[60:63], v[148:151], v[184:187], v[60:63]
    s_waitcnt vmcnt(16)
    ds_read_b128 v[144:147], v1 offset:40960
    v_max_f32 v69, 0, v69
    v_mfma_f32_16x16x32_bf16 v[64:67], v[148:151], v[188:191], v[64:67]
    s_waitcnt lgkmcnt(5)
    v_add_f32 v196, 0x3727c5ac, v69
    v_mfma_f32_16x16x32_bf16 v[12:15], v[124:127], v[152:155], v[12:15]
    ds_read_b128 v[148:151], v1 offset:41984
    v_mfma_f32_16x16x32_bf16 v[16:19], v[124:127], v[156:159], v[16:19]
    s_waitcnt lgkmcnt(4)
    v_rsq_f32 v192, v196
    v_mfma_f32_16x16x32_bf16 v[20:23], v[128:131], v[152:155], v[20:23]
    ds_read_b128 v[124:127], v1 offset:43008
    v_mul_f32 v192, 0xbfb8aa3b, v192
    v_mfma_f32_16x16x32_bf16 v[24:27], v[128:131], v[156:159], v[24:27]
    buffer_load_dwordx4 v[184:187], v1, s[4:7], s72 offen offset:1024 sc1
    v_mfma_f32_16x16x32_bf16 v[28:31], v[132:135], v[152:155], v[28:31]
    ds_read_b128 v[128:131], v1 offset:44032
    v_mfma_f32_16x16x32_bf16 v[32:35], v[132:135], v[156:159], v[32:35]
    s_waitcnt lgkmcnt(4)
    s_waitcnt vmcnt(15)
    v_add_f32 v72, v72, v73
    v_add_f32 v74, v74, v75
    v_mfma_f32_16x16x32_bf16 v[36:39], v[136:139], v[152:155], v[36:39]
    ds_read_b128 v[132:135], v1 offset:45056
    v_add_f32 v72, v72, v74
    v_mfma_f32_16x16x32_bf16 v[40:43], v[136:139], v[156:159], v[40:43]
    buffer_load_dwordx4 v[188:191], v1, s[4:7], s73 offen offset:1024 sc1
    v_mfma_f32_16x16x32_bf16 v[44:47], v[140:143], v[152:155], v[44:47]
    ds_read_b128 v[136:139], v1 offset:46080
    v_mov_b32 v73, v72
    v_mfma_f32_16x16x32_bf16 v[48:51], v[140:143], v[156:159], v[48:51]
    s_waitcnt lgkmcnt(4)
    v_permlane32_swap_b32 v72, v73
    v_mfma_f32_16x16x32_bf16 v[52:55], v[144:147], v[152:155], v[52:55]
    ds_read_b128 v[140:143], v1 offset:47104
    v_add_f32 v72, v72, v73
    v_mfma_f32_16x16x32_bf16 v[56:59], v[144:147], v[156:159], v[56:59]
    v_mov_b32 v73, v72
    v_mfma_f32_16x16x32_bf16 v[60:63], v[148:151], v[152:155], v[60:63]
    s_waitcnt vmcnt(12)
    ds_read_b128 v[144:147], v1 offset:48128
    v_mfma_f32_16x16x32_bf16 v[64:67], v[148:151], v[156:159], v[64:67]
    s_waitcnt lgkmcnt(5)
    v_permlane16_swap_b32 v72, v73
    v_mfma_f32_16x16x32_bf16 v[12:15], v[124:127], v[160:163], v[12:15]
    ds_read_b128 v[148:151], v1 offset:49152
    v_mul_f32 v201, 0xbacccccd, v72
    v_mfma_f32_16x16x32_bf16 v[16:19], v[124:127], v[164:167], v[16:19]
    s_waitcnt lgkmcnt(4)
    v_mul_f32 v73, 0x3acccccd, v73
    v_fma_f32 v73, -v201, v201, v73
    v_mfma_f32_16x16x32_bf16 v[20:23], v[128:131], v[160:163], v[20:23]
    ds_read_b128 v[124:127], v1 offset:50176
    v_max_f32 v73, 0, v73
    v_mfma_f32_16x16x32_bf16 v[24:27], v[128:131], v[164:167], v[24:27]
    buffer_load_dwordx4 v[152:155], v1, s[4:7], s72 offen offset:2048 sc1
    v_mfma_f32_16x16x32_bf16 v[28:31], v[132:135], v[160:163], v[28:31]
    ds_read_b128 v[128:131], v1 offset:51200
    v_add_f32 v197, 0x3727c5ac, v73
    v_mfma_f32_16x16x32_bf16 v[32:35], v[132:135], v[164:167], v[32:35]
    s_waitcnt lgkmcnt(4)
    v_rsq_f32 v193, v197
    v_mfma_f32_16x16x32_bf16 v[36:39], v[136:139], v[160:163], v[36:39]
    ds_read_b128 v[132:135], v1 offset:52224
    v_mul_f32 v193, 0xbfb8aa3b, v193
    v_mfma_f32_16x16x32_bf16 v[40:43], v[136:139], v[164:167], v[40:43]
    buffer_load_dwordx4 v[156:159], v1, s[4:7], s73 offen offset:2048 sc1
    v_mfma_f32_16x16x32_bf16 v[44:47], v[140:143], v[160:163], v[44:47]
    ds_read_b128 v[136:139], v1 offset:53248
    v_mfma_f32_16x16x32_bf16 v[48:51], v[140:143], v[164:167], v[48:51]
    s_waitcnt lgkmcnt(4)
    s_waitcnt vmcnt(12)
    v_add_f32 v76, v76, v77
    v_add_f32 v78, v78, v79
    v_mfma_f32_16x16x32_bf16 v[52:55], v[144:147], v[160:163], v[52:55]
    ds_read_b128 v[140:143], v1 offset:54272
    v_add_f32 v76, v76, v78
    v_mfma_f32_16x16x32_bf16 v[56:59], v[144:147], v[164:167], v[56:59]
    v_mov_b32 v77, v76
    v_mfma_f32_16x16x32_bf16 v[60:63], v[148:151], v[160:163], v[60:63]
    s_waitcnt vmcnt(8)
    ds_read_b128 v[144:147], v1 offset:55296
    v_mfma_f32_16x16x32_bf16 v[64:67], v[148:151], v[164:167], v[64:67]
    s_waitcnt lgkmcnt(5)
    v_permlane32_swap_b32 v76, v77
    v_mfma_f32_16x16x32_bf16 v[12:15], v[124:127], v[168:171], v[12:15]
    ds_read_b128 v[148:151], v1 offset:56320
    v_add_f32 v76, v76, v77
    v_mfma_f32_16x16x32_bf16 v[16:19], v[124:127], v[172:175], v[16:19]
    s_waitcnt lgkmcnt(4)
    v_mov_b32 v77, v76
    v_mfma_f32_16x16x32_bf16 v[20:23], v[128:131], v[168:171], v[20:23]
    ds_read_b128 v[124:127], v1 offset:57344
    v_mfma_f32_16x16x32_bf16 v[24:27], v[128:131], v[172:175], v[24:27]
    buffer_load_dwordx4 v[160:163], v1, s[4:7], s72 offen offset:3072 sc1
    v_mfma_f32_16x16x32_bf16 v[28:31], v[132:135], v[168:171], v[28:31]
    ds_read_b128 v[128:131], v1 offset:58368
    v_mfma_f32_16x16x32_bf16 v[32:35], v[132:135], v[172:175], v[32:35]
    s_waitcnt lgkmcnt(4)
    v_permlane16_swap_b32 v76, v77
    v_mfma_f32_16x16x32_bf16 v[36:39], v[136:139], v[168:171], v[36:39]
    ds_read_b128 v[132:135], v1 offset:59392
    v_mul_f32 v202, 0xbacccccd, v76
    v_mfma_f32_16x16x32_bf16 v[40:43], v[136:139], v[172:175], v[40:43]
    buffer_load_dwordx4 v[164:167], v1, s[4:7], s73 offen offset:3072 sc1
    v_mfma_f32_16x16x32_bf16 v[44:47], v[140:143], v[168:171], v[44:47]
    s_add_u32 s72, s72, 4096
    ds_read_b128 v[136:139], v1 offset:60416
    v_mul_f32 v77, 0x3acccccd, v77
    v_mfma_f32_16x16x32_bf16 v[48:51], v[140:143], v[172:175], v[48:51]
    s_waitcnt lgkmcnt(4)
    v_fma_f32 v77, -v202, v202, v77
    v_max_f32 v77, 0, v77
    v_mfma_f32_16x16x32_bf16 v[52:55], v[144:147], v[168:171], v[52:55]
    s_add_u32 s73, s73, 4096
    ds_read_b128 v[140:143], v1 offset:61440
    v_add_f32 v198, 0x3727c5ac, v77
    v_mfma_f32_16x16x32_bf16 v[56:59], v[144:147], v[172:175], v[56:59]
    s_waitcnt vmcnt(8)
    v_rsq_f32 v194, v198
    v_mfma_f32_16x16x32_bf16 v[60:63], v[148:151], v[168:171], v[60:63]
    s_waitcnt vmcnt(6)
    ds_read_b128 v[144:147], v1 offset:62464
    v_mul_f32 v194, 0xbfb8aa3b, v194
    v_mfma_f32_16x16x32_bf16 v[64:67], v[148:151], v[172:175], v[64:67]
    s_waitcnt lgkmcnt(5)
    v_add_f32 v80, v80, v81
    v_add_f32 v82, v82, v83
    v_mfma_f32_16x16x32_bf16 v[12:15], v[124:127], v[176:179], v[12:15]
    ds_read_b128 v[148:151], v1 offset:63488
    v_add_f32 v80, v80, v82
    v_mfma_f32_16x16x32_bf16 v[16:19], v[124:127], v[180:183], v[16:19]
    s_waitcnt lgkmcnt(4)
    v_mov_b32 v81, v80
    v_mfma_f32_16x16x32_bf16 v[20:23], v[128:131], v[176:179], v[20:23]
    ds_read_b128 v[124:127], v9 offset:0
    v_mfma_f32_16x16x32_bf16 v[24:27], v[128:131], v[180:183], v[24:27]
    buffer_load_dwordx4 v[168:171], v1, s[4:7], s72 offen offset:0 sc1
    v_mfma_f32_16x16x32_bf16 v[28:31], v[132:135], v[176:179], v[28:31]
    ds_read_b128 v[128:131], v9 offset:1024
    v_mfma_f32_16x16x32_bf16 v[32:35], v[132:135], v[180:183], v[32:35]
    s_waitcnt lgkmcnt(4)
    v_permlane32_swap_b32 v80, v81
    v_mfma_f32_16x16x32_bf16 v[36:39], v[136:139], v[176:179], v[36:39]
    ds_read_b128 v[132:135], v9 offset:2048
    v_add_f32 v80, v80, v81
    v_mfma_f32_16x16x32_bf16 v[40:43], v[136:139], v[180:183], v[40:43]
    buffer_load_dwordx4 v[172:175], v1, s[4:7], s73 offen offset:0 sc1
    v_mfma_f32_16x16x32_bf16 v[44:47], v[140:143], v[176:179], v[44:47]
    ds_read_b128 v[136:139], v9 offset:3072
    v_mov_b32 v81, v80
    v_mfma_f32_16x16x32_bf16 v[48:51], v[140:143], v[180:183], v[48:51]
    s_waitcnt lgkmcnt(4)
    v_permlane16_swap_b32 v80, v81
    v_mfma_f32_16x16x32_bf16 v[52:55], v[144:147], v[176:179], v[52:55]
    ds_read_b128 v[140:143], v9 offset:4096
    v_mul_f32 v203, 0xbacccccd, v80
    v_mfma_f32_16x16x32_bf16 v[56:59], v[144:147], v[180:183], v[56:59]
    v_mul_f32 v81, 0x3acccccd, v81
    v_fma_f32 v81, -v203, v203, v81
    v_mfma_f32_16x16x32_bf16 v[60:63], v[148:151], v[176:179], v[60:63]
    s_waitcnt vmcnt(6)
    ds_read_b128 v[144:147], v9 offset:5120
    v_max_f32 v81, 0, v81
    v_mfma_f32_16x16x32_bf16 v[64:67], v[148:151], v[180:183], v[64:67]
    s_waitcnt lgkmcnt(5)
    v_add_f32 v199, 0x3727c5ac, v81
    v_mfma_f32_16x16x32_bf16 v[12:15], v[124:127], v[184:187], v[12:15]
    ds_read_b128 v[148:151], v9 offset:6144
    v_mfma_f32_16x16x32_bf16 v[16:19], v[124:127], v[188:191], v[16:19]
    s_waitcnt lgkmcnt(4)
    v_rsq_f32 v195, v199
    v_mfma_f32_16x16x32_bf16 v[20:23], v[128:131], v[184:187], v[20:23]
    ds_read_b128 v[124:127], v9 offset:7168
    v_mul_f32 v195, 0xbfb8aa3b, v195
    v_mfma_f32_16x16x32_bf16 v[24:27], v[128:131], v[188:191], v[24:27]
    buffer_load_dwordx4 v[176:179], v1, s[4:7], s72 offen offset:1024 sc1
    v_mfma_f32_16x16x32_bf16 v[28:31], v[132:135], v[184:187], v[28:31]
    ds_read_b128 v[128:131], v9 offset:8192
    v_mfma_f32_16x16x32_bf16 v[32:35], v[132:135], v[188:191], v[32:35]
    s_waitcnt lgkmcnt(4)
    v_mfma_f32_16x16x32_bf16 v[36:39], v[136:139], v[184:187], v[36:39]
    ds_read_b128 v[132:135], v9 offset:9216
    v_mfma_f32_16x16x32_bf16 v[40:43], v[136:139], v[188:191], v[40:43]
    buffer_load_dwordx4 v[180:183], v1, s[4:7], s73 offen offset:1024 sc1
    v_mfma_f32_16x16x32_bf16 v[44:47], v[140:143], v[184:187], v[44:47]
    ds_read_b128 v[136:139], v9 offset:10240
    v_mfma_f32_16x16x32_bf16 v[48:51], v[140:143], v[188:191], v[48:51]
    s_waitcnt lgkmcnt(4)
    v_mfma_f32_16x16x32_bf16 v[52:55], v[144:147], v[184:187], v[52:55]
    ds_read_b128 v[140:143], v9 offset:11264
    v_mfma_f32_16x16x32_bf16 v[56:59], v[144:147], v[188:191], v[56:59]
    v_mfma_f32_16x16x32_bf16 v[60:63], v[148:151], v[184:187], v[60:63]
    s_waitcnt vmcnt(6)
    ds_read_b128 v[144:147], v9 offset:12288
    v_mfma_f32_16x16x32_bf16 v[64:67], v[148:151], v[188:191], v[64:67]
    s_waitcnt lgkmcnt(5)
    v_mfma_f32_16x16x32_bf16 v[12:15], v[124:127], v[152:155], v[12:15]
    ds_read_b128 v[148:151], v9 offset:13312
    v_mfma_f32_16x16x32_bf16 v[16:19], v[124:127], v[156:159], v[16:19]
    s_waitcnt lgkmcnt(4)
    v_mfma_f32_16x16x32_bf16 v[20:23], v[128:131], v[152:155], v[20:23]
    ds_read_b128 v[124:127], v9 offset:14336
    v_mfma_f32_16x16x32_bf16 v[24:27], v[128:131], v[156:159], v[24:27]
    buffer_load_dwordx4 v[184:187], v1, s[4:7], s72 offen offset:2048 sc1
    v_mfma_f32_16x16x32_bf16 v[28:31], v[132:135], v[152:155], v[28:31]
    ds_read_b128 v[128:131], v9 offset:15360
    v_mfma_f32_16x16x32_bf16 v[32:35], v[132:135], v[156:159], v[32:35]
    s_waitcnt lgkmcnt(4)
    v_mfma_f32_16x16x32_bf16 v[36:39], v[136:139], v[152:155], v[36:39]
    ds_read_b128 v[132:135], v9 offset:16384
    v_mfma_f32_16x16x32_bf16 v[40:43], v[136:139], v[156:159], v[40:43]
    buffer_load_dwordx4 v[188:191], v1, s[4:7], s73 offen offset:2048 sc1
    v_mfma_f32_16x16x32_bf16 v[44:47], v[140:143], v[152:155], v[44:47]
    ds_read_b128 v[136:139], v9 offset:17408
    v_mfma_f32_16x16x32_bf16 v[48:51], v[140:143], v[156:159], v[48:51]
    s_waitcnt lgkmcnt(4)
    v_mfma_f32_16x16x32_bf16 v[52:55], v[144:147], v[152:155], v[52:55]
    ds_read_b128 v[140:143], v9 offset:18432
    v_mfma_f32_16x16x32_bf16 v[56:59], v[144:147], v[156:159], v[56:59]
    ds_read_b128 v[72:75], v211 offset:0
    v_mfma_f32_16x16x32_bf16 v[60:63], v[148:151], v[152:155], v[60:63]
    s_waitcnt vmcnt(6)
    ds_read_b128 v[144:147], v9 offset:19456
    v_mfma_f32_16x16x32_bf16 v[64:67], v[148:151], v[156:159], v[64:67]
    s_waitcnt lgkmcnt(6)
    v_mfma_f32_16x16x32_bf16 v[12:15], v[124:127], v[160:163], v[12:15]
    ds_read_b128 v[148:151], v9 offset:20480
    v_mfma_f32_16x16x32_bf16 v[16:19], v[124:127], v[164:167], v[16:19]
    s_waitcnt lgkmcnt(5)
    v_mfma_f32_16x16x32_bf16 v[20:23], v[128:131], v[160:163], v[20:23]
    s_waitcnt lgkmcnt(2)
    ds_read_b128 v[124:127], v9 offset:21504
    v_mfma_f32_16x16x32_bf16 v[24:27], v[128:131], v[164:167], v[24:27]
    buffer_load_dwordx4 v[152:155], v1, s[4:7], s72 offen offset:3072 sc1
    v_mfma_f32_16x16x32_bf16 v[28:31], v[132:135], v[160:163], v[28:31]
    ds_read_b128 v[128:131], v9 offset:22528
    v_fmac_f32 v12, v200, v72
    v_mfma_f32_16x16x32_bf16 v[32:35], v[132:135], v[164:167], v[32:35]
    v_fmac_f32 v13, v200, v73
    v_fmac_f32 v14, v200, v74
    v_mfma_f32_16x16x32_bf16 v[36:39], v[136:139], v[160:163], v[36:39]
    ds_read_b128 v[132:135], v9 offset:23552
    v_fmac_f32 v15, v200, v75
    v_mfma_f32_16x16x32_bf16 v[40:43], v[136:139], v[164:167], v[40:43]
    buffer_load_dwordx4 v[156:159], v1, s[4:7], s73 offen offset:3072 sc1
    v_mfma_f32_16x16x32_bf16 v[44:47], v[140:143], v[160:163], v[44:47]
    s_add_u32 s72, s72, 4096
    ds_read_b128 v[136:139], v9 offset:24576
    v_fmac_f32 v16, v201, v72
    v_mfma_f32_16x16x32_bf16 v[48:51], v[140:143], v[164:167], v[48:51]
    s_waitcnt lgkmcnt(4)
    v_fmac_f32 v17, v201, v73
    v_fmac_f32 v18, v201, v74
    v_mfma_f32_16x16x32_bf16 v[52:55], v[144:147], v[160:163], v[52:55]
    s_add_u32 s73, s73, 4096
    ds_read_b128 v[140:143], v9 offset:25600
    v_fmac_f32 v19, v201, v75
    v_mfma_f32_16x16x32_bf16 v[56:59], v[144:147], v[164:167], v[56:59]
    v_mul_f32 v68, v202, v72
    v_mul_f32 v69, v202, v73
    v_mfma_f32_16x16x32_bf16 v[60:63], v[148:151], v[160:163], v[60:63]
    s_waitcnt vmcnt(6)
    ds_read_b128 v[144:147], v9 offset:26624
    v_mul_f32 v70, v202, v74
    v_mfma_f32_16x16x32_bf16 v[64:67], v[148:151], v[164:167], v[64:67]
    s_waitcnt lgkmcnt(5)
    ds_read_b128 v[80:83], v211 offset:64
    v_mul_f32 v71, v202, v75
    v_mfma_f32_16x16x32_bf16 v[12:15], v[124:127], v[168:171], v[12:15]
    ds_read_b128 v[148:151], v9 offset:27648
    v_mul_f32 v72, v203, v72
    v_mfma_f32_16x16x32_bf16 v[16:19], v[124:127], v[172:175], v[16:19]
    s_waitcnt lgkmcnt(5)
    v_mul_f32 v73, v203, v73
    v_mul_f32 v74, v203, v74
    v_mfma_f32_16x16x32_bf16 v[20:23], v[128:131], v[168:171], v[20:23]
    ds_read_b128 v[124:127], v9 offset:28672
    v_mul_f32 v75, v203, v75
    v_mfma_f32_16x16x32_bf16 v[24:27], v[128:131], v[172:175], v[24:27]
    buffer_load_dwordx4 v[160:163], v1, s[4:7], s72 offen offset:0 sc1
    v_mfma_f32_16x16x32_bf16 v[28:31], v[132:135], v[168:171], v[28:31]
    s_waitcnt lgkmcnt(2)
    ds_read_b128 v[128:131], v9 offset:29696
    v_mfma_f32_16x16x32_bf16 v[32:35], v[132:135], v[172:175], v[32:35]
    v_mfma_f32_16x16x32_bf16 v[36:39], v[136:139], v[168:171], v[36:39]
    ds_read_b128 v[132:135], v9 offset:30720
    v_fmac_f32 v20, v200, v80
    v_mfma_f32_16x16x32_bf16 v[40:43], v[136:139], v[172:175], v[40:43]
    buffer_load_dwordx4 v[164:167], v1, s[4:7], s73 offen offset:0 sc1
    v_mfma_f32_16x16x32_bf16 v[44:47], v[140:143], v[168:171], v[44:47]
    ds_read_b128 v[136:139], v9 offset:31744
    v_fmac_f32 v21, v200, v81
    v_mfma_f32_16x16x32_bf16 v[48:51], v[140:143], v[172:175], v[48:51]
    s_waitcnt lgkmcnt(4)
    v_fmac_f32 v22, v200, v82
    v_fmac_f32 v23, v200, v83
    v_mfma_f32_16x16x32_bf16 v[52:55], v[144:147], v[168:171], v[52:55]
    ds_read_b128 v[140:143], v9 offset:32768
    v_fmac_f32 v24, v201, v80
    v_mfma_f32_16x16x32_bf16 v[56:59], v[144:147], v[172:175], v[56:59]
    v_fmac_f32 v25, v201, v81
    v_fmac_f32 v26, v201, v82
    v_mfma_f32_16x16x32_bf16 v[60:63], v[148:151], v[168:171], v[60:63]
    s_waitcnt vmcnt(6)
    ds_read_b128 v[144:147], v9 offset:33792
    v_fmac_f32 v27, v201, v83
    v_mfma_f32_16x16x32_bf16 v[64:67], v[148:151], v[172:175], v[64:67]
    s_waitcnt lgkmcnt(5)
    v_mul_f32 v76, v202, v80
    v_mul_f32 v77, v202, v81
    v_mfma_f32_16x16x32_bf16 v[12:15], v[124:127], v[176:179], v[12:15]
    ds_read_b128 v[148:151], v9 offset:34816
    v_mul_f32 v78, v202, v82
    v_mfma_f32_16x16x32_bf16 v[16:19], v[124:127], v[180:183], v[16:19]
    s_waitcnt lgkmcnt(4)
    ds_read_b128 v[88:91], v211 offset:128
    v_mul_f32 v79, v202, v83
    v_mfma_f32_16x16x32_bf16 v[20:23], v[128:131], v[176:179], v[20:23]
    ds_read_b128 v[124:127], v9 offset:35840
    v_mul_f32 v80, v203, v80
    v_mfma_f32_16x16x32_bf16 v[24:27], v[128:131], v[180:183], v[24:27]
    buffer_load_dwordx4 v[168:171], v1, s[4:7], s72 offen offset:1024 sc1
    v_mfma_f32_16x16x32_bf16 v[28:31], v[132:135], v[176:179], v[28:31]
    ds_read_b128 v[128:131], v9 offset:36864
    v_mul_f32 v81, v203, v81
    v_mfma_f32_16x16x32_bf16 v[32:35], v[132:135], v[180:183], v[32:35]
    s_waitcnt lgkmcnt(5)
    v_mul_f32 v82, v203, v82
    v_mul_f32 v83, v203, v83
    v_mfma_f32_16x16x32_bf16 v[36:39], v[136:139], v[176:179], v[36:39]
    s_waitcnt lgkmcnt(2)
    ds_read_b128 v[132:135], v9 offset:37888
    v_mfma_f32_16x16x32_bf16 v[40:43], v[136:139], v[180:183], v[40:43]
    buffer_load_dwordx4 v[172:175], v1, s[4:7], s73 offen offset:1024 sc1
    v_mfma_f32_16x16x32_bf16 v[44:47], v[140:143], v[176:179], v[44:47]
    ds_read_b128 v[136:139], v9 offset:38912
    v_fmac_f32 v28, v200, v88
    v_mfma_f32_16x16x32_bf16 v[48:51], v[140:143], v[180:183], v[48:51]
    v_fmac_f32 v29, v200, v89
    v_fmac_f32 v30, v200, v90
    v_mfma_f32_16x16x32_bf16 v[52:55], v[144:147], v[176:179], v[52:55]
    ds_read_b128 v[140:143], v9 offset:39936
    v_fmac_f32 v31, v200, v91
    v_mfma_f32_16x16x32_bf16 v[56:59], v[144:147], v[180:183], v[56:59]
    v_fmac_f32 v32, v201, v88
    v_fmac_f32 v33, v201, v89
    v_mfma_f32_16x16x32_bf16 v[60:63], v[148:151], v[176:179], v[60:63]
    s_waitcnt vmcnt(6)
    ds_read_b128 v[144:147], v9 offset:40960
    v_fmac_f32 v34, v201, v90
    v_mfma_f32_16x16x32_bf16 v[64:67], v[148:151], v[180:183], v[64:67]
    s_waitcnt lgkmcnt(5)
    v_fmac_f32 v35, v201, v91
    v_mfma_f32_16x16x32_bf16 v[12:15], v[124:127], v[184:187], v[12:15]
    ds_read_b128 v[148:151], v9 offset:41984
    v_mul_f32 v84, v202, v88
    v_mfma_f32_16x16x32_bf16 v[16:19], v[124:127], v[188:191], v[16:19]
    s_waitcnt lgkmcnt(4)
    ds_read_b128 v[96:99], v211 offset:192
    v_mul_f32 v85, v202, v89
    v_mfma_f32_16x16x32_bf16 v[20:23], v[128:131], v[184:187], v[20:23]
    ds_read_b128 v[124:127], v9 offset:43008
    v_mul_f32 v86, v202, v90
    v_mfma_f32_16x16x32_bf16 v[24:27], v[128:131], v[188:191], v[24:27]
    buffer_load_dwordx4 v[176:179], v1, s[4:7], s72 offen offset:2048 sc1
    v_mfma_f32_16x16x32_bf16 v[28:31], v[132:135], v[184:187], v[28:31]
    ds_read_b128 v[128:131], v9 offset:44032
    v_mul_f32 v87, v202, v91
    v_mfma_f32_16x16x32_bf16 v[32:35], v[132:135], v[188:191], v[32:35]
    s_waitcnt lgkmcnt(5)
    v_mul_f32 v88, v203, v88
    v_mul_f32 v89, v203, v89
    v_mfma_f32_16x16x32_bf16 v[36:39], v[136:139], v[184:187], v[36:39]
    ds_read_b128 v[132:135], v9 offset:45056
    v_mul_f32 v90, v203, v90
    v_mfma_f32_16x16x32_bf16 v[40:43], v[136:139], v[188:191], v[40:43]
    buffer_load_dwordx4 v[180:183], v1, s[4:7], s73 offen offset:2048 sc1
    v_mfma_f32_16x16x32_bf16 v[44:47], v[140:143], v[184:187], v[44:47]
    s_waitcnt lgkmcnt(3)
    ds_read_b128 v[136:139], v9 offset:46080
    v_mul_f32 v91, v203, v91
    v_mfma_f32_16x16x32_bf16 v[48:51], v[140:143], v[188:191], v[48:51]
    v_mfma_f32_16x16x32_bf16 v[52:55], v[144:147], v[184:187], v[52:55]
    ds_read_b128 v[140:143], v9 offset:47104
    v_fmac_f32 v36, v200, v96
    v_mfma_f32_16x16x32_bf16 v[56:59], v[144:147], v[188:191], v[56:59]
    v_fmac_f32 v37, v200, v97
    v_fmac_f32 v38, v200, v98
    v_mfma_f32_16x16x32_bf16 v[60:63], v[148:151], v[184:187], v[60:63]
    s_waitcnt vmcnt(6)
    ds_read_b128 v[144:147], v9 offset:48128
    v_fmac_f32 v39, v200, v99
    v_mfma_f32_16x16x32_bf16 v[64:67], v[148:151], v[188:191], v[64:67]
    s_waitcnt lgkmcnt(5)
    v_fmac_f32 v40, v201, v96
    v_fmac_f32 v41, v201, v97
    v_mfma_f32_16x16x32_bf16 v[12:15], v[124:127], v[152:155], v[12:15]
    ds_read_b128 v[148:151], v9 offset:49152
    v_fmac_f32 v42, v201, v98
    v_mfma_f32_16x16x32_bf16 v[16:19], v[124:127], v[156:159], v[16:19]
    s_waitcnt lgkmcnt(4)
    v_fmac_f32 v43, v201, v99
    v_mfma_f32_16x16x32_bf16 v[20:23], v[128:131], v[152:155], v[20:23]
    ds_read_b128 v[124:127], v9 offset:50176
    v_mul_f32 v92, v202, v96
    v_mfma_f32_16x16x32_bf16 v[24:27], v[128:131], v[156:159], v[24:27]
    buffer_load_dwordx4 v[184:187], v1, s[4:7], s72 offen offset:3072 sc1
    v_mfma_f32_16x16x32_bf16 v[28:31], v[132:135], v[152:155], v[28:31]
    ds_read_b128 v[128:131], v9 offset:51200
    v_mul_f32 v93, v202, v97
    v_mfma_f32_16x16x32_bf16 v[32:35], v[132:135], v[156:159], v[32:35]
    s_waitcnt lgkmcnt(4)
    ds_read_b128 v[104:107], v211 offset:256
    v_mul_f32 v94, v202, v98
    v_mfma_f32_16x16x32_bf16 v[36:39], v[136:139], v[152:155], v[36:39]
    ds_read_b128 v[132:135], v9 offset:52224
    v_mul_f32 v95, v202, v99
    v_mfma_f32_16x16x32_bf16 v[40:43], v[136:139], v[156:159], v[40:43]
    buffer_load_dwordx4 v[188:191], v1, s[4:7], s73 offen offset:3072 sc1
    v_mfma_f32_16x16x32_bf16 v[44:47], v[140:143], v[152:155], v[44:47]
    s_add_u32 s72, s72, 4096
    ds_read_b128 v[136:139], v9 offset:53248
    v_mul_f32 v96, v203, v96
    v_mfma_f32_16x16x32_bf16 v[48:51], v[140:143], v[156:159], v[48:51]
    s_waitcnt lgkmcnt(5)
    v_mul_f32 v97, v203, v97
    v_mul_f32 v98, v203, v98
    v_mfma_f32_16x16x32_bf16 v[52:55], v[144:147], v[152:155], v[52:55]
    s_waitcnt lgkmcnt(2)
    s_add_u32 s73, s73, 4096
    ds_read_b128 v[140:143], v9 offset:54272
    v_mfma_f32_16x16x32_bf16 v[56:59], v[144:147], v[156:159], v[56:59]
    v_mul_f32 v99, v203, v99
    v_mfma_f32_16x16x32_bf16 v[60:63], v[148:151], v[152:155], v[60:63]
    s_waitcnt vmcnt(6)
    ds_read_b128 v[144:147], v9 offset:55296
    v_fmac_f32 v44, v200, v104
    v_mfma_f32_16x16x32_bf16 v[64:67], v[148:151], v[156:159], v[64:67]
    v_fmac_f32 v45, v200, v105
    v_fmac_f32 v46, v200, v106
    v_mfma_f32_16x16x32_bf16 v[12:15], v[124:127], v[160:163], v[12:15]
    ds_read_b128 v[148:151], v9 offset:56320
    v_fmac_f32 v47, v200, v107
    v_mfma_f32_16x16x32_bf16 v[16:19], v[124:127], v[164:167], v[16:19]
    s_waitcnt lgkmcnt(4)
    v_fmac_f32 v48, v201, v104
    v_fmac_f32 v49, v201, v105
    v_mfma_f32_16x16x32_bf16 v[20:23], v[128:131], v[160:163], v[20:23]
    ds_read_b128 v[124:127], v9 offset:57344
    v_fmac_f32 v50, v201, v106
    v_mfma_f32_16x16x32_bf16 v[24:27], v[128:131], v[164:167], v[24:27]
    buffer_load_dwordx4 v[152:155], v1, s[4:7], s74 offen offset:0 sc1
    v_mfma_f32_16x16x32_bf16 v[28:31], v[132:135], v[160:163], v[28:31]
    ds_read_b128 v[128:131], v9 offset:58368
    v_fmac_f32 v51, v201, v107
    v_mfma_f32_16x16x32_bf16 v[32:35], v[132:135], v[164:167], v[32:35]
    s_waitcnt lgkmcnt(4)
    ds_read_b128 v[112:115], v211 offset:320
    v_mul_f32 v100, v202, v104
    v_mfma_f32_16x16x32_bf16 v[36:39], v[136:139], v[160:163], v[36:39]
    ds_read_b128 v[132:135], v9 offset:59392
    v_mul_f32 v101, v202, v105
    v_mfma_f32_16x16x32_bf16 v[40:43], v[136:139], v[164:167], v[40:43]
    buffer_load_dwordx4 v[156:159], v1, s[4:7], s75 offen offset:0 sc1
    v_mfma_f32_16x16x32_bf16 v[44:47], v[140:143], v[160:163], v[44:47]
    ds_read_b128 v[136:139], v9 offset:60416
    v_mul_f32 v102, v202, v106
    v_mfma_f32_16x16x32_bf16 v[48:51], v[140:143], v[164:167], v[48:51]
    s_waitcnt lgkmcnt(5)
    v_mul_f32 v103, v202, v107
    v_mul_f32 v104, v203, v104
    v_mfma_f32_16x16x32_bf16 v[52:55], v[144:147], v[160:163], v[52:55]
    ds_read_b128 v[140:143], v9 offset:61440
    v_mul_f32 v105, v203, v105
    v_mfma_f32_16x16x32_bf16 v[56:59], v[144:147], v[164:167], v[56:59]
    v_mul_f32 v106, v203, v106
    v_mul_f32 v107, v203, v107
    v_mfma_f32_16x16x32_bf16 v[60:63], v[148:151], v[160:163], v[60:63]
    s_waitcnt lgkmcnt(3)
    s_waitcnt vmcnt(6)
    ds_read_b128 v[144:147], v9 offset:62464
    v_mfma_f32_16x16x32_bf16 v[64:67], v[148:151], v[164:167], v[64:67]
    v_mfma_f32_16x16x32_bf16 v[12:15], v[124:127], v[168:171], v[12:15]
    ds_read_b128 v[148:151], v9 offset:63488
    v_fmac_f32 v52, v200, v112
    v_mfma_f32_16x16x32_bf16 v[16:19], v[124:127], v[172:175], v[16:19]
    s_waitcnt lgkmcnt(4)
    v_fmac_f32 v53, v200, v113
    v_fmac_f32 v54, v200, v114
    v_mfma_f32_16x16x32_bf16 v[20:23], v[128:131], v[168:171], v[20:23]
    ds_read_b128 v[124:127], v10 offset:0
    v_fmac_f32 v55, v200, v115
    v_mfma_f32_16x16x32_bf16 v[24:27], v[128:131], v[172:175], v[24:27]
    buffer_load_dwordx4 v[160:163], v1, s[4:7], s74 offen offset:1024 sc1
    v_mfma_f32_16x16x32_bf16 v[28:31], v[132:135], v[168:171], v[28:31]
    ds_read_b128 v[128:131], v10 offset:1024
    v_fmac_f32 v56, v201, v112
    v_mfma_f32_16x16x32_bf16 v[32:35], v[132:135], v[172:175], v[32:35]
    s_waitcnt lgkmcnt(4)
    v_fmac_f32 v57, v201, v113
    v_fmac_f32 v58, v201, v114
    v_mfma_f32_16x16x32_bf16 v[36:39], v[136:139], v[168:171], v[36:39]
    ds_read_b128 v[132:135], v10 offset:2048
    v_fmac_f32 v59, v201, v115
    v_mfma_f32_16x16x32_bf16 v[40:43], v[136:139], v[172:175], v[40:43]
    buffer_load_dwordx4 v[164:167], v1, s[4:7], s75 offen offset:1024 sc1
    v_mfma_f32_16x16x32_bf16 v[44:47], v[140:143], v[168:171], v[44:47]
    ds_read_b128 v[136:139], v10 offset:3072
    v_mul_f32 v108, v202, v112
    v_mfma_f32_16x16x32_bf16 v[48:51], v[140:143], v[172:175], v[48:51]
    s_waitcnt lgkmcnt(4)
    ds_read_b128 v[120:123], v211 offset:384
    v_mul_f32 v109, v202, v113
    v_mfma_f32_16x16x32_bf16 v[52:55], v[144:147], v[168:171], v[52:55]
    ds_read_b128 v[140:143], v10 offset:4096
    v_mul_f32 v110, v202, v114
    v_mfma_f32_16x16x32_bf16 v[56:59], v[144:147], v[172:175], v[56:59]
    v_mul_f32 v111, v202, v115
    v_mul_f32 v112, v203, v112
    v_mfma_f32_16x16x32_bf16 v[60:63], v[148:151], v[168:171], v[60:63]
    s_waitcnt vmcnt(6)
    ds_read_b128 v[144:147], v10 offset:5120
    v_mul_f32 v113, v203, v113
    v_mfma_f32_16x16x32_bf16 v[64:67], v[148:151], v[172:175], v[64:67]
    s_waitcnt lgkmcnt(6)
    v_mul_f32 v114, v203, v114
    v_mul_f32 v115, v203, v115
    v_mfma_f32_16x16x32_bf16 v[12:15], v[124:127], v[176:179], v[12:15]
    s_waitcnt lgkmcnt(2)
    ds_read_b128 v[148:151], v10 offset:6144
    v_mfma_f32_16x16x32_bf16 v[16:19], v[124:127], v[180:183], v[16:19]
    v_mfma_f32_16x16x32_bf16 v[20:23], v[128:131], v[176:179], v[20:23]
    ds_read_b128 v[124:127], v10 offset:7168
    v_fmac_f32 v60, v200, v120
    v_mfma_f32_16x16x32_bf16 v[24:27], v[128:131], v[180:183], v[24:27]
    buffer_load_dwordx4 v[168:171], v1, s[4:7], s74 offen offset:2048 sc1
    v_mfma_f32_16x16x32_bf16 v[28:31], v[132:135], v[176:179], v[28:31]
    ds_read_b128 v[128:131], v10 offset:8192
    v_fmac_f32 v61, v200, v121
    v_mfma_f32_16x16x32_bf16 v[32:35], v[132:135], v[180:183], v[32:35]
    s_waitcnt lgkmcnt(4)
    v_fmac_f32 v62, v200, v122
    v_fmac_f32 v63, v200, v123
    v_mfma_f32_16x16x32_bf16 v[36:39], v[136:139], v[176:179], v[36:39]
    ds_read_b128 v[132:135], v10 offset:9216
    v_fmac_f32 v64, v201, v120
    v_mfma_f32_16x16x32_bf16 v[40:43], v[136:139], v[180:183], v[40:43]
    buffer_load_dwordx4 v[172:175], v1, s[4:7], s75 offen offset:2048 sc1
    v_mfma_f32_16x16x32_bf16 v[44:47], v[140:143], v[176:179], v[44:47]
    ds_read_b128 v[136:139], v10 offset:10240
    v_fmac_f32 v65, v201, v121
    v_mfma_f32_16x16x32_bf16 v[48:51], v[140:143], v[180:183], v[48:51]
    s_waitcnt lgkmcnt(4)
    v_fmac_f32 v66, v201, v122
    v_fmac_f32 v67, v201, v123
    v_mfma_f32_16x16x32_bf16 v[52:55], v[144:147], v[176:179], v[52:55]
    ds_read_b128 v[140:143], v10 offset:11264
    v_mul_f32 v116, v202, v120
    v_mfma_f32_16x16x32_bf16 v[56:59], v[144:147], v[180:183], v[56:59]
    v_mul_f32 v117, v202, v121
    v_mul_f32 v118, v202, v122
    v_mfma_f32_16x16x32_bf16 v[60:63], v[148:151], v[176:179], v[60:63]
    s_waitcnt vmcnt(6)
    ds_read_b128 v[144:147], v10 offset:12288
    v_mul_f32 v119, v202, v123
    v_mfma_f32_16x16x32_bf16 v[64:67], v[148:151], v[180:183], v[64:67]
    s_waitcnt lgkmcnt(5)
    v_mul_f32 v120, v203, v120
    v_mul_f32 v121, v203, v121
    v_mfma_f32_16x16x32_bf16 v[12:15], v[124:127], v[184:187], v[12:15]
    ds_read_b128 v[148:151], v10 offset:13312
    v_mul_f32 v122, v203, v122
    v_mfma_f32_16x16x32_bf16 v[16:19], v[124:127], v[188:191], v[16:19]
    s_waitcnt lgkmcnt(4)
    v_mul_f32 v123, v203, v123
    v_mfma_f32_16x16x32_bf16 v[20:23], v[128:131], v[184:187], v[20:23]
    ds_read_b128 v[124:127], v1 offset:0
    v_mfma_f32_16x16x32_bf16 v[24:27], v[128:131], v[188:191], v[24:27]
    buffer_load_dwordx4 v[176:179], v1, s[4:7], s74 offen offset:3072 sc1
    v_mfma_f32_16x16x32_bf16 v[28:31], v[132:135], v[184:187], v[28:31]
    ds_read_b128 v[128:131], v1 offset:1024
    v_mfma_f32_16x16x32_bf16 v[32:35], v[132:135], v[188:191], v[32:35]
    s_waitcnt lgkmcnt(4)
    v_mfma_f32_16x16x32_bf16 v[36:39], v[136:139], v[184:187], v[36:39]
    ds_read_b128 v[132:135], v1 offset:2048
    v_mfma_f32_16x16x32_bf16 v[40:43], v[136:139], v[188:191], v[40:43]
    buffer_load_dwordx4 v[180:183], v1, s[4:7], s75 offen offset:3072 sc1
    v_mfma_f32_16x16x32_bf16 v[44:47], v[140:143], v[184:187], v[44:47]
    s_add_u32 s74, s74, 4096
    ds_read_b128 v[136:139], v1 offset:3072
    v_mfma_f32_16x16x32_bf16 v[48:51], v[140:143], v[188:191], v[48:51]
    s_waitcnt lgkmcnt(4)
    v_mfma_f32_16x16x32_bf16 v[52:55], v[144:147], v[184:187], v[52:55]
    s_add_u32 s75, s75, 4096
    ds_read_b128 v[140:143], v1 offset:4096
    v_mfma_f32_16x16x32_bf16 v[56:59], v[144:147], v[188:191], v[56:59]
    v_mfma_f32_16x16x32_bf16 v[60:63], v[148:151], v[184:187], v[60:63]
    s_waitcnt vmcnt(6)
    ds_read_b128 v[144:147], v1 offset:5120
    v_mfma_f32_16x16x32_bf16 v[64:67], v[148:151], v[188:191], v[64:67]
    s_waitcnt lgkmcnt(5)
    v_mfma_f32_16x16x32_bf16 v[68:71], v[124:127], v[152:155], v[68:71]
    ds_read_b128 v[148:151], v1 offset:6144
    v_mfma_f32_16x16x32_bf16 v[72:75], v[124:127], v[156:159], v[72:75]
    s_waitcnt lgkmcnt(4)
    v_mfma_f32_16x16x32_bf16 v[76:79], v[128:131], v[152:155], v[76:79]
    ds_read_b128 v[124:127], v1 offset:7168
    v_mfma_f32_16x16x32_bf16 v[80:83], v[128:131], v[156:159], v[80:83]
    buffer_load_dwordx4 v[184:187], v1, s[4:7], s74 offen offset:0 sc1
    v_mfma_f32_16x16x32_bf16 v[84:87], v[132:135], v[152:155], v[84:87]
    ds_read_b128 v[128:131], v1 offset:8192
    v_mul_f32 v28, v12, v28
    v_mfma_f32_16x16x32_bf16 v[88:91], v[132:135], v[156:159], v[88:91]
    s_waitcnt lgkmcnt(4)
    v_mul_f32 v29, v13, v29
    v_mul_f32 v30, v14, v30
    v_mfma_f32_16x16x32_bf16 v[92:95], v[136:139], v[152:155], v[92:95]
    ds_read_b128 v[132:135], v1 offset:9216
    v_mul_f32 v31, v15, v31
    v_mfma_f32_16x16x32_bf16 v[96:99], v[136:139], v[156:159], v[96:99]
    buffer_load_dwordx4 v[188:191], v1, s[4:7], s75 offen offset:0 sc1
    v_mfma_f32_16x16x32_bf16 v[100:103], v[140:143], v[152:155], v[100:103]
    ds_read_b128 v[136:139], v1 offset:10240
    v_mul_f32 v12, v12, v192
    v_mfma_f32_16x16x32_bf16 v[104:107], v[140:143], v[156:159], v[104:107]
    s_waitcnt lgkmcnt(4)
    v_exp_f32 v12, v12
    v_mfma_f32_16x16x32_bf16 v[108:111], v[144:147], v[152:155], v[108:111]
    ds_read_b128 v[140:143], v1 offset:11264
    v_mul_f32 v13, v13, v192
    v_mfma_f32_16x16x32_bf16 v[112:115], v[144:147], v[156:159], v[112:115]
    v_exp_f32 v13, v13
    v_mfma_f32_16x16x32_bf16 v[116:119], v[148:151], v[152:155], v[116:119]
    s_waitcnt vmcnt(6)
    ds_read_b128 v[144:147], v1 offset:12288
    v_mul_f32 v14, v14, v192
    v_mfma_f32_16x16x32_bf16 v[120:123], v[148:151], v[156:159], v[120:123]
    s_waitcnt lgkmcnt(5)
    v_exp_f32 v14, v14
    v_mfma_f32_16x16x32_bf16 v[68:71], v[124:127], v[160:163], v[68:71]
    ds_read_b128 v[148:151], v1 offset:13312
    v_mul_f32 v15, v15, v192
    v_mfma_f32_16x16x32_bf16 v[72:75], v[124:127], v[164:167], v[72:75]
    s_waitcnt lgkmcnt(4)
    v_exp_f32 v15, v15
    v_mfma_f32_16x16x32_bf16 v[76:79], v[128:131], v[160:163], v[76:79]
    ds_read_b128 v[124:127], v1 offset:14336
    v_fma_f32 v12, v12, v196, v196
    v_mfma_f32_16x16x32_bf16 v[80:83], v[128:131], v[164:167], v[80:83]
    buffer_load_dwordx4 v[152:155], v1, s[4:7], s74 offen offset:1024 sc1
    v_mfma_f32_16x16x32_bf16 v[84:87], v[132:135], v[160:163], v[84:87]
    ds_read_b128 v[128:131], v1 offset:15360
    v_fma_f32 v13, v13, v196, v196
    v_mfma_f32_16x16x32_bf16 v[88:91], v[132:135], v[164:167], v[88:91]
    s_waitcnt lgkmcnt(4)
    v_rcp_f32 v12, v12
    v_mfma_f32_16x16x32_bf16 v[92:95], v[136:139], v[160:163], v[92:95]
    ds_read_b128 v[132:135], v1 offset:16384
    v_fma_f32 v14, v14, v196, v196
    v_mfma_f32_16x16x32_bf16 v[96:99], v[136:139], v[164:167], v[96:99]
    buffer_load_dwordx4 v[156:159], v1, s[4:7], s75 offen offset:1024 sc1
    v_mfma_f32_16x16x32_bf16 v[100:103], v[140:143], v[160:163], v[100:103]
    ds_read_b128 v[136:139], v1 offset:17408
    v_fma_f32 v15, v15, v196, v196
    v_mfma_f32_16x16x32_bf16 v[104:107], v[140:143], v[164:167], v[104:107]
    s_waitcnt lgkmcnt(4)
    v_rcp_f32 v13, v13
    v_mfma_f32_16x16x32_bf16 v[108:111], v[144:147], v[160:163], v[108:111]
    ds_read_b128 v[140:143], v1 offset:18432
    v_mul_f32 v28, v28, v12
    v_mfma_f32_16x16x32_bf16 v[112:115], v[144:147], v[164:167], v[112:115]
    v_rcp_f32 v14, v14
    v_mfma_f32_16x16x32_bf16 v[116:119], v[148:151], v[160:163], v[116:119]
    s_waitcnt vmcnt(6)
    ds_read_b128 v[144:147], v1 offset:19456
    v_mul_f32 v29, v29, v13
    v_mfma_f32_16x16x32_bf16 v[120:123], v[148:151], v[164:167], v[120:123]
    s_waitcnt lgkmcnt(5)
    v_rcp_f32 v15, v15
    v_mfma_f32_16x16x32_bf16 v[68:71], v[124:127], v[168:171], v[68:71]
    ds_read_b128 v[148:151], v1 offset:20480
    v_mul_f32 v30, v30, v14
    v_mfma_f32_16x16x32_bf16 v[72:75], v[124:127], v[172:175], v[72:75]
    s_waitcnt lgkmcnt(4)
    v_mul_f32 v31, v31, v15
    v_cvt_pk_bf16_f32 v12, v28, v29
    v_mfma_f32_16x16x32_bf16 v[76:79], v[128:131], v[168:171], v[76:79]
    ds_read_b128 v[124:127], v1 offset:21504
    v_cvt_pk_bf16_f32 v13, v30, v31
    v_mfma_f32_16x16x32_bf16 v[80:83], v[128:131], v[172:175], v[80:83]
    buffer_load_dwordx4 v[160:163], v1, s[4:7], s74 offen offset:2048 sc1
    v_mfma_f32_16x16x32_bf16 v[84:87], v[132:135], v[168:171], v[84:87]
    ds_read_b128 v[128:131], v1 offset:22528
    v_mul_f32 v36, v20, v36
    v_mfma_f32_16x16x32_bf16 v[88:91], v[132:135], v[172:175], v[88:91]
    s_waitcnt lgkmcnt(4)
    v_mul_f32 v37, v21, v37
    v_mul_f32 v38, v22, v38
    v_mfma_f32_16x16x32_bf16 v[92:95], v[136:139], v[168:171], v[92:95]
    ds_read_b128 v[132:135], v1 offset:23552
    v_mul_f32 v39, v23, v39
    v_mfma_f32_16x16x32_bf16 v[96:99], v[136:139], v[172:175], v[96:99]
    buffer_load_dwordx4 v[164:167], v1, s[4:7], s75 offen offset:2048 sc1
    v_mfma_f32_16x16x32_bf16 v[100:103], v[140:143], v[168:171], v[100:103]
    ds_read_b128 v[136:139], v1 offset:24576
    v_mul_f32 v20, v20, v192
    v_mfma_f32_16x16x32_bf16 v[104:107], v[140:143], v[172:175], v[104:107]
    s_waitcnt lgkmcnt(4)
    v_exp_f32 v20, v20
    v_mfma_f32_16x16x32_bf16 v[108:111], v[144:147], v[168:171], v[108:111]
    ds_read_b128 v[140:143], v1 offset:25600
    v_mul_f32 v21, v21, v192
    v_mfma_f32_16x16x32_bf16 v[112:115], v[144:147], v[172:175], v[112:115]
    v_exp_f32 v21, v21
    v_mfma_f32_16x16x32_bf16 v[116:119], v[148:151], v[168:171], v[116:119]
    s_waitcnt vmcnt(6)
    ds_read_b128 v[144:147], v1 offset:26624
    v_mul_f32 v22, v22, v192
    v_mfma_f32_16x16x32_bf16 v[120:123], v[148:151], v[172:175], v[120:123]
    s_waitcnt lgkmcnt(5)
    v_exp_f32 v22, v22
    v_mfma_f32_16x16x32_bf16 v[68:71], v[124:127], v[176:179], v[68:71]
    ds_read_b128 v[148:151], v1 offset:27648
    v_mul_f32 v23, v23, v192
    v_mfma_f32_16x16x32_bf16 v[72:75], v[124:127], v[180:183], v[72:75]
    s_waitcnt lgkmcnt(4)
    v_exp_f32 v23, v23
    v_mfma_f32_16x16x32_bf16 v[76:79], v[128:131], v[176:179], v[76:79]
    ds_read_b128 v[124:127], v1 offset:28672
    v_fma_f32 v20, v20, v196, v196
    v_mfma_f32_16x16x32_bf16 v[80:83], v[128:131], v[180:183], v[80:83]
    buffer_load_dwordx4 v[168:171], v1, s[4:7], s74 offen offset:3072 sc1
    v_mfma_f32_16x16x32_bf16 v[84:87], v[132:135], v[176:179], v[84:87]
    ds_read_b128 v[128:131], v1 offset:29696
    v_fma_f32 v21, v21, v196, v196
    v_mfma_f32_16x16x32_bf16 v[88:91], v[132:135], v[180:183], v[88:91]
    s_waitcnt lgkmcnt(4)
    v_rcp_f32 v20, v20
    v_mfma_f32_16x16x32_bf16 v[92:95], v[136:139], v[176:179], v[92:95]
    ds_read_b128 v[132:135], v1 offset:30720
    v_fma_f32 v22, v22, v196, v196
    v_mfma_f32_16x16x32_bf16 v[96:99], v[136:139], v[180:183], v[96:99]
    buffer_load_dwordx4 v[172:175], v1, s[4:7], s75 offen offset:3072 sc1
    v_mfma_f32_16x16x32_bf16 v[100:103], v[140:143], v[176:179], v[100:103]
    s_add_u32 s74, s74, 4096
    ds_read_b128 v[136:139], v1 offset:31744
    v_fma_f32 v23, v23, v196, v196
    v_mfma_f32_16x16x32_bf16 v[104:107], v[140:143], v[180:183], v[104:107]
    s_waitcnt lgkmcnt(4)
    v_rcp_f32 v21, v21
    v_mfma_f32_16x16x32_bf16 v[108:111], v[144:147], v[176:179], v[108:111]
    s_add_u32 s75, s75, 4096
    ds_read_b128 v[140:143], v1 offset:32768
    v_mul_f32 v36, v36, v20
    v_mfma_f32_16x16x32_bf16 v[112:115], v[144:147], v[180:183], v[112:115]
    v_rcp_f32 v22, v22
    v_mfma_f32_16x16x32_bf16 v[116:119], v[148:151], v[176:179], v[116:119]
    s_waitcnt vmcnt(6)
    ds_read_b128 v[144:147], v1 offset:33792
    v_mul_f32 v37, v37, v21
    v_mfma_f32_16x16x32_bf16 v[120:123], v[148:151], v[180:183], v[120:123]
    s_waitcnt lgkmcnt(5)
    v_rcp_f32 v23, v23
    v_mfma_f32_16x16x32_bf16 v[68:71], v[124:127], v[184:187], v[68:71]
    ds_read_b128 v[148:151], v1 offset:34816
    v_mul_f32 v38, v38, v22
    v_mfma_f32_16x16x32_bf16 v[72:75], v[124:127], v[188:191], v[72:75]
    s_waitcnt lgkmcnt(4)
    v_mul_f32 v39, v39, v23
    v_cvt_pk_bf16_f32 v14, v36, v37
    v_mfma_f32_16x16x32_bf16 v[76:79], v[128:131], v[184:187], v[76:79]
    ds_read_b128 v[124:127], v1 offset:35840
    v_cvt_pk_bf16_f32 v15, v38, v39
    v_mfma_f32_16x16x32_bf16 v[80:83], v[128:131], v[188:191], v[80:83]
    buffer_load_dwordx4 v[176:179], v1, s[4:7], s74 offen offset:0 sc1
    v_mfma_f32_16x16x32_bf16 v[84:87], v[132:135], v[184:187], v[84:87]
    ds_read_b128 v[128:131], v1 offset:36864
    v_mul_f32 v32, v16, v32
    v_mfma_f32_16x16x32_bf16 v[88:91], v[132:135], v[188:191], v[88:91]
    s_waitcnt lgkmcnt(4)
    buffer_store_dwordx4 v[12:15], v1, s[4:7], s76 offen sc1
    v_mfma_f32_16x16x32_bf16 v[92:95], v[136:139], v[184:187], v[92:95]
    ds_read_b128 v[132:135], v1 offset:37888
    v_mul_f32 v33, v17, v33
    v_mfma_f32_16x16x32_bf16 v[96:99], v[136:139], v[188:191], v[96:99]
    buffer_load_dwordx4 v[180:183], v1, s[4:7], s75 offen offset:0 sc1
    v_mfma_f32_16x16x32_bf16 v[100:103], v[140:143], v[184:187], v[100:103]
    ds_read_b128 v[136:139], v1 offset:38912
    v_mul_f32 v34, v18, v34
    v_mfma_f32_16x16x32_bf16 v[104:107], v[140:143], v[188:191], v[104:107]
    s_waitcnt lgkmcnt(4)
    v_mul_f32 v35, v19, v35
    v_mul_f32 v16, v16, v193
    v_mfma_f32_16x16x32_bf16 v[108:111], v[144:147], v[184:187], v[108:111]
    ds_read_b128 v[140:143], v1 offset:39936
    v_mul_f32 v17, v17, v193
    v_mfma_f32_16x16x32_bf16 v[112:115], v[144:147], v[188:191], v[112:115]
    v_exp_f32 v16, v16
    v_mfma_f32_16x16x32_bf16 v[116:119], v[148:151], v[184:187], v[116:119]
    s_waitcnt vmcnt(7)
    ds_read_b128 v[144:147], v1 offset:40960
    v_mul_f32 v18, v18, v193
    v_mfma_f32_16x16x32_bf16 v[120:123], v[148:151], v[188:191], v[120:123]
    s_waitcnt lgkmcnt(5)
    v_exp_f32 v17, v17
    v_mfma_f32_16x16x32_bf16 v[68:71], v[124:127], v[152:155], v[68:71]
    ds_read_b128 v[148:151], v1 offset:41984
    v_mul_f32 v19, v19, v193
    v_mfma_f32_16x16x32_bf16 v[72:75], v[124:127], v[156:159], v[72:75]
    s_waitcnt lgkmcnt(4)
    v_exp_f32 v18, v18
    v_mfma_f32_16x16x32_bf16 v[76:79], v[128:131], v[152:155], v[76:79]
    ds_read_b128 v[124:127], v1 offset:43008
    v_fma_f32 v16, v16, v197, v197
    v_mfma_f32_16x16x32_bf16 v[80:83], v[128:131], v[156:159], v[80:83]
    buffer_load_dwordx4 v[184:187], v1, s[4:7], s74 offen offset:1024 sc1
    v_mfma_f32_16x16x32_bf16 v[84:87], v[132:135], v[152:155], v[84:87]
    ds_read_b128 v[128:131], v1 offset:44032
    v_fma_f32 v17, v17, v197, v197
    v_mfma_f32_16x16x32_bf16 v[88:91], v[132:135], v[156:159], v[88:91]
    s_waitcnt lgkmcnt(4)
    v_exp_f32 v19, v19
    v_mfma_f32_16x16x32_bf16 v[92:95], v[136:139], v[152:155], v[92:95]
    ds_read_b128 v[132:135], v1 offset:45056
    v_fma_f32 v18, v18, v197, v197
    v_mfma_f32_16x16x32_bf16 v[96:99], v[136:139], v[156:159], v[96:99]
    buffer_load_dwordx4 v[188:191], v1, s[4:7], s75 offen offset:1024 sc1
    v_mfma_f32_16x16x32_bf16 v[100:103], v[140:143], v[152:155], v[100:103]
    ds_read_b128 v[136:139], v1 offset:46080
    v_fma_f32 v19, v19, v197, v197
    v_mfma_f32_16x16x32_bf16 v[104:107], v[140:143], v[156:159], v[104:107]
    s_waitcnt lgkmcnt(4)
    v_rcp_f32 v16, v16
    v_mfma_f32_16x16x32_bf16 v[108:111], v[144:147], v[152:155], v[108:111]
    ds_read_b128 v[140:143], v1 offset:47104
    v_mul_f32 v32, v32, v16
    v_mfma_f32_16x16x32_bf16 v[112:115], v[144:147], v[156:159], v[112:115]
    v_rcp_f32 v17, v17
    v_mfma_f32_16x16x32_bf16 v[116:119], v[148:151], v[152:155], v[116:119]
    s_waitcnt vmcnt(7)
    ds_read_b128 v[144:147], v1 offset:48128
    v_mul_f32 v33, v33, v17
    v_mfma_f32_16x16x32_bf16 v[120:123], v[148:151], v[156:159], v[120:123]
    s_waitcnt lgkmcnt(5)
    v_rcp_f32 v18, v18
    v_mfma_f32_16x16x32_bf16 v[68:71], v[124:127], v[160:163], v[68:71]
    ds_read_b128 v[148:151], v1 offset:49152
    v_mul_f32 v34, v34, v18
    v_mfma_f32_16x16x32_bf16 v[72:75], v[124:127], v[164:167], v[72:75]
    s_waitcnt lgkmcnt(4)
    v_rcp_f32 v19, v19
    v_mfma_f32_16x16x32_bf16 v[76:79], v[128:131], v[160:163], v[76:79]
    ds_read_b128 v[124:127], v1 offset:50176
    v_mul_f32 v35, v35, v19
    v_mfma_f32_16x16x32_bf16 v[80:83], v[128:131], v[164:167], v[80:83]
    buffer_load_dwordx4 v[152:155], v1, s[4:7], s74 offen offset:2048 sc1
    v_mfma_f32_16x16x32_bf16 v[84:87], v[132:135], v[160:163], v[84:87]
    ds_read_b128 v[128:131], v1 offset:51200
    v_cvt_pk_bf16_f32 v16, v32, v33
    v_mfma_f32_16x16x32_bf16 v[88:91], v[132:135], v[164:167], v[88:91]
    s_waitcnt lgkmcnt(4)
    v_cvt_pk_bf16_f32 v17, v34, v35
    v_mul_f32 v40, v24, v40
    v_mfma_f32_16x16x32_bf16 v[92:95], v[136:139], v[160:163], v[92:95]
    ds_read_b128 v[132:135], v1 offset:52224
    v_mul_f32 v41, v25, v41
    v_mfma_f32_16x16x32_bf16 v[96:99], v[136:139], v[164:167], v[96:99]
    buffer_load_dwordx4 v[156:159], v1, s[4:7], s75 offen offset:2048 sc1
    v_mfma_f32_16x16x32_bf16 v[100:103], v[140:143], v[160:163], v[100:103]
    ds_read_b128 v[136:139], v1 offset:53248
    v_mul_f32 v42, v26, v42
    v_mfma_f32_16x16x32_bf16 v[104:107], v[140:143], v[164:167], v[104:107]
    s_waitcnt lgkmcnt(4)
    v_mul_f32 v43, v27, v43
    v_mul_f32 v24, v24, v193
    v_mfma_f32_16x16x32_bf16 v[108:111], v[144:147], v[160:163], v[108:111]
    ds_read_b128 v[140:143], v1 offset:54272
    v_mul_f32 v25, v25, v193
    v_mfma_f32_16x16x32_bf16 v[112:115], v[144:147], v[164:167], v[112:115]
    v_exp_f32 v24, v24
    v_mfma_f32_16x16x32_bf16 v[116:119], v[148:151], v[160:163], v[116:119]
    s_waitcnt vmcnt(7)
    ds_read_b128 v[144:147], v1 offset:55296
    v_mul_f32 v26, v26, v193
    v_mfma_f32_16x16x32_bf16 v[120:123], v[148:151], v[164:167], v[120:123]
    s_waitcnt lgkmcnt(5)
    v_exp_f32 v25, v25
    v_mfma_f32_16x16x32_bf16 v[68:71], v[124:127], v[168:171], v[68:71]
    ds_read_b128 v[148:151], v1 offset:56320
    v_mul_f32 v27, v27, v193
    v_mfma_f32_16x16x32_bf16 v[72:75], v[124:127], v[172:175], v[72:75]
    s_waitcnt lgkmcnt(4)
    v_exp_f32 v26, v26
    v_mfma_f32_16x16x32_bf16 v[76:79], v[128:131], v[168:171], v[76:79]
    ds_read_b128 v[124:127], v1 offset:57344
    v_fma_f32 v24, v24, v197, v197
    v_mfma_f32_16x16x32_bf16 v[80:83], v[128:131], v[172:175], v[80:83]
    buffer_load_dwordx4 v[160:163], v1, s[4:7], s74 offen offset:3072 sc1
    v_mfma_f32_16x16x32_bf16 v[84:87], v[132:135], v[168:171], v[84:87]
    ds_read_b128 v[128:131], v1 offset:58368
    v_fma_f32 v25, v25, v197, v197
    v_mfma_f32_16x16x32_bf16 v[88:91], v[132:135], v[172:175], v[88:91]
    s_waitcnt lgkmcnt(4)
    v_exp_f32 v27, v27
    v_mfma_f32_16x16x32_bf16 v[92:95], v[136:139], v[168:171], v[92:95]
    ds_read_b128 v[132:135], v1 offset:59392
    v_fma_f32 v26, v26, v197, v197
    v_mfma_f32_16x16x32_bf16 v[96:99], v[136:139], v[172:175], v[96:99]
    buffer_load_dwordx4 v[164:167], v1, s[4:7], s75 offen offset:3072 sc1
    v_mfma_f32_16x16x32_bf16 v[100:103], v[140:143], v[168:171], v[100:103]
    s_add_u32 s74, s74, 4096
    ds_read_b128 v[136:139], v1 offset:60416
    v_fma_f32 v27, v27, v197, v197
    v_mfma_f32_16x16x32_bf16 v[104:107], v[140:143], v[172:175], v[104:107]
    s_waitcnt lgkmcnt(4)
    v_rcp_f32 v24, v24
    v_mfma_f32_16x16x32_bf16 v[108:111], v[144:147], v[168:171], v[108:111]
    s_add_u32 s75, s75, 4096
    ds_read_b128 v[140:143], v1 offset:61440
    v_mul_f32 v40, v40, v24
    v_mfma_f32_16x16x32_bf16 v[112:115], v[144:147], v[172:175], v[112:115]
    v_rcp_f32 v25, v25
    v_mfma_f32_16x16x32_bf16 v[116:119], v[148:151], v[168:171], v[116:119]
    s_waitcnt vmcnt(6)
    ds_read_b128 v[144:147], v1 offset:62464
    v_mul_f32 v41, v41, v25
    v_mfma_f32_16x16x32_bf16 v[120:123], v[148:151], v[172:175], v[120:123]
    s_waitcnt lgkmcnt(5)
    v_rcp_f32 v26, v26
    v_mfma_f32_16x16x32_bf16 v[68:71], v[124:127], v[176:179], v[68:71]
    ds_read_b128 v[148:151], v1 offset:63488
    v_mul_f32 v42, v42, v26
    v_mfma_f32_16x16x32_bf16 v[72:75], v[124:127], v[180:183], v[72:75]
    s_waitcnt lgkmcnt(4)
    v_rcp_f32 v27, v27
    v_mfma_f32_16x16x32_bf16 v[76:79], v[128:131], v[176:179], v[76:79]
    ds_read_b128 v[124:127], v9 offset:0
    v_mul_f32 v43, v43, v27
    v_mfma_f32_16x16x32_bf16 v[80:83], v[128:131], v[180:183], v[80:83]
    buffer_load_dwordx4 v[168:171], v1, s[4:7], s74 offen offset:0 sc1
    v_mfma_f32_16x16x32_bf16 v[84:87], v[132:135], v[176:179], v[84:87]
    ds_read_b128 v[128:131], v9 offset:1024
    v_cvt_pk_bf16_f32 v18, v40, v41
    v_mfma_f32_16x16x32_bf16 v[88:91], v[132:135], v[180:183], v[88:91]
    s_waitcnt lgkmcnt(4)
    v_cvt_pk_bf16_f32 v19, v42, v43
    v_mul_f32 v52, v44, v52
    v_mfma_f32_16x16x32_bf16 v[92:95], v[136:139], v[176:179], v[92:95]
    ds_read_b128 v[132:135], v9 offset:2048
    v_mul_f32 v53, v45, v53
    v_mfma_f32_16x16x32_bf16 v[96:99], v[136:139], v[180:183], v[96:99]
    buffer_load_dwordx4 v[172:175], v1, s[4:7], s75 offen offset:0 sc1
    v_mfma_f32_16x16x32_bf16 v[100:103], v[140:143], v[176:179], v[100:103]
    ds_read_b128 v[136:139], v9 offset:3072
    v_mul_f32 v54, v46, v54
    v_mfma_f32_16x16x32_bf16 v[104:107], v[140:143], v[180:183], v[104:107]
    s_waitcnt lgkmcnt(4)
    buffer_store_dwordx4 v[16:19], v1, s[4:7], s77 offen sc1
    v_mfma_f32_16x16x32_bf16 v[108:111], v[144:147], v[176:179], v[108:111]
    ds_read_b128 v[140:143], v9 offset:4096
    v_mul_f32 v55, v47, v55
    v_mfma_f32_16x16x32_bf16 v[112:115], v[144:147], v[180:183], v[112:115]
    v_mul_f32 v44, v44, v192
    v_mul_f32 v45, v45, v192
    v_mfma_f32_16x16x32_bf16 v[116:119], v[148:151], v[176:179], v[116:119]
    s_waitcnt vmcnt(7)
    ds_read_b128 v[144:147], v9 offset:5120
    v_mul_f32 v46, v46, v192
    v_mfma_f32_16x16x32_bf16 v[120:123], v[148:151], v[180:183], v[120:123]
    s_waitcnt lgkmcnt(5)
    v_exp_f32 v44, v44
    v_mfma_f32_16x16x32_bf16 v[68:71], v[124:127], v[184:187], v[68:71]
    ds_read_b128 v[148:151], v9 offset:6144
    v_mul_f32 v47, v47, v192
    v_mfma_f32_16x16x32_bf16 v[72:75], v[124:127], v[188:191], v[72:75]
    s_waitcnt lgkmcnt(4)
    v_exp_f32 v45, v45
    v_mfma_f32_16x16x32_bf16 v[76:79], v[128:131], v[184:187], v[76:79]
    ds_read_b128 v[124:127], v9 offset:7168
    v_fma_f32 v44, v44, v196, v196
    v_mfma_f32_16x16x32_bf16 v[80:83], v[128:131], v[188:191], v[80:83]
    buffer_load_dwordx4 v[176:179], v1, s[4:7], s74 offen offset:1024 sc1
    v_mfma_f32_16x16x32_bf16 v[84:87], v[132:135], v[184:187], v[84:87]
    ds_read_b128 v[128:131], v9 offset:8192
    v_fma_f32 v45, v45, v196, v196
    v_mfma_f32_16x16x32_bf16 v[88:91], v[132:135], v[188:191], v[88:91]
    s_waitcnt lgkmcnt(4)
    v_exp_f32 v46, v46
    v_mfma_f32_16x16x32_bf16 v[92:95], v[136:139], v[184:187], v[92:95]
    ds_read_b128 v[132:135], v9 offset:9216
    v_fma_f32 v46, v46, v196, v196
    v_mfma_f32_16x16x32_bf16 v[96:99], v[136:139], v[188:191], v[96:99]
    buffer_load_dwordx4 v[180:183], v1, s[4:7], s75 offen offset:1024 sc1
    v_mfma_f32_16x16x32_bf16 v[100:103], v[140:143], v[184:187], v[100:103]
    ds_read_b128 v[136:139], v9 offset:10240
    v_mul_f32 v56, v48, v56
    v_mfma_f32_16x16x32_bf16 v[104:107], v[140:143], v[188:191], v[104:107]
    s_waitcnt lgkmcnt(4)
    v_exp_f32 v47, v47
    v_mfma_f32_16x16x32_bf16 v[108:111], v[144:147], v[184:187], v[108:111]
    ds_read_b128 v[140:143], v9 offset:11264
    v_fma_f32 v47, v47, v196, v196
    v_mfma_f32_16x16x32_bf16 v[112:115], v[144:147], v[188:191], v[112:115]
    v_rcp_f32 v44, v44
    v_mfma_f32_16x16x32_bf16 v[116:119], v[148:151], v[184:187], v[116:119]
    s_waitcnt vmcnt(7)
    ds_read_b128 v[144:147], v9 offset:12288
    v_mul_f32 v52, v52, v44
    v_mfma_f32_16x16x32_bf16 v[120:123], v[148:151], v[188:191], v[120:123]
    s_waitcnt lgkmcnt(5)
    v_rcp_f32 v45, v45
    v_mfma_f32_16x16x32_bf16 v[68:71], v[124:127], v[152:155], v[68:71]
    ds_read_b128 v[148:151], v9 offset:13312
    v_mul_f32 v53, v53, v45
    v_mfma_f32_16x16x32_bf16 v[72:75], v[124:127], v[156:159], v[72:75]
    s_waitcnt lgkmcnt(4)
    v_rcp_f32 v46, v46
    v_mfma_f32_16x16x32_bf16 v[76:79], v[128:131], v[152:155], v[76:79]
    ds_read_b128 v[124:127], v9 offset:14336
    v_mul_f32 v54, v54, v46
    v_mfma_f32_16x16x32_bf16 v[80:83], v[128:131], v[156:159], v[80:83]
    buffer_load_dwordx4 v[184:187], v1, s[4:7], s74 offen offset:2048 sc1
    v_mfma_f32_16x16x32_bf16 v[84:87], v[132:135], v[152:155], v[84:87]
    ds_read_b128 v[128:131], v9 offset:15360
    v_cvt_pk_bf16_f32 v44, v52, v53
    v_mfma_f32_16x16x32_bf16 v[88:91], v[132:135], v[156:159], v[88:91]
    s_waitcnt lgkmcnt(4)
    v_rcp_f32 v47, v47
    v_mfma_f32_16x16x32_bf16 v[92:95], v[136:139], v[152:155], v[92:95]
    ds_read_b128 v[132:135], v9 offset:16384
    v_mul_f32 v55, v55, v47
    v_mfma_f32_16x16x32_bf16 v[96:99], v[136:139], v[156:159], v[96:99]
    buffer_load_dwordx4 v[188:191], v1, s[4:7], s75 offen offset:2048 sc1
    v_mfma_f32_16x16x32_bf16 v[100:103], v[140:143], v[152:155], v[100:103]
    ds_read_b128 v[136:139], v9 offset:17408
    v_cvt_pk_bf16_f32 v45, v54, v55
    v_mfma_f32_16x16x32_bf16 v[104:107], v[140:143], v[156:159], v[104:107]
    s_waitcnt lgkmcnt(4)
    v_mul_f32 v57, v49, v57
    v_mul_f32 v58, v50, v58
    v_mfma_f32_16x16x32_bf16 v[108:111], v[144:147], v[152:155], v[108:111]
    ds_read_b128 v[140:143], v9 offset:18432
    v_mul_f32 v59, v51, v59
    v_mfma_f32_16x16x32_bf16 v[112:115], v[144:147], v[156:159], v[112:115]
    v_permlane32_swap_b32 v60, v64
    v_mfma_f32_16x16x32_bf16 v[116:119], v[148:151], v[152:155], v[116:119]
    s_waitcnt vmcnt(7)
    ds_read_b128 v[144:147], v9 offset:19456
    v_mul_f32 v48, v48, v193
    v_mfma_f32_16x16x32_bf16 v[120:123], v[148:151], v[156:159], v[120:123]
    s_waitcnt lgkmcnt(5)
    v_exp_f32 v48, v48
    v_mfma_f32_16x16x32_bf16 v[68:71], v[124:127], v[160:163], v[68:71]
    ds_read_b128 v[148:151], v9 offset:20480
    v_mul_f32 v49, v49, v193
    v_mfma_f32_16x16x32_bf16 v[72:75], v[124:127], v[164:167], v[72:75]
    s_waitcnt lgkmcnt(4)
    v_exp_f32 v49, v49
    v_mfma_f32_16x16x32_bf16 v[76:79], v[128:131], v[160:163], v[76:79]
    ds_read_b128 v[124:127], v9 offset:21504
    v_mul_f32 v50, v50, v193
    v_mfma_f32_16x16x32_bf16 v[80:83], v[128:131], v[164:167], v[80:83]
    buffer_load_dwordx4 v[152:155], v1, s[4:7], s74 offen offset:3072 sc1
    v_mfma_f32_16x16x32_bf16 v[84:87], v[132:135], v[160:163], v[84:87]
    ds_read_b128 v[128:131], v9 offset:22528
    v_mul_f32 v51, v51, v193
    v_mfma_f32_16x16x32_bf16 v[88:91], v[132:135], v[164:167], v[88:91]
    s_waitcnt lgkmcnt(4)
    v_exp_f32 v50, v50
    v_mfma_f32_16x16x32_bf16 v[92:95], v[136:139], v[160:163], v[92:95]
    ds_read_b128 v[132:135], v9 offset:23552
    v_fma_f32 v48, v48, v197, v197
    v_mfma_f32_16x16x32_bf16 v[96:99], v[136:139], v[164:167], v[96:99]
    buffer_load_dwordx4 v[156:159], v1, s[4:7], s75 offen offset:3072 sc1
    v_mfma_f32_16x16x32_bf16 v[100:103], v[140:143], v[160:163], v[100:103]
    s_add_u32 s74, s74, 4096
    ds_read_b128 v[136:139], v9 offset:24576
    v_fma_f32 v49, v49, v197, v197
    v_mfma_f32_16x16x32_bf16 v[104:107], v[140:143], v[164:167], v[104:107]
    s_waitcnt lgkmcnt(4)
    v_exp_f32 v51, v51
    v_mfma_f32_16x16x32_bf16 v[108:111], v[144:147], v[160:163], v[108:111]
    s_add_u32 s75, s75, 4096
    ds_read_b128 v[140:143], v9 offset:25600
    v_fma_f32 v50, v50, v197, v197
    v_mfma_f32_16x16x32_bf16 v[112:115], v[144:147], v[164:167], v[112:115]
    v_rcp_f32 v48, v48
    v_mfma_f32_16x16x32_bf16 v[116:119], v[148:151], v[160:163], v[116:119]
    s_waitcnt vmcnt(7)
    ds_read_b128 v[144:147], v9 offset:26624
    v_fma_f32 v51, v51, v197, v197
    v_mfma_f32_16x16x32_bf16 v[120:123], v[148:151], v[164:167], v[120:123]
    s_waitcnt lgkmcnt(5)
    v_rcp_f32 v49, v49
    v_mfma_f32_16x16x32_bf16 v[68:71], v[124:127], v[168:171], v[68:71]
    ds_read_b128 v[148:151], v9 offset:27648
    v_mul_f32 v56, v56, v48
    v_mfma_f32_16x16x32_bf16 v[72:75], v[124:127], v[172:175], v[72:75]
    s_waitcnt lgkmcnt(4)
    v_rcp_f32 v50, v50
    v_mfma_f32_16x16x32_bf16 v[76:79], v[128:131], v[168:171], v[76:79]
    ds_read_b128 v[124:127], v9 offset:28672
    v_mul_f32 v57, v57, v49
    v_mfma_f32_16x16x32_bf16 v[80:83], v[128:131], v[172:175], v[80:83]
    buffer_load_dwordx4 v[160:163], v1, s[4:7], s74 offen offset:0 sc1
    v_mfma_f32_16x16x32_bf16 v[84:87], v[132:135], v[168:171], v[84:87]
    ds_read_b128 v[128:131], v9 offset:29696
    v_mul_f32 v58, v58, v50
    v_mfma_f32_16x16x32_bf16 v[88:91], v[132:135], v[172:175], v[88:91]
    s_waitcnt lgkmcnt(4)
    v_rcp_f32 v51, v51
    v_mfma_f32_16x16x32_bf16 v[92:95], v[136:139], v[168:171], v[92:95]
    ds_read_b128 v[132:135], v9 offset:30720
    v_mul_f32 v59, v59, v51
    v_mfma_f32_16x16x32_bf16 v[96:99], v[136:139], v[172:175], v[96:99]
    buffer_load_dwordx4 v[164:167], v1, s[4:7], s75 offen offset:0 sc1
    v_mfma_f32_16x16x32_bf16 v[100:103], v[140:143], v[168:171], v[100:103]
    ds_read_b128 v[136:139], v9 offset:31744
    v_cvt_pk_bf16_f32 v46, v56, v57
    v_mfma_f32_16x16x32_bf16 v[104:107], v[140:143], v[172:175], v[104:107]
    s_waitcnt lgkmcnt(4)
    v_permlane32_swap_b32 v61, v65
    v_mfma_f32_16x16x32_bf16 v[108:111], v[144:147], v[168:171], v[108:111]
    ds_read_b128 v[140:143], v9 offset:32768
    v_cvt_pk_bf16_f32 v47, v58, v59
    v_mfma_f32_16x16x32_bf16 v[112:115], v[144:147], v[172:175], v[112:115]
    v_permlane32_swap_b32 v62, v66
    v_mfma_f32_16x16x32_bf16 v[116:119], v[148:151], v[168:171], v[116:119]
    s_waitcnt vmcnt(6)
    ds_read_b128 v[144:147], v9 offset:33792
    v_cndmask_b32 v206, v193, v192, s[66:67]
    v_mfma_f32_16x16x32_bf16 v[120:123], v[148:151], v[172:175], v[120:123]
    s_waitcnt lgkmcnt(5)
    v_permlane32_swap_b32 v63, v67
    v_mfma_f32_16x16x32_bf16 v[68:71], v[124:127], v[176:179], v[68:71]
    ds_read_b128 v[148:151], v9 offset:34816
    v_cndmask_b32 v207, v197, v196, s[66:67]
    v_mfma_f32_16x16x32_bf16 v[72:75], v[124:127], v[180:183], v[72:75]
    s_waitcnt lgkmcnt(4)
    v_permlane32_swap_b32 v44, v46
    v_mfma_f32_16x16x32_bf16 v[76:79], v[128:131], v[176:179], v[76:79]
    ds_read_b128 v[124:127], v9 offset:35840
    v_mul_f32 v64, v60, v64
    v_mfma_f32_16x16x32_bf16 v[80:83], v[128:131], v[180:183], v[80:83]
    buffer_load_dwordx4 v[168:171], v1, s[4:7], s74 offen offset:1024 sc1
    v_mfma_f32_16x16x32_bf16 v[84:87], v[132:135], v[176:179], v[84:87]
    ds_read_b128 v[128:131], v9 offset:36864
    v_mul_f32 v65, v61, v65
    v_mfma_f32_16x16x32_bf16 v[88:91], v[132:135], v[180:183], v[88:91]
    s_waitcnt lgkmcnt(4)
    v_permlane32_swap_b32 v45, v47
    v_mfma_f32_16x16x32_bf16 v[92:95], v[136:139], v[176:179], v[92:95]
    ds_read_b128 v[132:135], v9 offset:37888
    v_mul_f32 v66, v62, v66
    v_mfma_f32_16x16x32_bf16 v[96:99], v[136:139], v[180:183], v[96:99]
    buffer_load_dwordx4 v[172:175], v1, s[4:7], s75 offen offset:1024 sc1
    v_mfma_f32_16x16x32_bf16 v[100:103], v[140:143], v[176:179], v[100:103]
    ds_read_b128 v[136:139], v9 offset:38912
    v_mul_f32 v67, v63, v67
    v_mfma_f32_16x16x32_bf16 v[104:107], v[140:143], v[180:183], v[104:107]
    s_waitcnt lgkmcnt(4)
    buffer_store_dwordx4 v[44:47], v6, s[4:7], s76 offen sc1
    v_mfma_f32_16x16x32_bf16 v[108:111], v[144:147], v[176:179], v[108:111]
    ds_read_b128 v[140:143], v9 offset:39936
    v_mul_f32 v60, v60, v206
    v_mfma_f32_16x16x32_bf16 v[112:115], v[144:147], v[180:183], v[112:115]
    v_exp_f32 v60, v60
    v_mfma_f32_16x16x32_bf16 v[116:119], v[148:151], v[176:179], v[116:119]
    s_waitcnt vmcnt(7)
    ds_read_b128 v[144:147], v9 offset:40960
    v_mul_f32 v61, v61, v206
    v_mfma_f32_16x16x32_bf16 v[120:123], v[148:151], v[180:183], v[120:123]
    s_waitcnt lgkmcnt(5)
    v_exp_f32 v61, v61
    v_mfma_f32_16x16x32_bf16 v[68:71], v[124:127], v[184:187], v[68:71]
    ds_read_b128 v[148:151], v9 offset:41984
    v_mul_f32 v62, v62, v206
    v_mfma_f32_16x16x32_bf16 v[72:75], v[124:127], v[188:191], v[72:75]
    s_waitcnt lgkmcnt(4)
    v_exp_f32 v62, v62
    v_mfma_f32_16x16x32_bf16 v[76:79], v[128:131], v[184:187], v[76:79]
    ds_read_b128 v[124:127], v9 offset:43008
    v_mul_f32 v63, v63, v206
    v_mfma_f32_16x16x32_bf16 v[80:83], v[128:131], v[188:191], v[80:83]
    buffer_load_dwordx4 v[176:179], v1, s[4:7], s74 offen offset:2048 sc1
    v_mfma_f32_16x16x32_bf16 v[84:87], v[132:135], v[184:187], v[84:87]
    ds_read_b128 v[128:131], v9 offset:44032
    v_fma_f32 v60, v60, v207, v207
    v_mfma_f32_16x16x32_bf16 v[88:91], v[132:135], v[188:191], v[88:91]
    s_waitcnt lgkmcnt(4)
    v_exp_f32 v63, v63
    v_mfma_f32_16x16x32_bf16 v[92:95], v[136:139], v[184:187], v[92:95]
    ds_read_b128 v[132:135], v9 offset:45056
    v_fma_f32 v61, v61, v207, v207
    v_mfma_f32_16x16x32_bf16 v[96:99], v[136:139], v[188:191], v[96:99]
    buffer_load_dwordx4 v[180:183], v1, s[4:7], s75 offen offset:2048 sc1
    v_mfma_f32_16x16x32_bf16 v[100:103], v[140:143], v[184:187], v[100:103]
    ds_read_b128 v[136:139], v9 offset:46080
    v_fma_f32 v62, v62, v207, v207
    v_mfma_f32_16x16x32_bf16 v[104:107], v[140:143], v[188:191], v[104:107]
    s_waitcnt lgkmcnt(4)
    v_rcp_f32 v60, v60
    v_mfma_f32_16x16x32_bf16 v[108:111], v[144:147], v[184:187], v[108:111]
    ds_read_b128 v[140:143], v9 offset:47104
    v_fma_f32 v63, v63, v207, v207
    v_mfma_f32_16x16x32_bf16 v[112:115], v[144:147], v[188:191], v[112:115]
    v_rcp_f32 v61, v61
    v_mfma_f32_16x16x32_bf16 v[116:119], v[148:151], v[184:187], v[116:119]
    s_waitcnt vmcnt(7)
    ds_read_b128 v[144:147], v9 offset:48128
    v_mul_f32 v64, v64, v60
    v_mfma_f32_16x16x32_bf16 v[120:123], v[148:151], v[188:191], v[120:123]
    s_waitcnt lgkmcnt(5)
    v_rcp_f32 v62, v62
    v_mfma_f32_16x16x32_bf16 v[68:71], v[124:127], v[152:155], v[68:71]
    ds_read_b128 v[148:151], v9 offset:49152
    v_mul_f32 v65, v65, v61
    v_mfma_f32_16x16x32_bf16 v[72:75], v[124:127], v[156:159], v[72:75]
    s_waitcnt lgkmcnt(4)
    v_rcp_f32 v63, v63
    v_mfma_f32_16x16x32_bf16 v[76:79], v[128:131], v[152:155], v[76:79]
    ds_read_b128 v[124:127], v9 offset:50176
    v_mul_f32 v66, v66, v62
    v_mfma_f32_16x16x32_bf16 v[80:83], v[128:131], v[156:159], v[80:83]
    buffer_load_dwordx4 v[184:187], v1, s[4:7], s74 offen offset:3072 sc1
    v_mfma_f32_16x16x32_bf16 v[84:87], v[132:135], v[152:155], v[84:87]
    ds_read_b128 v[128:131], v9 offset:51200
    v_mul_f32 v67, v67, v63
    v_mfma_f32_16x16x32_bf16 v[88:91], v[132:135], v[156:159], v[88:91]
    s_waitcnt lgkmcnt(4)
    v_cvt_pk_bf16_f32 v60, v64, v65
    v_cvt_pk_bf16_f32 v61, v66, v67
    v_mfma_f32_16x16x32_bf16 v[92:95], v[136:139], v[152:155], v[92:95]
    ds_read_b128 v[132:135], v9 offset:52224
    v_and_b32 v200, 7, v0
    v_mfma_f32_16x16x32_bf16 v[96:99], v[136:139], v[156:159], v[96:99]
    buffer_load_dwordx4 v[188:191], v1, s[4:7], s75 offen offset:3072 sc1
    v_mfma_f32_16x16x32_bf16 v[100:103], v[140:143], v[152:155], v[100:103]
    s_add_u32 s74, s74, 4096
    ds_read_b128 v[136:139], v9 offset:53248
    v_lshlrev_b32 v200, 12, v200
    v_mfma_f32_16x16x32_bf16 v[104:107], v[140:143], v[156:159], v[104:107]
    s_waitcnt lgkmcnt(4)
    buffer_store_dwordx2 v[60:61], v7, s[4:7], s76 offen sc1
    v_mfma_f32_16x16x32_bf16 v[108:111], v[144:147], v[152:155], v[108:111]
    s_add_u32 s75, s75, 4096
    ds_read_b128 v[140:143], v9 offset:54272
    v_lshrrev_b32 v201, 3, v0
    v_mfma_f32_16x16x32_bf16 v[112:115], v[144:147], v[156:159], v[112:115]
    s_sub_u32 s69, s86, s4
    v_lshl_add_u32 v200, v201, 28, v200
    v_mov_b32 v201, 1
    v_mfma_f32_16x16x32_bf16 v[116:119], v[148:151], v[152:155], v[116:119]
    s_waitcnt vmcnt(8)
    ds_read_b128 v[144:147], v9 offset:55296
    s_add_u32 s69, s69, 131084
    v_mfma_f32_16x16x32_bf16 v[120:123], v[148:151], v[156:159], v[120:123]
    s_waitcnt lgkmcnt(5)
    s_mul_i32 s50, s40, 229376
    s_mul_i32 s51, s36, 14336
    v_mfma_f32_16x16x32_bf16 v[68:71], v[124:127], v[160:163], v[68:71]
    ds_read_b128 v[148:151], v9 offset:56320
    s_add_u32 s50, s50, s51
    v_mfma_f32_16x16x32_bf16 v[72:75], v[124:127], v[164:167], v[72:75]
    s_waitcnt lgkmcnt(4)
    s_add_u32 s50, s50, 30867456
    s_lshr_b32 s54, s36, 1
    v_mfma_f32_16x16x32_bf16 v[76:79], v[128:131], v[160:163], v[76:79]
    ds_read_b128 v[124:127], v9 offset:57344
    s_xor_b32 s54, s54, s36
    v_mfma_f32_16x16x32_bf16 v[80:83], v[128:131], v[164:167], v[80:83]
    s_and_b32 s54, s54, 1
    s_lshl_b32 s51, s39, 7
    s_xor_b32 s55, s54, 1
    v_mfma_f32_16x16x32_bf16 v[84:87], v[132:135], v[160:163], v[84:87]
    ds_read_b128 v[128:131], v9 offset:58368
    s_mul_i32 s52, s55, 57344
    v_mfma_f32_16x16x32_bf16 v[88:91], v[132:135], v[164:167], v[88:91]
    s_waitcnt lgkmcnt(4)
    s_add_u32 s52, s50, s52
    v_add_u32 v8, s52, v1
    v_mfma_f32_16x16x32_bf16 v[92:95], v[136:139], v[160:163], v[92:95]
    ds_read_b128 v[132:135], v9 offset:59392
    s_xor_b32 s55, s54, 0
    v_mfma_f32_16x16x32_bf16 v[96:99], v[136:139], v[164:167], v[96:99]
    s_mul_i32 s52, s55, 57344
    s_add_u32 s52, s50, s52
    v_add_u32 v208, s52, v1
    v_mfma_f32_16x16x32_bf16 v[100:103], v[140:143], v[160:163], v[100:103]
    ds_read_b128 v[136:139], v9 offset:60416
    s_xor_b32 s55, s54, 2
    v_mfma_f32_16x16x32_bf16 v[104:107], v[140:143], v[164:167], v[104:107]
    s_waitcnt lgkmcnt(4)
    s_mul_i32 s52, s55, 57344
    s_add_u32 s52, s50, s52
    v_mfma_f32_16x16x32_bf16 v[108:111], v[144:147], v[160:163], v[108:111]
    ds_read_b128 v[140:143], v9 offset:61440
    v_add_u32 v209, s52, v1
    v_mfma_f32_16x16x32_bf16 v[112:115], v[144:147], v[164:167], v[112:115]
    s_xor_b32 s55, s54, 3
    s_mul_i32 s52, s55, 57344
    s_add_u32 s52, s50, s52
    v_mfma_f32_16x16x32_bf16 v[116:119], v[148:151], v[160:163], v[116:119]
    s_waitcnt vmcnt(6)
    ds_read_b128 v[144:147], v9 offset:62464
    v_add_u32 v210, s52, v1
    v_mfma_f32_16x16x32_bf16 v[120:123], v[148:151], v[164:167], v[120:123]
    s_waitcnt lgkmcnt(5)
    v_mfma_f32_16x16x32_bf16 v[68:71], v[124:127], v[168:171], v[68:71]
    ds_read_b128 v[148:151], v9 offset:63488
    v_mfma_f32_16x16x32_bf16 v[72:75], v[124:127], v[172:175], v[72:75]
    s_waitcnt lgkmcnt(4)
    v_mfma_f32_16x16x32_bf16 v[76:79], v[128:131], v[168:171], v[76:79]
    ds_read_b128 v[124:127], v10 offset:0
    v_mfma_f32_16x16x32_bf16 v[80:83], v[128:131], v[172:175], v[80:83]
    v_mfma_f32_16x16x32_bf16 v[84:87], v[132:135], v[168:171], v[84:87]
    ds_read_b128 v[128:131], v10 offset:1024
    v_mfma_f32_16x16x32_bf16 v[88:91], v[132:135], v[172:175], v[88:91]
    s_waitcnt lgkmcnt(4)
    v_mfma_f32_16x16x32_bf16 v[92:95], v[136:139], v[168:171], v[92:95]
    ds_read_b128 v[132:135], v10 offset:2048
    v_mfma_f32_16x16x32_bf16 v[96:99], v[136:139], v[172:175], v[96:99]
    v_mfma_f32_16x16x32_bf16 v[100:103], v[140:143], v[168:171], v[100:103]
    ds_read_b128 v[136:139], v10 offset:3072
    v_mfma_f32_16x16x32_bf16 v[104:107], v[140:143], v[172:175], v[104:107]
    s_waitcnt lgkmcnt(4)
    v_mfma_f32_16x16x32_bf16 v[108:111], v[144:147], v[168:171], v[108:111]
    ds_read_b128 v[140:143], v10 offset:4096
    v_mfma_f32_16x16x32_bf16 v[112:115], v[144:147], v[172:175], v[112:115]
    v_mfma_f32_16x16x32_bf16 v[116:119], v[148:151], v[168:171], v[116:119]
    s_waitcnt vmcnt(3)
    ds_read_b128 v[144:147], v10 offset:5120
    v_mfma_f32_16x16x32_bf16 v[120:123], v[148:151], v[172:175], v[120:123]
    s_waitcnt lgkmcnt(5)
    v_mfma_f32_16x16x32_bf16 v[68:71], v[124:127], v[176:179], v[68:71]
    ds_read_b128 v[148:151], v10 offset:6144
    v_mfma_f32_16x16x32_bf16 v[72:75], v[124:127], v[180:183], v[72:75]
    s_waitcnt lgkmcnt(4)
    v_mfma_f32_16x16x32_bf16 v[76:79], v[128:131], v[176:179], v[76:79]
    ds_read_b128 v[124:127], v10 offset:7168
    v_mfma_f32_16x16x32_bf16 v[80:83], v[128:131], v[180:183], v[80:83]
    v_mfma_f32_16x16x32_bf16 v[84:87], v[132:135], v[176:179], v[84:87]
    ds_read_b128 v[128:131], v10 offset:8192
    v_mfma_f32_16x16x32_bf16 v[88:91], v[132:135], v[180:183], v[88:91]
    s_waitcnt lgkmcnt(4)
    v_mfma_f32_16x16x32_bf16 v[92:95], v[136:139], v[176:179], v[92:95]
    ds_read_b128 v[132:135], v10 offset:9216
    v_mfma_f32_16x16x32_bf16 v[96:99], v[136:139], v[180:183], v[96:99]
    v_mfma_f32_16x16x32_bf16 v[100:103], v[140:143], v[176:179], v[100:103]
    ds_read_b128 v[136:139], v10 offset:10240
    v_mfma_f32_16x16x32_bf16 v[104:107], v[140:143], v[180:183], v[104:107]
    s_waitcnt lgkmcnt(4)
    v_mfma_f32_16x16x32_bf16 v[108:111], v[144:147], v[176:179], v[108:111]
    ds_read_b128 v[140:143], v10 offset:11264
    v_mfma_f32_16x16x32_bf16 v[112:115], v[144:147], v[180:183], v[112:115]
    v_mfma_f32_16x16x32_bf16 v[116:119], v[148:151], v[176:179], v[116:119]
    s_waitcnt vmcnt(1)
    ds_read_b128 v[144:147], v10 offset:12288
    v_mfma_f32_16x16x32_bf16 v[120:123], v[148:151], v[180:183], v[120:123]
    s_waitcnt lgkmcnt(5)
    v_mfma_f32_16x16x32_bf16 v[68:71], v[124:127], v[184:187], v[68:71]
    ds_read_b128 v[148:151], v10 offset:13312
    v_mfma_f32_16x16x32_bf16 v[72:75], v[124:127], v[188:191], v[72:75]
    s_waitcnt lgkmcnt(4)
    v_mfma_f32_16x16x32_bf16 v[76:79], v[128:131], v[184:187], v[76:79]
    v_mfma_f32_16x16x32_bf16 v[80:83], v[128:131], v[188:191], v[80:83]
    v_mfma_f32_16x16x32_bf16 v[84:87], v[132:135], v[184:187], v[84:87]
    v_mfma_f32_16x16x32_bf16 v[88:91], v[132:135], v[188:191], v[88:91]
    s_waitcnt lgkmcnt(2)
    v_mfma_f32_16x16x32_bf16 v[92:95], v[136:139], v[184:187], v[92:95]
    v_mfma_f32_16x16x32_bf16 v[96:99], v[136:139], v[188:191], v[96:99]
    v_mfma_f32_16x16x32_bf16 v[100:103], v[140:143], v[184:187], v[100:103]
    v_mfma_f32_16x16x32_bf16 v[104:107], v[140:143], v[188:191], v[104:107]
    s_waitcnt lgkmcnt(0)
    v_mfma_f32_16x16x32_bf16 v[108:111], v[144:147], v[184:187], v[108:111]
    v_mfma_f32_16x16x32_bf16 v[112:115], v[144:147], v[188:191], v[112:115]
    v_mfma_f32_16x16x32_bf16 v[116:119], v[148:151], v[184:187], v[116:119]
    v_mfma_f32_16x16x32_bf16 v[120:123], v[148:151], v[188:191], v[120:123]
    s_waitcnt vmcnt(0)
    buffer_atomic_add v201, v200, s[4:7], s69 offen sc1
    v_pk_mul_f32 v[84:85], v[68:69], v[84:85]
    v_pk_mul_f32 v[86:87], v[70:71], v[86:87]
    v_pk_mul_f32 v[68:69], v[68:69], v[194:195] op_sel:[0,0] op_sel_hi:[1,0]
    v_pk_mul_f32 v[70:71], v[70:71], v[194:195] op_sel:[0,0] op_sel_hi:[1,0]
    v_exp_f32 v68, v68
    v_exp_f32 v69, v69
    v_exp_f32 v70, v70
    v_exp_f32 v71, v71
    v_pk_fma_f32 v[68:69], v[68:69], v[198:199], v[198:199] op_sel:[0,0,0] op_sel_hi:[1,0,0]
    v_pk_fma_f32 v[70:71], v[70:71], v[198:199], v[198:199] op_sel:[0,0,0] op_sel_hi:[1,0,0]
    v_rcp_f32 v68, v68
    v_rcp_f32 v69, v69
    v_rcp_f32 v70, v70
    v_rcp_f32 v71, v71
    v_pk_mul_f32 v[84:85], v[84:85], v[68:69]
    v_pk_mul_f32 v[86:87], v[86:87], v[70:71]
    v_cvt_pk_bf16_f32 v68, v84, v85
    v_cvt_pk_bf16_f32 v69, v86, v87
    v_pk_mul_f32 v[92:93], v[76:77], v[92:93]
    v_pk_mul_f32 v[94:95], v[78:79], v[94:95]
    v_pk_mul_f32 v[76:77], v[76:77], v[194:195] op_sel:[0,0] op_sel_hi:[1,0]
    v_pk_mul_f32 v[78:79], v[78:79], v[194:195] op_sel:[0,0] op_sel_hi:[1,0]
    v_exp_f32 v76, v76
    v_exp_f32 v77, v77
    v_exp_f32 v78, v78
    v_exp_f32 v79, v79
    v_pk_fma_f32 v[76:77], v[76:77], v[198:199], v[198:199] op_sel:[0,0,0] op_sel_hi:[1,0,0]
    v_pk_fma_f32 v[78:79], v[78:79], v[198:199], v[198:199] op_sel:[0,0,0] op_sel_hi:[1,0,0]
    v_rcp_f32 v76, v76
    v_rcp_f32 v77, v77
    v_rcp_f32 v78, v78
    v_rcp_f32 v79, v79
    v_pk_mul_f32 v[92:93], v[92:93], v[76:77]
    v_pk_mul_f32 v[94:95], v[94:95], v[78:79]
    v_cvt_pk_bf16_f32 v70, v92, v93
    v_cvt_pk_bf16_f32 v71, v94, v95
    buffer_store_dwordx4 v[68:71], v1, s[4:7], s78 offen sc1
    v_pk_mul_f32 v[88:89], v[72:73], v[88:89]
    v_pk_mul_f32 v[90:91], v[74:75], v[90:91]
    v_pk_mul_f32 v[72:73], v[72:73], v[194:195] op_sel:[0,1] op_sel_hi:[1,1]
    v_pk_mul_f32 v[74:75], v[74:75], v[194:195] op_sel:[0,1] op_sel_hi:[1,1]
    v_exp_f32 v72, v72
    v_exp_f32 v73, v73
    v_exp_f32 v74, v74
    v_exp_f32 v75, v75
    v_pk_fma_f32 v[72:73], v[72:73], v[198:199], v[198:199] op_sel:[0,1,1] op_sel_hi:[1,1,1]
    v_pk_fma_f32 v[74:75], v[74:75], v[198:199], v[198:199] op_sel:[0,1,1] op_sel_hi:[1,1,1]
    v_rcp_f32 v72, v72
    v_rcp_f32 v73, v73
    v_rcp_f32 v74, v74
    v_rcp_f32 v75, v75
    v_pk_mul_f32 v[88:89], v[88:89], v[72:73]
    v_pk_mul_f32 v[90:91], v[90:91], v[74:75]
    v_cvt_pk_bf16_f32 v72, v88, v89
    v_cvt_pk_bf16_f32 v73, v90, v91
    v_pk_mul_f32 v[96:97], v[80:81], v[96:97]
    v_pk_mul_f32 v[98:99], v[82:83], v[98:99]
    v_pk_mul_f32 v[80:81], v[80:81], v[194:195] op_sel:[0,1] op_sel_hi:[1,1]
    v_pk_mul_f32 v[82:83], v[82:83], v[194:195] op_sel:[0,1] op_sel_hi:[1,1]
    v_exp_f32 v80, v80
    v_exp_f32 v81, v81
    v_exp_f32 v82, v82
    v_exp_f32 v83, v83
    v_pk_fma_f32 v[80:81], v[80:81], v[198:199], v[198:199] op_sel:[0,1,1] op_sel_hi:[1,1,1]
    v_pk_fma_f32 v[82:83], v[82:83], v[198:199], v[198:199] op_sel:[0,1,1] op_sel_hi:[1,1,1]
    v_rcp_f32 v80, v80
    v_rcp_f32 v81, v81
    v_rcp_f32 v82, v82
    v_rcp_f32 v83, v83
    v_pk_mul_f32 v[96:97], v[96:97], v[80:81]
    s_load_dword s91, s[92:93], 131084 glc
    v_pk_mul_f32 v[98:99], v[98:99], v[82:83]
    v_cvt_pk_bf16_f32 v74, v96, v97
    v_cvt_pk_bf16_f32 v75, v98, v99
    buffer_store_dwordx4 v[72:75], v1, s[4:7], s79 offen sc1
    v_pk_mul_f32 v[108:109], v[100:101], v[108:109]
    v_pk_mul_f32 v[110:111], v[102:103], v[110:111]
    v_pk_mul_f32 v[100:101], v[100:101], v[194:195] op_sel:[0,0] op_sel_hi:[1,0]
    v_pk_mul_f32 v[102:103], v[102:103], v[194:195] op_sel:[0,0] op_sel_hi:[1,0]
    v_exp_f32 v100, v100
    v_exp_f32 v101, v101
    v_exp_f32 v102, v102
    v_exp_f32 v103, v103
    v_pk_fma_f32 v[100:101], v[100:101], v[198:199], v[198:199] op_sel:[0,0,0] op_sel_hi:[1,0,0]
    v_pk_fma_f32 v[102:103], v[102:103], v[198:199], v[198:199] op_sel:[0,0,0] op_sel_hi:[1,0,0]
    v_rcp_f32 v100, v100
    v_rcp_f32 v101, v101
    v_rcp_f32 v102, v102
    v_rcp_f32 v103, v103
    v_pk_mul_f32 v[108:109], v[108:109], v[100:101]
    v_pk_mul_f32 v[110:111], v[110:111], v[102:103]
    v_cvt_pk_bf16_f32 v100, v108, v109
    v_cvt_pk_bf16_f32 v101, v110, v111
    v_pk_mul_f32 v[112:113], v[104:105], v[112:113]
    v_pk_mul_f32 v[114:115], v[106:107], v[114:115]
    v_pk_mul_f32 v[104:105], v[104:105], v[194:195] op_sel:[0,1] op_sel_hi:[1,1]
    v_pk_mul_f32 v[106:107], v[106:107], v[194:195] op_sel:[0,1] op_sel_hi:[1,1]
    v_exp_f32 v104, v104
    v_exp_f32 v105, v105
    v_exp_f32 v106, v106
    v_exp_f32 v107, v107
    v_pk_fma_f32 v[104:105], v[104:105], v[198:199], v[198:199] op_sel:[0,1,1] op_sel_hi:[1,1,1]
    v_pk_fma_f32 v[106:107], v[106:107], v[198:199], v[198:199] op_sel:[0,1,1] op_sel_hi:[1,1,1]
    v_rcp_f32 v104, v104
    v_rcp_f32 v105, v105
    v_rcp_f32 v106, v106
    v_rcp_f32 v107, v107
    v_pk_mul_f32 v[112:113], v[112:113], v[104:105]
    v_pk_mul_f32 v[114:115], v[114:115], v[106:107]
    v_cvt_pk_bf16_f32 v102, v112, v113
    v_cvt_pk_bf16_f32 v103, v114, v115
    v_permlane32_swap_b32 v116, v120
    v_permlane32_swap_b32 v117, v121
    v_permlane32_swap_b32 v118, v122
    v_permlane32_swap_b32 v119, v123
    v_cndmask_b32 v206, v195, v194, s[66:67]
    v_cndmask_b32 v207, v199, v198, s[66:67]
    v_permlane32_swap_b32 v100, v102
    v_permlane32_swap_b32 v101, v103
    buffer_store_dwordx4 v[100:103], v6, s[4:7], s78 offen sc1
    v_pk_mul_f32 v[120:121], v[116:117], v[120:121]
    v_pk_mul_f32 v[122:123], v[118:119], v[122:123]
    v_pk_mul_f32 v[116:117], v[116:117], v[206:207] op_sel:[0,0] op_sel_hi:[1,0]
    v_pk_mul_f32 v[118:119], v[118:119], v[206:207] op_sel:[0,0] op_sel_hi:[1,0]
    v_exp_f32 v116, v116
    v_exp_f32 v117, v117
    v_exp_f32 v118, v118
    v_exp_f32 v119, v119
    v_pk_fma_f32 v[116:117], v[116:117], v[206:207], v[206:207] op_sel:[0,1,1] op_sel_hi:[1,1,1]
    v_pk_fma_f32 v[118:119], v[118:119], v[206:207], v[206:207] op_sel:[0,1,1] op_sel_hi:[1,1,1]
    v_rcp_f32 v116, v116
    v_rcp_f32 v117, v117
    v_rcp_f32 v118, v118
    v_rcp_f32 v119, v119
    v_pk_mul_f32 v[120:121], v[120:121], v[116:117]
    v_pk_mul_f32 v[122:123], v[122:123], v[118:119]
    v_cvt_pk_bf16_f32 v116, v120, v121
    v_cvt_pk_bf16_f32 v117, v122, v123
    buffer_store_dwordx2 v[116:117], v7, s[4:7], s78 offen sc1
    s_waitcnt lgkmcnt(0)
    s_cmp_ge_u32 s91, 8
    s_cbranch_scc1 POLLX22
    s_mov_b32 s68, 0
POLL21:
    s_load_dword s91, s[92:93], 131084 glc
    s_add_u32 s68, s68, 1
    s_waitcnt lgkmcnt(0)
    s_cmp_ge_u32 s91, 8
    s_cbranch_scc1 POLLX22
    s_cmp_lt_u32 s68, 400000
    s_cbranch_scc1 POLL21
POLLX22:
    buffer_load_dwordx4 v[124:127], v8, s[4:7], 0 offen offset:0 sc1
    buffer_load_dwordx4 v[128:131], v8, s[4:7], 0 offen offset:1024 sc1
    buffer_load_dwordx4 v[132:135], v8, s[4:7], 0 offen offset:2048 sc1
    buffer_load_dwordx4 v[136:139], v8, s[4:7], 0 offen offset:3072 sc1
    buffer_load_dwordx4 v[140:143], v8, s[4:7], s16 offen offset:0 sc1
    buffer_load_dwordx4 v[144:147], v8, s[4:7], s16 offen offset:1024 sc1
    buffer_load_dwordx4 v[148:151], v8, s[4:7], s16 offen offset:2048 sc1
    s_waitcnt vmcnt(7)
    s_barrier
    s_waitcnt vmcnt(6)
    v_mfma_f32_16x16x32_bf16 v[12:15], a[0:3], v[124:127], 0
    s_atomic_add s90, s[86:87], 16
    buffer_load_dwordx4 v[152:155], v8, s[4:7], s16 offen offset:3072 sc1
    v_mfma_f32_16x16x32_bf16 v[16:19], a[4:7], v[124:127], 0
    s_atomic_add s90, s[86:87], 4112
    v_mfma_f32_16x16x32_bf16 v[20:23], a[8:11], v[124:127], 0
    s_atomic_add s90, s[86:87], 8208
    buffer_load_dwordx4 v[156:159], v8, s[4:7], s17 offen offset:0 sc1
    v_mfma_f32_16x16x32_bf16 v[24:27], a[12:15], v[124:127], 0
    s_waitcnt vmcnt(7)
    v_mfma_f32_16x16x32_bf16 v[28:31], a[16:19], v[124:127], 0
    s_atomic_add s90, s[86:87], 12304
    v_mfma_f32_16x16x32_bf16 v[12:15], a[20:23], v[128:131], v[12:15]
    s_atomic_add s90, s[86:87], 16400
    buffer_load_dwordx4 v[160:163], v8, s[4:7], s17 offen offset:1024 sc1
    v_mfma_f32_16x16x32_bf16 v[16:19], a[24:27], v[128:131], v[16:19]
    s_atomic_add s90, s[86:87], 20496
    v_mfma_f32_16x16x32_bf16 v[20:23], a[28:31], v[128:131], v[20:23]
    s_atomic_add s90, s[86:87], 24592
    buffer_load_dwordx4 v[164:167], v8, s[4:7], s17 offen offset:2048 sc1
    v_mfma_f32_16x16x32_bf16 v[24:27], a[32:35], v[128:131], v[24:27]
    s_waitcnt vmcnt(7)
    v_mfma_f32_16x16x32_bf16 v[28:31], a[36:39], v[128:131], v[28:31]
    s_atomic_add s90, s[86:87], 28688
    v_mfma_f32_16x16x32_bf16 v[12:15], a[40:43], v[132:135], v[12:15]
    buffer_load_dwordx4 v[168:171], v8, s[4:7], s17 offen offset:3072 sc1
    v_mfma_f32_16x16x32_bf16 v[12:15], a[60:63], v[136:139], v[12:15]
    v_mfma_f32_16x16x32_bf16 v[16:19], a[64:67], v[136:139], v[16:19]
    buffer_load_dwordx4 v[172:175], v8, s[4:7], s18 offen offset:0 sc1
    v_mfma_f32_16x16x32_bf16 v[16:19], a[44:47], v[132:135], v[16:19]
    s_xor_b32 s55, s54, 1
    s_mul_i32 s53, s55, 15360
    s_sub_u32 s52, s36, s55
    v_mfma_f32_16x16x32_bf16 v[20:23], a[48:51], v[132:135], v[20:23]
    s_sub_u32 s52, s52, 1
    s_and_b32 s52, s52, 3
    s_mul_i32 s52, s52, 5120
    v_mfma_f32_16x16x32_bf16 v[20:23], a[68:71], v[136:139], v[20:23]
    buffer_load_dwordx4 v[176:179], v8, s[4:7], s18 offen offset:1024 sc1
    v_mfma_f32_16x16x32_bf16 v[24:27], a[72:75], v[136:139], v[24:27]
    s_add_u32 s52, s52, s53
    s_add_u32 s52, s52, 93184
    v_add_u32 v184, s52, v1
    v_mfma_f32_16x16x32_bf16 v[24:27], a[52:55], v[132:135], v[24:27]
    buffer_load_dwordx4 v[124:127], v208, s[4:7], 0 offen offset:0 sc1
    v_mfma_f32_16x16x32_bf16 v[28:31], a[56:59], v[132:135], v[28:31]
    s_waitcnt vmcnt(9)
    s_xor_b32 s55, s54, 0
    s_mul_i32 s53, s55, 15360
    v_mfma_f32_16x16x32_bf16 v[28:31], a[76:79], v[136:139], v[28:31]
    s_sub_u32 s52, s36, s55
    s_sub_u32 s52, s52, 1
    s_and_b32 s52, s52, 3
    v_mfma_f32_16x16x32_bf16 v[12:15], a[80:83], v[140:143], v[12:15]
    buffer_load_dwordx4 v[128:131], v208, s[4:7], 0 offen offset:1024 sc1
    v_mfma_f32_16x16x32_bf16 v[12:15], a[100:103], v[144:147], v[12:15]
    s_mul_i32 s52, s52, 5120
    s_add_u32 s52, s52, s53
    s_add_u32 s52, s52, 93184
    v_mfma_f32_16x16x32_bf16 v[16:19], a[104:107], v[144:147], v[16:19]
    buffer_load_dwordx4 v[132:135], v208, s[4:7], 0 offen offset:2048 sc1
    v_mfma_f32_16x16x32_bf16 v[16:19], a[84:87], v[140:143], v[16:19]
    s_cmp_eq_u32 s55, s36
    s_cselect_b32 s52, 156672, s52
    s_cselect_b32 s20, 1.0, 0
    v_mfma_f32_16x16x32_bf16 v[20:23], a[88:91], v[140:143], v[20:23]
    s_xor_b32 s55, s54, 2
    v_add_u32 v185, s52, v1
    s_mul_i32 s53, s55, 15360
    v_mfma_f32_16x16x32_bf16 v[20:23], a[108:111], v[144:147], v[20:23]
    buffer_load_dwordx4 v[136:139], v208, s[4:7], 0 offen offset:3072 sc1
    v_mfma_f32_16x16x32_bf16 v[24:27], a[112:115], v[144:147], v[24:27]
    s_sub_u32 s52, s36, s55
    s_sub_u32 s52, s52, 1
    s_and_b32 s52, s52, 3
    v_mfma_f32_16x16x32_bf16 v[24:27], a[92:95], v[140:143], v[24:27]
    s_mul_i32 s52, s52, 5120
    s_add_u32 s52, s52, s53
    s_add_u32 s52, s52, 93184
    v_mfma_f32_16x16x32_bf16 v[28:31], a[96:99], v[140:143], v[28:31]
    s_waitcnt vmcnt(10)
    v_add_u32 v186, s52, v1
    s_xor_b32 s55, s54, 3
    v_mfma_f32_16x16x32_bf16 v[28:31], a[116:119], v[144:147], v[28:31]
    s_mul_i32 s53, s55, 15360
    s_sub_u32 s52, s36, s55
    s_sub_u32 s52, s52, 1
    v_mfma_f32_16x16x32_bf16 v[12:15], a[120:123], v[148:151], v[12:15]
    buffer_load_dwordx4 v[140:143], v208, s[4:7], s16 offen offset:0 sc1
    v_mfma_f32_16x16x32_bf16 v[12:15], a[140:143], v[152:155], v[12:15]
    s_and_b32 s52, s52, 3
    s_mul_i32 s52, s52, 5120
    s_add_u32 s52, s52, s53
    v_mfma_f32_16x16x32_bf16 v[16:19], a[144:147], v[152:155], v[16:19]
    buffer_load_dwordx4 v[144:147], v208, s[4:7], s16 offen offset:1024 sc1
    v_mfma_f32_16x16x32_bf16 v[16:19], a[124:127], v[148:151], v[16:19]
    s_add_u32 s52, s52, 93184
    s_cmp_eq_u32 s55, s36
    s_cselect_b32 s52, 156672, s52
    s_cselect_b32 s21, 1.0, 0
    v_mfma_f32_16x16x32_bf16 v[20:23], a[128:131], v[148:151], v[20:23]
    v_add_u32 v187, s52, v1
    s_mul_i32 s52, s36, 15360
    v_mfma_f32_16x16x32_bf16 v[20:23], a[148:151], v[152:155], v[20:23]
    s_add_u32 s52, s52, 93184
    s_cmp_eq_u32 s36, 3
    s_cselect_b32 s53, 5120, 0
    s_cselect_b32 s55, 0, 10240
    v_mfma_f32_16x16x32_bf16 v[24:27], a[152:155], v[152:155], v[24:27]
    v_add_u32 v188, s52, v1
    v_add_u32 v189, s53, v188
    v_mfma_f32_16x16x32_bf16 v[24:27], a[132:135], v[148:151], v[24:27]
    v_add_u32 v190, s55, v188
    v_mfma_f32_16x16x32_bf16 v[28:31], a[136:139], v[148:151], v[28:31]
    s_waitcnt vmcnt(10)
    v_mfma_f32_16x16x32_bf16 v[28:31], a[156:159], v[152:155], v[28:31]
    v_mfma_f32_16x16x32_bf16 v[12:15], a[160:163], v[156:159], v[12:15]
    buffer_load_dwordx4 v[148:151], v208, s[4:7], s16 offen offset:2048 sc1
    v_mfma_f32_16x16x32_bf16 v[12:15], a[180:183], v[160:163], v[12:15]
    v_mfma_f32_16x16x32_bf16 v[16:19], a[184:187], v[160:163], v[16:19]
    buffer_load_dwordx4 v[152:155], v208, s[4:7], s16 offen offset:3072 sc1
    v_mfma_f32_16x16x32_bf16 v[16:19], a[164:167], v[156:159], v[16:19]
    v_mfma_f32_16x16x32_bf16 v[20:23], a[168:171], v[156:159], v[20:23]
    v_mfma_f32_16x16x32_bf16 v[20:23], a[188:191], v[160:163], v[20:23]
    v_mfma_f32_16x16x32_bf16 v[24:27], a[192:195], v[160:163], v[24:27]
    v_mfma_f32_16x16x32_bf16 v[24:27], a[172:175], v[156:159], v[24:27]
    v_mfma_f32_16x16x32_bf16 v[28:31], a[176:179], v[156:159], v[28:31]
    s_waitcnt vmcnt(10)
    v_mfma_f32_16x16x32_bf16 v[28:31], a[196:199], v[160:163], v[28:31]
    v_mfma_f32_16x16x32_bf16 v[12:15], a[200:203], v[164:167], v[12:15]
    buffer_load_dwordx4 v[156:159], v208, s[4:7], s17 offen offset:0 sc1
    v_mfma_f32_16x16x32_bf16 v[12:15], a[220:223], v[168:171], v[12:15]
    v_mfma_f32_16x16x32_bf16 v[16:19], a[224:227], v[168:171], v[16:19]
    buffer_load_dwordx4 v[160:163], v208, s[4:7], s17 offen offset:1024 sc1
    v_mfma_f32_16x16x32_bf16 v[16:19], a[204:207], v[164:167], v[16:19]
    v_mfma_f32_16x16x32_bf16 v[20:23], a[208:211], v[164:167], v[20:23]
    v_mfma_f32_16x16x32_bf16 v[20:23], a[228:231], v[168:171], v[20:23]
    v_mfma_f32_16x16x32_bf16 v[24:27], a[232:235], v[168:171], v[24:27]
    s_load_dword s91, s[92:93], 16 glc
    v_mfma_f32_16x16x32_bf16 v[24:27], a[212:215], v[164:167], v[24:27]
    v_mfma_f32_16x16x32_bf16 v[28:31], a[216:219], v[164:167], v[28:31]
    s_waitcnt vmcnt(10)
    v_mfma_f32_16x16x32_bf16 v[28:31], a[236:239], v[168:171], v[28:31]
    v_mfma_f32_16x16x32_bf16 v[12:15], a[240:243], v[172:175], v[12:15]
    buffer_load_dwordx4 v[164:167], v208, s[4:7], s17 offen offset:2048 sc1
    v_mfma_f32_16x16x32_bf16 v[12:15], v[236:239], v[176:179], v[12:15]
    v_mfma_f32_16x16x32_bf16 v[16:19], v[240:243], v[176:179], v[16:19]
    buffer_load_dwordx4 v[168:171], v208, s[4:7], s17 offen offset:3072 sc1
    v_mfma_f32_16x16x32_bf16 v[16:19], a[244:247], v[172:175], v[16:19]
    v_mfma_f32_16x16x32_bf16 v[20:23], a[248:251], v[172:175], v[20:23]
    v_mfma_f32_16x16x32_bf16 v[20:23], v[244:247], v[176:179], v[20:23]
    v_mfma_f32_16x16x32_bf16 v[24:27], v[248:251], v[176:179], v[24:27]
    v_mfma_f32_16x16x32_bf16 v[24:27], a[252:255], v[172:175], v[24:27]
    v_mfma_f32_16x16x32_bf16 v[28:31], v[232:235], v[172:175], v[28:31]
    s_waitcnt vmcnt(10)
    v_mfma_f32_16x16x32_bf16 v[28:31], v[252:255], v[176:179], v[28:31]
    v_mfma_f32_16x16x32_bf16 v[32:35], a[0:3], v[124:127], 0
    buffer_load_dwordx4 v[172:175], v208, s[4:7], s18 offen offset:0 sc1
    v_mfma_f32_16x16x32_bf16 v[32:35], a[20:23], v[128:131], v[32:35]
    v_mfma_f32_16x16x32_bf16 v[36:39], a[24:27], v[128:131], 0
    buffer_load_dwordx4 v[176:179], v208, s[4:7], s18 offen offset:1024 sc1
    v_mfma_f32_16x16x32_bf16 v[36:39], a[4:7], v[124:127], v[36:39]
    v_mfma_f32_16x16x32_bf16 v[40:43], a[8:11], v[124:127], 0
    v_mfma_f32_16x16x32_bf16 v[40:43], a[28:31], v[128:131], v[40:43]
    v_mfma_f32_16x16x32_bf16 v[44:47], a[32:35], v[128:131], 0
    v_mfma_f32_16x16x32_bf16 v[44:47], a[12:15], v[124:127], v[44:47]
    v_mfma_f32_16x16x32_bf16 v[48:51], a[16:19], v[124:127], 0
    s_waitcnt vmcnt(10)
    v_mfma_f32_16x16x32_bf16 v[48:51], a[36:39], v[128:131], v[48:51]
    ds_write_b128 v184, v[12:15] offset:0
    v_mfma_f32_16x16x32_bf16 v[32:35], a[40:43], v[132:135], v[32:35]
    v_mfma_f32_16x16x32_bf16 v[32:35], a[60:63], v[136:139], v[32:35]
    v_mfma_f32_16x16x32_bf16 v[36:39], a[64:67], v[136:139], v[36:39]
    v_mfma_f32_16x16x32_bf16 v[36:39], a[44:47], v[132:135], v[36:39]
    v_mfma_f32_16x16x32_bf16 v[40:43], a[48:51], v[132:135], v[40:43]
    ds_write_b128 v184, v[16:19] offset:1024
    v_mfma_f32_16x16x32_bf16 v[40:43], a[68:71], v[136:139], v[40:43]
    v_mfma_f32_16x16x32_bf16 v[44:47], a[72:75], v[136:139], v[44:47]
    v_mfma_f32_16x16x32_bf16 v[44:47], a[52:55], v[132:135], v[44:47]
    v_mfma_f32_16x16x32_bf16 v[48:51], a[56:59], v[132:135], v[48:51]
    s_waitcnt vmcnt(8)
    v_mfma_f32_16x16x32_bf16 v[48:51], a[76:79], v[136:139], v[48:51]
    ds_write_b128 v184, v[20:23] offset:2048
    v_mfma_f32_16x16x32_bf16 v[32:35], a[80:83], v[140:143], v[32:35]
    v_mfma_f32_16x16x32_bf16 v[32:35], a[100:103], v[144:147], v[32:35]
    v_mfma_f32_16x16x32_bf16 v[36:39], a[104:107], v[144:147], v[36:39]
    v_mfma_f32_16x16x32_bf16 v[36:39], a[84:87], v[140:143], v[36:39]
    v_mfma_f32_16x16x32_bf16 v[40:43], a[88:91], v[140:143], v[40:43]
    s_waitcnt lgkmcnt(0)
    s_cmp_ge_u32 s91, 8
    s_cbranch_scc1 POLLX24
    s_mov_b32 s68, 0
POLL23:
    s_load_dword s91, s[92:93], 16 glc
    s_add_u32 s68, s68, 1
    s_waitcnt lgkmcnt(0)
    s_cmp_ge_u32 s91, 8
    s_cbranch_scc1 POLLX24
    s_cmp_lt_u32 s68, 400000
    s_cbranch_scc1 POLL23
POLLX24:
    ds_write_b128 v184, v[24:27] offset:3072
    v_mfma_f32_16x16x32_bf16 v[40:43], a[108:111], v[144:147], v[40:43]
    buffer_load_dwordx4 v[124:127], v209, s[4:7], 0 offen offset:0 sc1
    v_mfma_f32_16x16x32_bf16 v[44:47], a[112:115], v[144:147], v[44:47]
    v_mfma_f32_16x16x32_bf16 v[44:47], a[92:95], v[140:143], v[44:47]
    buffer_load_dwordx4 v[128:131], v209, s[4:7], 0 offen offset:1024 sc1
    v_mfma_f32_16x16x32_bf16 v[48:51], a[96:99], v[140:143], v[48:51]
    s_waitcnt vmcnt(8)
    v_mfma_f32_16x16x32_bf16 v[48:51], a[116:119], v[144:147], v[48:51]
    ds_write_b128 v184, v[28:31] offset:4096
    v_mfma_f32_16x16x32_bf16 v[32:35], a[120:123], v[148:151], v[32:35]
    buffer_load_dwordx4 v[132:135], v209, s[4:7], 0 offen offset:2048 sc1
    v_mfma_f32_16x16x32_bf16 v[32:35], a[140:143], v[152:155], v[32:35]
    s_lshr_b32 s50, s36, 1
    s_lshl_b32 s50, s50, 5
    s_and_b32 s51, s36, 1
    v_mfma_f32_16x16x32_bf16 v[36:39], a[144:147], v[152:155], v[36:39]
    buffer_load_dwordx4 v[136:139], v209, s[4:7], 0 offen offset:3072 sc1
    v_mfma_f32_16x16x32_bf16 v[36:39], a[124:127], v[148:151], v[36:39]
    s_lshl_b32 s51, s51, 10
    s_add_u32 s50, s50, s51
    s_add_u32 s50, s50, s41
    v_mfma_f32_16x16x32_bf16 v[40:43], a[128:131], v[148:151], v[40:43]
    s_mul_i32 s72, s50, 1280
    s_mul_i32 s51, s39, 80
    s_add_u32 s72, s72, s51
    v_mfma_f32_16x16x32_bf16 v[40:43], a[148:151], v[152:155], v[40:43]
    buffer_load_dwordx4 v[140:143], v209, s[4:7], s16 offen offset:0 sc1
    v_mfma_f32_16x16x32_bf16 v[44:47], a[152:155], v[152:155], v[44:47]
    s_mul_i32 s51, s39, 160
    s_sub_u32 s51, 1120, s51
    v_mov_b32 v98, s51
    v_mfma_f32_16x16x32_bf16 v[44:47], a[132:135], v[148:151], v[44:47]
    buffer_load_dwordx4 v[144:147], v209, s[4:7], s16 offen offset:1024 sc1
    v_mfma_f32_16x16x32_bf16 v[48:51], a[136:139], v[148:151], v[48:51]
    s_waitcnt vmcnt(10)
    s_mul_i32 s50, s36, 3072
    v_add_u32 v97, s50, v1
    v_mfma_f32_16x16x32_bf16 v[48:51], a[156:159], v[152:155], v[48:51]
    v_mul_u32_u24 v96, 160, v2
    v_add_u32 v96, s50, v96
    v_mfma_f32_16x16x32_bf16 v[32:35], a[160:163], v[156:159], v[32:35]
    buffer_load_dwordx4 v[148:151], v209, s[4:7], s16 offen offset:2048 sc1
    v_mfma_f32_16x16x32_bf16 v[32:35], a[180:183], v[160:163], v[32:35]
    v_lshl_add_u32 v95, v3, 4, v96
    v_and_b32 v99, 1, v3
    v_mfma_f32_16x16x32_bf16 v[36:39], a[184:187], v[160:163], v[36:39]
    buffer_load_dwordx4 v[152:155], v209, s[4:7], s16 offen offset:3072 sc1
    v_mfma_f32_16x16x32_bf16 v[36:39], a[164:167], v[156:159], v[36:39]
    v_lshl_add_u32 v96, v99, 3, v96
    v_lshrrev_b32 v99, 1, v3
    v_mfma_f32_16x16x32_bf16 v[40:43], a[168:171], v[156:159], v[40:43]
    v_mul_u32_u24 v112, 80, v99
    v_add_u32 v96, v96, v112
    v_mfma_f32_16x16x32_bf16 v[40:43], a[188:191], v[160:163], v[40:43]
    v_add_u32 v112, 0, v0
    v_mul_u32_u24 v113, 6554, v112
    v_mfma_f32_16x16x32_bf16 v[44:47], a[192:195], v[160:163], v[44:47]
    v_lshrrev_b32 v113, 16, v113
    v_mul_u32_u24 v114, 10, v113
    v_mfma_f32_16x16x32_bf16 v[44:47], a[172:175], v[156:159], v[44:47]
    v_sub_u32 v114, v112, v114
    v_cmp_lt_u32 vcc, 4, v114
    v_mfma_f32_16x16x32_bf16 v[48:51], a[176:179], v[156:159], v[48:51]
    s_waitcnt vmcnt(10)
    v_mul_u32_u24 v92, 81920, v113
    v_lshl_add_u32 v92, v114, 4, v92
    v_mfma_f32_16x16x32_bf16 v[48:51], a[196:199], v[160:163], v[48:51]
    v_cndmask_b32 v112, 0, v98, vcc
    v_add_u32 v92, v92, v112
    v_mfma_f32_16x16x32_bf16 v[32:35], a[200:203], v[164:167], v[32:35]
    buffer_load_dwordx4 v[156:159], v209, s[4:7], s17 offen offset:0 sc1
    v_mfma_f32_16x16x32_bf16 v[32:35], a[220:223], v[168:171], v[32:35]
    v_add_u32 v112, 64, v0
    v_mul_u32_u24 v113, 6554, v112
    v_mfma_f32_16x16x32_bf16 v[36:39], a[224:227], v[168:171], v[36:39]
    buffer_load_dwordx4 v[160:163], v209, s[4:7], s17 offen offset:1024 sc1
    v_mfma_f32_16x16x32_bf16 v[36:39], a[204:207], v[164:167], v[36:39]
    v_lshrrev_b32 v113, 16, v113
    v_mul_u32_u24 v114, 10, v113
    v_mfma_f32_16x16x32_bf16 v[40:43], a[208:211], v[164:167], v[40:43]
    v_sub_u32 v114, v112, v114
    v_cmp_lt_u32 vcc, 4, v114
    v_mfma_f32_16x16x32_bf16 v[40:43], a[228:231], v[168:171], v[40:43]
    v_mul_u32_u24 v93, 81920, v113
    v_lshl_add_u32 v93, v114, 4, v93
    v_mfma_f32_16x16x32_bf16 v[44:47], a[232:235], v[168:171], v[44:47]
    v_cndmask_b32 v112, 0, v98, vcc
    v_add_u32 v93, v93, v112
    v_mfma_f32_16x16x32_bf16 v[44:47], a[212:215], v[164:167], v[44:47]
    v_add_u32 v112, 128, v0
    v_mul_u32_u24 v113, 6554, v112
    v_mfma_f32_16x16x32_bf16 v[48:51], a[216:219], v[164:167], v[48:51]
    s_waitcnt vmcnt(10)
    v_lshrrev_b32 v113, 16, v113
    v_mul_u32_u24 v114, 10, v113
    v_mfma_f32_16x16x32_bf16 v[48:51], a[236:239], v[168:171], v[48:51]
    v_sub_u32 v114, v112, v114
    v_cmp_lt_u32 vcc, 4, v114
    v_mfma_f32_16x16x32_bf16 v[32:35], a[240:243], v[172:175], v[32:35]
    buffer_load_dwordx4 v[164:167], v209, s[4:7], s17 offen offset:2048 sc1
    v_mfma_f32_16x16x32_bf16 v[32:35], v[236:239], v[176:179], v[32:35]
    v_mul_u32_u24 v94, 81920, v113
    v_lshl_add_u32 v94, v114, 4, v94
    v_mfma_f32_16x16x32_bf16 v[36:39], v[240:243], v[176:179], v[36:39]
    buffer_load_dwordx4 v[168:171], v209, s[4:7], s17 offen offset:3072 sc1
    v_mfma_f32_16x16x32_bf16 v[36:39], a[244:247], v[172:175], v[36:39]
    v_cndmask_b32 v112, 0, v98, vcc
    v_add_u32 v94, v94, v112
    v_mfma_f32_16x16x32_bf16 v[40:43], a[248:251], v[172:175], v[40:43]
    v_lshl_add_u32 v94, v99, 28, v94
    v_mfma_f32_16x16x32_bf16 v[40:43], v[244:247], v[176:179], v[40:43]
    v_mfma_f32_16x16x32_bf16 v[44:47], v[248:251], v[176:179], v[44:47]
    v_mfma_f32_16x16x32_bf16 v[44:47], a[252:255], v[172:175], v[44:47]
    v_mfma_f32_16x16x32_bf16 v[48:51], v[232:235], v[172:175], v[48:51]
    s_waitcnt vmcnt(10)
    v_mfma_f32_16x16x32_bf16 v[48:51], v[252:255], v[176:179], v[48:51]
    v_mfma_f32_16x16x32_bf16 v[52:55], a[0:3], v[124:127], 0
    buffer_load_dwordx4 v[172:175], v209, s[4:7], s18 offen offset:0 sc1
    v_mfma_f32_16x16x32_bf16 v[52:55], a[20:23], v[128:131], v[52:55]
    v_mfma_f32_16x16x32_bf16 v[56:59], a[24:27], v[128:131], 0
    buffer_load_dwordx4 v[176:179], v209, s[4:7], s18 offen offset:1024 sc1
    v_mfma_f32_16x16x32_bf16 v[56:59], a[4:7], v[124:127], v[56:59]
    v_mfma_f32_16x16x32_bf16 v[60:63], a[8:11], v[124:127], 0
    v_mfma_f32_16x16x32_bf16 v[60:63], a[28:31], v[128:131], v[60:63]
    v_mfma_f32_16x16x32_bf16 v[64:67], a[32:35], v[128:131], 0
    v_fmac_f32 v212, s20, v32
    v_fmac_f32 v213, s20, v33
    v_mfma_f32_16x16x32_bf16 v[64:67], a[12:15], v[124:127], v[64:67]
    v_fmac_f32 v214, s20, v34
    v_fmac_f32 v215, s20, v35
    v_mfma_f32_16x16x32_bf16 v[68:71], a[16:19], v[124:127], 0
    s_waitcnt vmcnt(10)
    v_fmac_f32 v216, s20, v36
    v_fmac_f32 v217, s20, v37
    v_mfma_f32_16x16x32_bf16 v[68:71], a[36:39], v[128:131], v[68:71]
    ds_write_b128 v185, v[32:35] offset:0
    v_mfma_f32_16x16x32_bf16 v[52:55], a[40:43], v[132:135], v[52:55]
    buffer_load_dwordx4 v[124:127], v210, s[4:7], 0 offen offset:0 sc1
    v_mfma_f32_16x16x32_bf16 v[52:55], a[60:63], v[136:139], v[52:55]
    v_fmac_f32 v218, s20, v38
    v_fmac_f32 v219, s20, v39
    v_mfma_f32_16x16x32_bf16 v[56:59], a[64:67], v[136:139], v[56:59]
    buffer_load_dwordx4 v[128:131], v210, s[4:7], 0 offen offset:1024 sc1
    v_mfma_f32_16x16x32_bf16 v[56:59], a[44:47], v[132:135], v[56:59]
    v_fmac_f32 v220, s20, v40
    v_fmac_f32 v221, s20, v41
    v_mfma_f32_16x16x32_bf16 v[60:63], a[48:51], v[132:135], v[60:63]
    ds_write_b128 v185, v[36:39] offset:1024
    v_mfma_f32_16x16x32_bf16 v[60:63], a[68:71], v[136:139], v[60:63]
    v_fmac_f32 v222, s20, v42
    v_fmac_f32 v223, s20, v43
    v_mfma_f32_16x16x32_bf16 v[64:67], a[72:75], v[136:139], v[64:67]
    v_fmac_f32 v224, s20, v44
    v_fmac_f32 v225, s20, v45
    v_mfma_f32_16x16x32_bf16 v[64:67], a[52:55], v[132:135], v[64:67]
    v_fmac_f32 v226, s20, v46
    v_fmac_f32 v227, s20, v47
    v_mfma_f32_16x16x32_bf16 v[68:71], a[56:59], v[132:135], v[68:71]
    s_waitcnt vmcnt(10)
    v_fmac_f32 v228, s20, v48
    v_fmac_f32 v229, s20, v49
    v_mfma_f32_16x16x32_bf16 v[68:71], a[76:79], v[136:139], v[68:71]
    ds_write_b128 v185, v[40:43] offset:2048
    v_mfma_f32_16x16x32_bf16 v[52:55], a[80:83], v[140:143], v[52:55]
    buffer_load_dwordx4 v[132:135], v210, s[4:7], 0 offen offset:2048 sc1
    v_mfma_f32_16x16x32_bf16 v[52:55], a[100:103], v[144:147], v[52:55]
    v_fmac_f32 v230, s20, v50
    v_fmac_f32 v231, s20, v51
    v_mfma_f32_16x16x32_bf16 v[56:59], a[104:107], v[144:147], v[56:59]
    buffer_load_dwordx4 v[136:139], v210, s[4:7], 0 offen offset:3072 sc1
    v_mfma_f32_16x16x32_bf16 v[56:59], a[84:87], v[140:143], v[56:59]
    v_mfma_f32_16x16x32_bf16 v[60:63], a[88:91], v[140:143], v[60:63]
    ds_write_b128 v185, v[44:47] offset:3072
    v_mfma_f32_16x16x32_bf16 v[60:63], a[108:111], v[144:147], v[60:63]
    v_mfma_f32_16x16x32_bf16 v[64:67], a[112:115], v[144:147], v[64:67]
    v_mfma_f32_16x16x32_bf16 v[64:67], a[92:95], v[140:143], v[64:67]
    v_mfma_f32_16x16x32_bf16 v[68:71], a[96:99], v[140:143], v[68:71]
    s_waitcnt vmcnt(10)
    v_mfma_f32_16x16x32_bf16 v[68:71], a[116:119], v[144:147], v[68:71]
    ds_write_b128 v185, v[48:51] offset:4096
    v_mfma_f32_16x16x32_bf16 v[52:55], a[120:123], v[148:151], v[52:55]
    buffer_load_dwordx4 v[140:143], v210, s[4:7], s16 offen offset:0 sc1
    v_mfma_f32_16x16x32_bf16 v[52:55], a[140:143], v[152:155], v[52:55]
    v_mfma_f32_16x16x32_bf16 v[56:59], a[144:147], v[152:155], v[56:59]
    buffer_load_dwordx4 v[144:147], v210, s[4:7], s16 offen offset:1024 sc1
    v_mfma_f32_16x16x32_bf16 v[56:59], a[124:127], v[148:151], v[56:59]
    v_mfma_f32_16x16x32_bf16 v[60:63], a[128:131], v[148:151], v[60:63]
    v_mfma_f32_16x16x32_bf16 v[60:63], a[148:151], v[152:155], v[60:63]
    v_mfma_f32_16x16x32_bf16 v[64:67], a[152:155], v[152:155], v[64:67]
    v_mfma_f32_16x16x32_bf16 v[64:67], a[132:135], v[148:151], v[64:67]
    v_mfma_f32_16x16x32_bf16 v[68:71], a[136:139], v[148:151], v[68:71]
    s_waitcnt vmcnt(10)
    v_mfma_f32_16x16x32_bf16 v[68:71], a[156:159], v[152:155], v[68:71]
    v_mfma_f32_16x16x32_bf16 v[52:55], a[160:163], v[156:159], v[52:55]
    buffer_load_dwordx4 v[148:151], v210, s[4:7], s16 offen offset:2048 sc1
    v_mfma_f32_16x16x32_bf16 v[52:55], a[180:183], v[160:163], v[52:55]
    v_mfma_f32_16x16x32_bf16 v[56:59], a[184:187], v[160:163], v[56:59]
    buffer_load_dwordx4 v[152:155], v210, s[4:7], s16 offen offset:3072 sc1
    v_mfma_f32_16x16x32_bf16 v[56:59], a[164:167], v[156:159], v[56:59]
    v_mfma_f32_16x16x32_bf16 v[60:63], a[168:171], v[156:159], v[60:63]
    v_mfma_f32_16x16x32_bf16 v[60:63], a[188:191], v[160:163], v[60:63]
    v_mfma_f32_16x16x32_bf16 v[64:67], a[192:195], v[160:163], v[64:67]
    v_mfma_f32_16x16x32_bf16 v[64:67], a[172:175], v[156:159], v[64:67]
    v_mfma_f32_16x16x32_bf16 v[68:71], a[176:179], v[156:159], v[68:71]
    s_waitcnt vmcnt(10)
    v_mfma_f32_16x16x32_bf16 v[68:71], a[196:199], v[160:163], v[68:71]
    v_mfma_f32_16x16x32_bf16 v[52:55], a[200:203], v[164:167], v[52:55]
    buffer_load_dwordx4 v[156:159], v210, s[4:7], s17 offen offset:0 sc1
    v_mfma_f32_16x16x32_bf16 v[52:55], a[220:223], v[168:171], v[52:55]
    v_mfma_f32_16x16x32_bf16 v[56:59], a[224:227], v[168:171], v[56:59]
    buffer_load_dwordx4 v[160:163], v210, s[4:7], s17 offen offset:1024 sc1
    v_mfma_f32_16x16x32_bf16 v[56:59], a[204:207], v[164:167], v[56:59]
    v_mfma_f32_16x16x32_bf16 v[60:63], a[208:211], v[164:167], v[60:63]
    v_mfma_f32_16x16x32_bf16 v[60:63], a[228:231], v[168:171], v[60:63]
    v_mfma_f32_16x16x32_bf16 v[64:67], a[232:235], v[168:171], v[64:67]
    v_mfma_f32_16x16x32_bf16 v[64:67], a[212:215], v[164:167], v[64:67]
    v_mfma_f32_16x16x32_bf16 v[68:71], a[216:219], v[164:167], v[68:71]
    s_waitcnt vmcnt(10)
    v_mfma_f32_16x16x32_bf16 v[68:71], a[236:239], v[168:171], v[68:71]
    v_mfma_f32_16x16x32_bf16 v[52:55], a[240:243], v[172:175], v[52:55]
    buffer_load_dwordx4 v[164:167], v210, s[4:7], s17 offen offset:2048 sc1
    v_mfma_f32_16x16x32_bf16 v[52:55], v[236:239], v[176:179], v[52:55]
    v_mfma_f32_16x16x32_bf16 v[56:59], v[240:243], v[176:179], v[56:59]
    buffer_load_dwordx4 v[168:171], v210, s[4:7], s17 offen offset:3072 sc1
    v_mfma_f32_16x16x32_bf16 v[56:59], a[244:247], v[172:175], v[56:59]
    v_mfma_f32_16x16x32_bf16 v[60:63], a[248:251], v[172:175], v[60:63]
    v_mfma_f32_16x16x32_bf16 v[60:63], v[244:247], v[176:179], v[60:63]
    v_mfma_f32_16x16x32_bf16 v[64:67], v[248:251], v[176:179], v[64:67]
    v_mfma_f32_16x16x32_bf16 v[64:67], a[252:255], v[172:175], v[64:67]
    v_mfma_f32_16x16x32_bf16 v[68:71], v[232:235], v[172:175], v[68:71]
    s_waitcnt vmcnt(10)
    v_mfma_f32_16x16x32_bf16 v[68:71], v[252:255], v[176:179], v[68:71]
    v_mfma_f32_16x16x32_bf16 v[72:75], a[0:3], v[124:127], 0
    buffer_load_dwordx4 v[172:175], v210, s[4:7], s18 offen offset:0 sc1
    v_mfma_f32_16x16x32_bf16 v[72:75], a[20:23], v[128:131], v[72:75]
    v_mfma_f32_16x16x32_bf16 v[76:79], a[24:27], v[128:131], 0
    buffer_load_dwordx4 v[176:179], v210, s[4:7], s18 offen offset:1024 sc1
    v_mfma_f32_16x16x32_bf16 v[76:79], a[4:7], v[124:127], v[76:79]
    v_mfma_f32_16x16x32_bf16 v[80:83], a[8:11], v[124:127], 0
    ds_write_b128 v186, v[52:55] offset:0
    v_mfma_f32_16x16x32_bf16 v[80:83], a[28:31], v[128:131], v[80:83]
    v_mfma_f32_16x16x32_bf16 v[84:87], a[32:35], v[128:131], 0
    ds_write_b128 v186, v[56:59] offset:1024
    v_mfma_f32_16x16x32_bf16 v[84:87], a[12:15], v[124:127], v[84:87]
    v_mfma_f32_16x16x32_bf16 v[88:91], a[16:19], v[124:127], 0
    s_waitcnt vmcnt(10)
    ds_write_b128 v186, v[60:63] offset:2048
    v_mfma_f32_16x16x32_bf16 v[88:91], a[36:39], v[128:131], v[88:91]
    v_mfma_f32_16x16x32_bf16 v[72:75], a[40:43], v[132:135], v[72:75]
    ds_write_b128 v186, v[64:67] offset:3072
    v_mfma_f32_16x16x32_bf16 v[72:75], a[60:63], v[136:139], v[72:75]
    v_mfma_f32_16x16x32_bf16 v[76:79], a[64:67], v[136:139], v[76:79]
    ds_write_b128 v186, v[68:71] offset:4096
    v_mfma_f32_16x16x32_bf16 v[76:79], a[44:47], v[132:135], v[76:79]
    v_mfma_f32_16x16x32_bf16 v[80:83], a[48:51], v[132:135], v[80:83]
    v_mfma_f32_16x16x32_bf16 v[80:83], a[68:71], v[136:139], v[80:83]
    v_mfma_f32_16x16x32_bf16 v[84:87], a[72:75], v[136:139], v[84:87]
    v_mfma_f32_16x16x32_bf16 v[84:87], a[52:55], v[132:135], v[84:87]
    v_mfma_f32_16x16x32_bf16 v[88:91], a[56:59], v[132:135], v[88:91]
    s_waitcnt lgkmcnt(0)
    s_waitcnt vmcnt(8)
    s_barrier
    v_mfma_f32_16x16x32_bf16 v[88:91], a[76:79], v[136:139], v[88:91]
    ds_read_b128 v[12:15], v189 offset:0
    v_mfma_f32_16x16x32_bf16 v[72:75], a[80:83], v[140:143], v[72:75]
    ds_read_b128 v[32:35], v189 offset:5120
    v_mfma_f32_16x16x32_bf16 v[72:75], a[100:103], v[144:147], v[72:75]
    ds_read_b128 v[16:19], v189 offset:1024
    v_mfma_f32_16x16x32_bf16 v[76:79], a[104:107], v[144:147], v[76:79]
    ds_read_b128 v[36:39], v189 offset:6144
    v_mfma_f32_16x16x32_bf16 v[76:79], a[84:87], v[140:143], v[76:79]
    ds_read_b128 v[20:23], v189 offset:2048
    v_mfma_f32_16x16x32_bf16 v[80:83], a[88:91], v[140:143], v[80:83]
    ds_read_b128 v[40:43], v189 offset:7168
    v_mfma_f32_16x16x32_bf16 v[80:83], a[108:111], v[144:147], v[80:83]
    ds_read_b128 v[24:27], v189 offset:3072
    v_mfma_f32_16x16x32_bf16 v[84:87], a[112:115], v[144:147], v[84:87]
    ds_read_b128 v[44:47], v189 offset:8192
    v_mfma_f32_16x16x32_bf16 v[84:87], a[92:95], v[140:143], v[84:87]
    ds_read_b128 v[28:31], v189 offset:4096
    s_waitcnt lgkmcnt(8)
    v_add_f32 v212, v212, v12
    v_mfma_f32_16x16x32_bf16 v[88:91], a[96:99], v[140:143], v[88:91]
    s_waitcnt vmcnt(7)
    ds_read_b128 v[48:51], v189 offset:9216
    v_add_f32 v213, v213, v13
    v_mfma_f32_16x16x32_bf16 v[88:91], a[116:119], v[144:147], v[88:91]
    v_add_f32 v214, v214, v14
    v_add_f32 v215, v215, v15
    v_mfma_f32_16x16x32_bf16 v[72:75], a[120:123], v[148:151], v[72:75]
    s_waitcnt lgkmcnt(8)
    v_add_f32 v212, v212, v32
    v_add_f32 v213, v213, v33
    v_mfma_f32_16x16x32_bf16 v[76:79], a[124:127], v[148:151], v[76:79]
    v_add_f32 v214, v214, v34
    v_add_f32 v215, v215, v35
    v_mfma_f32_16x16x32_bf16 v[80:83], a[128:131], v[148:151], v[80:83]
    s_waitcnt lgkmcnt(7)
    v_add_f32 v216, v216, v16
    v_add_f32 v217, v217, v17
    v_mfma_f32_16x16x32_bf16 v[84:87], a[132:135], v[148:151], v[84:87]
    s_waitcnt vmcnt(6)
    v_add_f32 v218, v218, v18
    v_add_f32 v219, v219, v19
    v_mfma_f32_16x16x32_bf16 v[88:91], a[136:139], v[148:151], v[88:91]
    s_waitcnt lgkmcnt(6)
    v_add_f32 v216, v216, v36
    v_add_f32 v217, v217, v37
    v_mfma_f32_16x16x32_bf16 v[72:75], a[140:143], v[152:155], v[72:75]
    v_add_f32 v218, v218, v38
    v_add_f32 v219, v219, v39
    s_waitcnt vmcnt(5)
    v_mfma_f32_16x16x32_bf16 v[72:75], a[160:163], v[156:159], v[72:75]
    s_waitcnt lgkmcnt(5)
    v_add_f32 v220, v220, v20
    v_add_f32 v221, v221, v21
    s_waitcnt vmcnt(4)
    v_mfma_f32_16x16x32_bf16 v[72:75], a[180:183], v[160:163], v[72:75]
    v_add_f32 v222, v222, v22
    v_add_f32 v223, v223, v23
    s_waitcnt vmcnt(3)
    v_mfma_f32_16x16x32_bf16 v[72:75], a[200:203], v[164:167], v[72:75]
    s_waitcnt lgkmcnt(4)
    v_add_f32 v220, v220, v40
    v_add_f32 v221, v221, v41
    s_waitcnt vmcnt(2)
    v_mfma_f32_16x16x32_bf16 v[72:75], a[220:223], v[168:171], v[72:75]
    v_add_f32 v222, v222, v42
    v_add_f32 v223, v223, v43
    s_waitcnt vmcnt(1)
    v_mfma_f32_16x16x32_bf16 v[72:75], a[240:243], v[172:175], v[72:75]
    s_waitcnt lgkmcnt(3)
    v_add_f32 v224, v224, v24
    v_add_f32 v225, v225, v25
    s_waitcnt vmcnt(0)
    v_mfma_f32_16x16x32_bf16 v[72:75], v[236:239], v[176:179], v[72:75]
    v_add_f32 v226, v226, v26
    v_add_f32 v227, v227, v27
    v_mfma_f32_16x16x32_bf16 v[76:79], a[144:147], v[152:155], v[76:79]
    s_waitcnt lgkmcnt(2)
    v_add_f32 v224, v224, v44
    v_add_f32 v225, v225, v45
    v_mfma_f32_16x16x32_bf16 v[76:79], a[164:167], v[156:159], v[76:79]
    v_add_f32 v226, v226, v46
    v_add_f32 v227, v227, v47
    v_mfma_f32_16x16x32_bf16 v[76:79], a[184:187], v[160:163], v[76:79]
    s_waitcnt lgkmcnt(1)
    v_add_f32 v228, v228, v28
    v_add_f32 v229, v229, v29
    v_mfma_f32_16x16x32_bf16 v[76:79], a[204:207], v[164:167], v[76:79]
    ds_write_b128 v187, v[72:75] offset:0
    v_mfma_f32_16x16x32_bf16 v[76:79], a[224:227], v[168:171], v[76:79]
    v_add_f32 v230, v230, v30
    v_add_f32 v231, v231, v31
    v_mfma_f32_16x16x32_bf16 v[76:79], a[244:247], v[172:175], v[76:79]
    s_waitcnt lgkmcnt(1)
    v_add_f32 v228, v228, v48
    v_add_f32 v229, v229, v49
    v_mfma_f32_16x16x32_bf16 v[76:79], v[240:243], v[176:179], v[76:79]
    v_add_f32 v230, v230, v50
    v_add_f32 v231, v231, v51
    v_mfma_f32_16x16x32_bf16 v[80:83], a[148:151], v[152:155], v[80:83]
    v_fmac_f32 v212, s21, v72
    v_fmac_f32 v213, s21, v73
    v_mfma_f32_16x16x32_bf16 v[80:83], a[168:171], v[156:159], v[80:83]
    v_fmac_f32 v214, s21, v74
    v_fmac_f32 v215, s21, v75
    v_mfma_f32_16x16x32_bf16 v[80:83], a[188:191], v[160:163], v[80:83]
    v_mfma_f32_16x16x32_bf16 v[80:83], a[208:211], v[164:167], v[80:83]
    ds_write_b128 v187, v[76:79] offset:1024
    v_mfma_f32_16x16x32_bf16 v[80:83], a[228:231], v[168:171], v[80:83]
    v_fmac_f32 v216, s21, v76
    v_fmac_f32 v217, s21, v77
    v_mfma_f32_16x16x32_bf16 v[80:83], a[248:251], v[172:175], v[80:83]
    v_fmac_f32 v218, s21, v78
    v_fmac_f32 v219, s21, v79
    v_mfma_f32_16x16x32_bf16 v[80:83], v[244:247], v[176:179], v[80:83]
    v_mfma_f32_16x16x32_bf16 v[84:87], a[152:155], v[152:155], v[84:87]
    v_mfma_f32_16x16x32_bf16 v[84:87], a[172:175], v[156:159], v[84:87]
    s_nop 1
    v_mfma_f32_16x16x32_bf16 v[84:87], a[192:195], v[160:163], v[84:87]
    s_nop 1
    v_mfma_f32_16x16x32_bf16 v[84:87], a[212:215], v[164:167], v[84:87]
    ds_write_b128 v187, v[80:83] offset:2048
    v_mfma_f32_16x16x32_bf16 v[84:87], a[232:235], v[168:171], v[84:87]
    v_fmac_f32 v220, s21, v80
    v_fmac_f32 v221, s21, v81
    v_mfma_f32_16x16x32_bf16 v[84:87], a[252:255], v[172:175], v[84:87]
    v_fmac_f32 v222, s21, v82
    v_fmac_f32 v223, s21, v83
    v_mfma_f32_16x16x32_bf16 v[84:87], v[248:251], v[176:179], v[84:87]
    v_mfma_f32_16x16x32_bf16 v[88:91], a[156:159], v[152:155], v[88:91]
    v_mfma_f32_16x16x32_bf16 v[88:91], a[176:179], v[156:159], v[88:91]
    s_nop 1
    v_mfma_f32_16x16x32_bf16 v[88:91], a[196:199], v[160:163], v[88:91]
    s_nop 1
    v_mfma_f32_16x16x32_bf16 v[88:91], a[216:219], v[164:167], v[88:91]
    ds_write_b128 v187, v[84:87] offset:3072
    v_mfma_f32_16x16x32_bf16 v[88:91], a[236:239], v[168:171], v[88:91]
    v_fmac_f32 v224, s21, v84
    v_fmac_f32 v225, s21, v85
    v_mfma_f32_16x16x32_bf16 v[88:91], v[232:235], v[172:175], v[88:91]
    v_fmac_f32 v226, s21, v86
    v_fmac_f32 v227, s21, v87
    v_mfma_f32_16x16x32_bf16 v[88:91], v[252:255], v[176:179], v[88:91]
    s_nop 7
    ds_write_b128 v187, v[88:91] offset:4096
    v_fmac_f32 v228, s21, v88
    v_fmac_f32 v229, s21, v89
    v_fmac_f32 v230, s21, v90
    v_fmac_f32 v231, s21, v91
    s_waitcnt lgkmcnt(0)
    s_barrier
    ds_read_b128 v[52:55], v190 offset:0
    ds_read_b128 v[56:59], v190 offset:1024
    ds_read_b128 v[60:63], v190 offset:2048
    ds_read_b128 v[64:67], v190 offset:3072
    ds_read_b128 v[68:71], v190 offset:4096
    s_waitcnt lgkmcnt(4)
    v_pk_add_f32 v[212:213], v[212:213], v[52:53]
    v_pk_add_f32 v[214:215], v[214:215], v[54:55]
    v_cvt_pk_bf16_f32 v100, v212, v213
    v_cvt_pk_bf16_f32 v101, v214, v215
    s_waitcnt lgkmcnt(3)
    v_pk_add_f32 v[216:217], v[216:217], v[56:57]
    v_pk_add_f32 v[218:219], v[218:219], v[58:59]
    v_cvt_pk_bf16_f32 v102, v216, v217
    v_cvt_pk_bf16_f32 v103, v218, v219
    ds_write_b128 v95, v[100:103]
    s_waitcnt lgkmcnt(3)
    v_pk_add_f32 v[220:221], v[220:221], v[60:61]
    v_pk_add_f32 v[222:223], v[222:223], v[62:63]
    v_cvt_pk_bf16_f32 v104, v220, v221
    v_cvt_pk_bf16_f32 v105, v222, v223
    s_waitcnt lgkmcnt(2)
    v_pk_add_f32 v[224:225], v[224:225], v[64:65]
    v_pk_add_f32 v[226:227], v[226:227], v[66:67]
    v_cvt_pk_bf16_f32 v106, v224, v225
    v_cvt_pk_bf16_f32 v107, v226, v227
    ds_write_b128 v95, v[104:107] offset:80
    s_waitcnt lgkmcnt(2)
    v_pk_add_f32 v[228:229], v[228:229], v[68:69]
    v_pk_add_f32 v[230:231], v[230:231], v[70:71]
    v_cvt_pk_bf16_f32 v108, v228, v229
    v_cvt_pk_bf16_f32 v109, v230, v231
    ds_write_b64 v96, v[108:109] offset:64
    ds_read_b128 v[112:115], v97 offset:0
    ds_read_b128 v[116:119], v97 offset:1024
    ds_read_b128 v[120:123], v97 offset:2048
    s_waitcnt lgkmcnt(2)
    buffer_store_dwordx4 v[112:115], v92, s[12:15], s72 offen
    s_waitcnt lgkmcnt(1)
    buffer_store_dwordx4 v[116:119], v93, s[12:15], s72 offen
    s_waitcnt lgkmcnt(0)
    buffer_store_dwordx4 v[120:123], v94, s[12:15], s72 offen
    s_endpgm
END:
    s_endpgm
CODE_END:
.section .rodata,"a"
.p2align 6
.amdhsa_kernel interleave_layers__spectral_fnet__swiglu_ffn__prompt_kernel
  .amdhsa_next_free_vgpr 512
  .amdhsa_next_free_sgpr 102
  .amdhsa_accum_offset 256
  .amdhsa_group_segment_fixed_size 0
  .amdhsa_kernarg_size 96
  .amdhsa_user_sgpr_count 2
  .amdhsa_user_sgpr_kernarg_segment_ptr 1
  .amdhsa_system_sgpr_workgroup_id_x 1
.end_amdhsa_kernel
```
